```python
import torch

def _softmax(x, axis=-1):
    return torch.softmax(x, dim=axis)

def _gelu(x):
    return torch.nn.functional.gelu(x, approximate='tanh')

def _silu(x):
    return torch.nn.functional.silu(x)

def _sigmoid(x):
    return torch.sigmoid(x)

def _layernorm(x, axis=-1, eps=1e-05):
    m = x.mean(dim=axis, keepdim=True)
    v = x.var(dim=axis, keepdim=True, unbiased=False)
    return (x - m) / torch.sqrt(v + eps)

def _scatter_add(tgt, idx, src, axis=0):
    return tgt.clone().index_add_(axis, idx, src)

def _segment_sum(src, seg, n):
    out = torch.zeros((n,) + src.shape[1:], dtype=src.dtype)
    return out.index_add_(0, seg, src)

def _pad(x, pw):
    flat = tuple((v for pair in reversed(pw) for v in pair))
    return torch.nn.functional.pad(x, flat)
kernel_name = 'sequential_preLN__memory_aug_recurrent_mem_tr__glu_gated_glu__prompt'

def setup_inputs():

    _w = lambda a: (lambda t: t.to(torch.bfloat16) if t.is_floating_point() else t)(torch.as_tensor(a))

    def _A_setup():
        B, S, Dm = (1, 2048, 640)
        H, Dh = (32, 128)
        M, seg = (8, 32)
        seg = min(seg, S)
        S = S // seg * seg
        return {'x': _w((lambda *s: torch.randn(*s, dtype=torch.bfloat16) * 0.05)(B, S, Dm)), 'mem0': _w((lambda *s: torch.randn(*s, dtype=torch.bfloat16) * 0.2)(B, M, Dm)), 'Wq': _w((lambda *s: torch.randn(*s, dtype=torch.bfloat16) * 1.6)(Dm, H, Dh) * Dm ** (-0.5)), 'Wk': _w((lambda *s: torch.randn(*s, dtype=torch.bfloat16) * 1.6)(Dm, H, Dh) * Dm ** (-0.5)), 'Wv': _w((lambda *s: torch.randn(*s, dtype=torch.bfloat16) * 0.2)(Dm, H, Dh) * Dm ** (-0.5)), 'Wo': _w((lambda *s: torch.randn(*s, dtype=torch.bfloat16) * 0.2)(H, Dh, Dm) * (H * Dh) ** (-0.5)), 'seg_len': seg}
    _A_in = _A_setup()

    def _B_setup():
        B, S, D, F = (1, 2048, 640, 1728)
        return {'x': _w((lambda *s: torch.randn(*s, dtype=torch.bfloat16) * 0.05)(B, S, D)), 'w_gate': _w((lambda *s: torch.randn(*s, dtype=torch.bfloat16) * 0.05)(D, F)), 'w_up': _w((lambda *s: torch.randn(*s, dtype=torch.bfloat16) * 0.05)(D, F)), 'w_down': _w((lambda *s: torch.randn(*s, dtype=torch.bfloat16) * 0.05)(F, D))}
    _B_in = _B_setup()
    return {'A_x': _A_in['x'], 'A_mem0': _A_in['mem0'], 'A_Wq': _A_in['Wq'], 'A_Wk': _A_in['Wk'], 'A_Wv': _A_in['Wv'], 'A_Wo': _A_in['Wo'], 'A_seg_len': _A_in['seg_len'], 'B_x': _B_in['x'], 'B_w_gate': _B_in['w_gate'], 'B_w_up': _B_in['w_up'], 'B_w_down': _B_in['w_down']}

def reference(A_x, A_mem0, A_Wq, A_Wk, A_Wv, A_Wo, A_seg_len, B_x, B_w_gate, B_w_up, B_w_down):

    def _A_ref(x, mem0, Wq, Wk, Wv, Wo, seg_len):
        B, S, Dm = x.shape
        H, Dh = (Wq.shape[1], Wq.shape[2])
        M = mem0.shape[1]
        scale = Dh ** (-0.5)
        n_seg = S // seg_len
        L = M + seg_len
        idx = torch.arange(L)
        mask = (idx[:, None] < M) | (idx[:, None] >= idx[None, :])
        mem = mem0
        outs = []
        for s in range(n_seg):
            xs = x[:, s * seg_len:(s + 1) * seg_len, :].clone()
            h = torch.concatenate([mem, xs], axis=1)
            q = torch.einsum('btd,dhe->bhte', h, Wq)
            k = torch.einsum('btd,dhe->bhte', h, Wk)
            v = torch.einsum('btd,dhe->bhte', h, Wv)
            scores = torch.einsum('bhqe,bhke->bhqk', q, k) * scale
            scores = torch.where(mask[None, None], scores, -1000000000.0)
            p = _softmax(scores, axis=-1)
            o = torch.einsum('bhqk,bhke->bhqe', p, v)
            o = torch.einsum('bhte,hed->btd', o, Wo)
            mem = o[:, :M, :].clone()
            outs.append(o[:, M:, :])
        return torch.concatenate(outs, axis=1)

    def _B_ref(x, w_gate, w_up, w_down):
        g = torch.einsum('bsd,df->bsf', x, w_gate)
        u = torch.einsum('bsd,df->bsf', x, w_up)
        h = _sigmoid(g) * u
        return torch.einsum('bsf,fd->bsd', h, w_down)
    x = A_x
    h = x + _A_ref(_layernorm(x, axis=-1), A_mem0, A_Wq, A_Wk, A_Wv, A_Wo, A_seg_len)
    h2 = h + _B_ref(_layernorm(h, axis=-1), B_w_gate, B_w_up, B_w_down)
    return h2
```

```asm
; @launch kernel=main_kernel grid=(256,1,1) block=(256,1,1) lds=163840
.amdgcn_target "amdgcn-amd-amdhsa--gfx950"
.text
.globl main_kernel
.p2align 8
.type main_kernel,@function
main_kernel:

    s_cmp_ge_u32 s2, 256
    s_cbranch_scc1 L_end
    s_load_dwordx2 s[4:5], s[0:1], 96
    s_load_dwordx2 s[6:7], s[0:1], 104
    v_lshrrev_b32 v1, 6, v0
    s_nop 0
    v_readfirstlane_b32 s3, v1
    s_waitcnt lgkmcnt(0)
    s_mov_b32 s8, s6
    s_mov_b32 s9, s7
    s_mov_b32 s10, 0x10000000
    s_mov_b32 s11, 0x20000
    s_getreg_b32 s20, hwreg(HW_REG_XCC_ID)
    s_and_b32 s20, s20, 15
    s_mov_b32 s21, 8
    s_cmp_eq_u32 s20, 0
    s_cselect_b32 s21, 0, s21
    s_cmp_eq_u32 s20, 1
    s_cselect_b32 s21, 1, s21
    s_cmp_eq_u32 s20, 2
    s_cselect_b32 s21, 2, s21
    s_cmp_eq_u32 s20, 3
    s_cselect_b32 s21, 3, s21
    s_cmp_eq_u32 s20, 4
    s_cselect_b32 s21, 4, s21
    s_cmp_eq_u32 s20, 5
    s_cselect_b32 s21, 5, s21
    s_cmp_eq_u32 s20, 6
    s_cselect_b32 s21, 6, s21
    s_cmp_eq_u32 s20, 7
    s_cselect_b32 s21, 7, s21
    s_cmp_lg_u32 s3, 0
    s_cbranch_scc1 L_role_wait
    s_lshl_b32 s22, s21, 2
    v_mov_b32 v2, s22
    v_mov_b32 v3, 1
    s_mov_b64 exec, 1
    global_atomic_add v4, v2, v3, s[4:5] sc0
    s_waitcnt vmcnt(0)
    v_readfirstlane_b32 s23, v4
    s_mov_b64 exec, -1
    s_cmp_eq_u32 s21, 8
    s_cbranch_scc1 L_role_spare
    s_cmp_lt_u32 s23, 32
    s_cbranch_scc0 L_role_spare
    s_mov_b32 s16, s23
    s_mov_b32 s17, s21
    s_branch L_role_pub
L_role_spare:
    v_mov_b32 v2, 40
    s_mov_b64 exec, 1
    global_atomic_add v4, v2, v3, s[4:5] sc0
    s_waitcnt vmcnt(0)
    v_readfirstlane_b32 s24, v4
    s_mov_b64 exec, -1
    s_mov_b32 s25, 0
    v_and_b32 v2, 15, v0
    v_min_u32 v2, 8, v2
    v_lshlrev_b32 v2, 2, v2
L_role_all:
    global_load_dword v4, v2, s[4:5] sc1
    s_add_u32 s25, s25, 1
    s_waitcnt vmcnt(0)
    s_mov_b32 s29, 0
    v_readlane_b32 s30, v4, 0
    s_nop 0
    s_add_u32 s29, s29, s30
    v_readlane_b32 s31, v4, 1
    s_nop 0
    s_add_u32 s29, s29, s31
    v_readlane_b32 s32, v4, 2
    s_nop 0
    s_add_u32 s29, s29, s32
    v_readlane_b32 s33, v4, 3
    s_nop 0
    s_add_u32 s29, s29, s33
    v_readlane_b32 s34, v4, 4
    s_nop 0
    s_add_u32 s29, s29, s34
    v_readlane_b32 s35, v4, 5
    s_nop 0
    s_add_u32 s29, s29, s35
    v_readlane_b32 s36, v4, 6
    s_nop 0
    s_add_u32 s29, s29, s36
    v_readlane_b32 s37, v4, 7
    s_nop 0
    s_add_u32 s29, s29, s37
    v_readlane_b32 s38, v4, 8
    s_nop 0
    s_add_u32 s29, s29, s38
    s_cmp_ge_u32 s25, 200000
    s_cbranch_scc1 L_role_all_done
    s_cmp_lt_u32 s29, 256
    s_cbranch_scc1 L_role_all
L_role_all_done:
    s_mov_b32 s17, 7
    s_mov_b32 s16, 31
    s_min_u32 s26, s30, 32
    s_sub_u32 s26, 32, s26
    s_cmp_lt_u32 s24, s26
    s_cbranch_scc0 L_role_fill_1
    s_sub_u32 s16, 31, s24
    s_mov_b32 s17, 0
    s_branch L_role_pub
L_role_fill_1:
    s_sub_u32 s24, s24, s26
    s_min_u32 s26, s31, 32
    s_sub_u32 s26, 32, s26
    s_cmp_lt_u32 s24, s26
    s_cbranch_scc0 L_role_fill_2
    s_sub_u32 s16, 31, s24
    s_mov_b32 s17, 1
    s_branch L_role_pub
L_role_fill_2:
    s_sub_u32 s24, s24, s26
    s_min_u32 s26, s32, 32
    s_sub_u32 s26, 32, s26
    s_cmp_lt_u32 s24, s26
    s_cbranch_scc0 L_role_fill_3
    s_sub_u32 s16, 31, s24
    s_mov_b32 s17, 2
    s_branch L_role_pub
L_role_fill_3:
    s_sub_u32 s24, s24, s26
    s_min_u32 s26, s33, 32
    s_sub_u32 s26, 32, s26
    s_cmp_lt_u32 s24, s26
    s_cbranch_scc0 L_role_fill_4
    s_sub_u32 s16, 31, s24
    s_mov_b32 s17, 3
    s_branch L_role_pub
L_role_fill_4:
    s_sub_u32 s24, s24, s26
    s_min_u32 s26, s34, 32
    s_sub_u32 s26, 32, s26
    s_cmp_lt_u32 s24, s26
    s_cbranch_scc0 L_role_fill_5
    s_sub_u32 s16, 31, s24
    s_mov_b32 s17, 4
    s_branch L_role_pub
L_role_fill_5:
    s_sub_u32 s24, s24, s26
    s_min_u32 s26, s35, 32
    s_sub_u32 s26, 32, s26
    s_cmp_lt_u32 s24, s26
    s_cbranch_scc0 L_role_fill_6
    s_sub_u32 s16, 31, s24
    s_mov_b32 s17, 5
    s_branch L_role_pub
L_role_fill_6:
    s_sub_u32 s24, s24, s26
    s_min_u32 s26, s36, 32
    s_sub_u32 s26, 32, s26
    s_cmp_lt_u32 s24, s26
    s_cbranch_scc0 L_role_fill_7
    s_sub_u32 s16, 31, s24
    s_mov_b32 s17, 6
    s_branch L_role_pub
L_role_fill_7:
    s_sub_u32 s24, s24, s26
    s_min_u32 s26, s37, 32
    s_sub_u32 s26, 32, s26
    s_cmp_lt_u32 s24, s26
    s_cbranch_scc0 L_role_fill_8
    s_sub_u32 s16, 31, s24
    s_mov_b32 s17, 7
    s_branch L_role_pub
L_role_fill_8:
    s_sub_u32 s24, s24, s26
L_role_pub:
    v_mov_b32 v2, 0
    v_mov_b32 v4, s16
    v_mov_b32 v5, s17
    ds_write_b64 v2, v[4:5]
    s_waitcnt lgkmcnt(0)
L_role_wait:
    s_barrier
    v_mov_b32 v2, 0
    ds_read_b64 v[4:5], v2
    s_waitcnt lgkmcnt(0)
    v_readfirstlane_b32 s16, v4
    v_readfirstlane_b32 s17, v5
    s_barrier
    s_mov_b32 s18, 255
    s_mov_b32 s19, s17
    s_cmp_lt_u32 s17, 2
    s_cbranch_scc1 L_tab_done
    s_cmp_lg_u32 s19, 2
    s_cbranch_scc1 L_tab_9
    s_cmp_ge_u32 s16, 20
    s_cbranch_scc1 L_tabp_10
    s_sub_u32 s20, s16, 0
    s_add_u32 s18, s20, 0
    s_add_u32 s16, s20, 0
    s_mov_b32 s17, 4
    s_branch L_tab_done
L_tabp_10:
    s_cmp_ge_u32 s16, 32
    s_cbranch_scc1 L_tabp_11
    s_sub_u32 s20, s16, 20
    s_add_u32 s16, s20, 0
    s_mov_b32 s17, 2
    s_branch L_tab_done
L_tabp_11:
L_tab_9:
    s_cmp_lg_u32 s19, 3
    s_cbranch_scc1 L_tab_12
    s_cmp_ge_u32 s16, 20
    s_cbranch_scc1 L_tabp_13
    s_sub_u32 s20, s16, 0
    s_add_u32 s18, s20, 20
    s_add_u32 s16, s20, 20
    s_mov_b32 s17, 4
    s_branch L_tab_done
L_tabp_13:
    s_cmp_ge_u32 s16, 32
    s_cbranch_scc1 L_tabp_14
    s_sub_u32 s20, s16, 20
    s_add_u32 s16, s20, 12
    s_mov_b32 s17, 2
    s_branch L_tab_done
L_tabp_14:
L_tab_12:
    s_cmp_lg_u32 s19, 4
    s_cbranch_scc1 L_tab_15
    s_cmp_ge_u32 s16, 20
    s_cbranch_scc1 L_tabp_16
    s_sub_u32 s20, s16, 0
    s_add_u32 s18, s20, 40
    s_add_u32 s16, s20, 0
    s_mov_b32 s17, 6
    s_branch L_tab_done
L_tabp_16:
    s_cmp_ge_u32 s16, 32
    s_cbranch_scc1 L_tabp_17
    s_sub_u32 s20, s16, 20
    s_add_u32 s16, s20, 24
    s_mov_b32 s17, 2
    s_branch L_tab_done
L_tabp_17:
L_tab_15:
    s_cmp_lg_u32 s19, 5
    s_cbranch_scc1 L_tab_18
    s_cmp_ge_u32 s16, 27
    s_cbranch_scc1 L_tabp_19
    s_sub_u32 s20, s16, 0
    s_add_u32 s18, s20, 60
    s_add_u32 s16, s20, 0
    s_mov_b32 s17, 5
    s_branch L_tab_done
L_tabp_19:
    s_cmp_ge_u32 s16, 32
    s_cbranch_scc1 L_tabp_20
    s_sub_u32 s20, s16, 27
    s_add_u32 s16, s20, 36
    s_mov_b32 s17, 2
    s_branch L_tab_done
L_tabp_20:
L_tab_18:
    s_cmp_lg_u32 s19, 6
    s_cbranch_scc1 L_tab_21
    s_cmp_ge_u32 s16, 27
    s_cbranch_scc1 L_tabp_22
    s_sub_u32 s20, s16, 0
    s_add_u32 s18, s20, 87
    s_add_u32 s16, s20, 27
    s_mov_b32 s17, 5
    s_branch L_tab_done
L_tabp_22:
    s_cmp_ge_u32 s16, 32
    s_cbranch_scc1 L_tabp_23
    s_sub_u32 s20, s16, 27
    s_add_u32 s16, s20, 41
    s_mov_b32 s17, 2
    s_branch L_tab_done
L_tabp_23:
L_tab_21:
    s_cmp_lg_u32 s19, 7
    s_cbranch_scc1 L_tab_24
    s_cmp_ge_u32 s16, 24
    s_cbranch_scc1 L_tabp_25
    s_sub_u32 s20, s16, 0
    s_add_u32 s18, s20, 114
    s_add_u32 s16, s20, 0
    s_mov_b32 s17, 3
    s_branch L_tab_done
L_tabp_25:
    s_cmp_ge_u32 s16, 26
    s_cbranch_scc1 L_tabp_26
    s_sub_u32 s20, s16, 24
    s_add_u32 s16, s20, 46
    s_mov_b32 s17, 2
    s_branch L_tab_done
L_tabp_26:
    s_cmp_ge_u32 s16, 32
    s_cbranch_scc1 L_tabp_27
    s_sub_u32 s20, s16, 26
    s_add_u32 s16, s20, 0
    s_mov_b32 s17, 7
    s_branch L_tab_done
L_tabp_27:
L_tab_24:
L_tab_done:
    s_cmp_ge_u32 s17, 2
    s_cbranch_scc1 L_worker
    s_mov_b32 s18, s17
    v_mov_b32 v70, v0
    s_mov_b32 s17, 0
    s_mov_b32 s29, 0
    s_mul_i32 s27, s18, 32768
    s_add_u32 s19, s27, 68157440
    s_mov_b32 s20, 8192
    s_mov_b32 s49, 65536
    s_xor_b32 s24, s18, 1
    s_mul_i32 s24, s24, 32768
    s_sub_u32 s24, s24, s27
    s_add_u32 s50, s24, 65536
    s_lshl_b32 s24, s16, 13
    s_lshl_b32 s25, s3, 11
    s_add_u32 s22, s24, s25
    s_add_u32 s22, s22, 4194304
    s_add_u32 s23, s22, 16777216
    s_lshl_b32 s24, s16, 12
    s_lshl_b32 s25, s3, 10
    s_add_u32 s30, s24, s25
    s_add_u32 s30, s30, 54525952
    s_lshr_b32 s24, s30, 1
    s_add_u32 s58, s24, 35651584
    s_mov_b32 s31, 0x3e0293ee
    s_mov_b32 s42, s31
    s_mov_b32 s43, s31
    s_mov_b32 s32, 0x00ff00ff
    s_mov_b32 s33, 0x00ff00ff
    s_mul_i32 s27, s18, 491520
    s_add_u32 s27, s27, 67108864
    s_mov_b32 s21, 0
    s_mov_b32 s41, 327680
    s_mul_i32 s24, s3, 3
    s_cmp_eq_u32 s3, 3
    s_cselect_b32 s24, 8, s24
    s_lshl_b32 s24, s24, 14
    s_lshl_b32 s25, s16, 9
    s_add_u32 s24, s24, s25
    s_add_u32 s45, s24, s27
    s_mov_b32 s44, s45
    s_cmp_lt_u32 s3, 2
    s_cselect_b32 s51, 1, 0
    s_mov_b32 s59, 16384
    s_cselect_b32 s59, 32768, s59
    s_lshl_b32 s26, s3, 5
    s_add_u32 s26, s26, s16
    s_cmp_lt_u32 s26, 40
    s_cselect_b32 s48, 1, 0
    s_lshl_b32 s46, s26, 7
    s_lshr_b32 s24, s26, 2
    s_lshl_b32 s24, s24, 14
    s_and_b32 s25, s26, 3
    s_lshl_b32 s25, s25, 7
    s_add_u32 s24, s24, s25
    s_add_u32 s40, s24, s27
    s_mul_i32 s47, s3, 1536
    v_and_b32 v71, 63, v70
    v_lshlrev_b32 v0, 4, v71
    s_mul_i32 s24, s3, 19
    s_cmp_eq_u32 s3, 3
    s_cselect_b32 s24, 53, s24
    s_lshl_b32 s24, s24, 11
    s_add_u32 s24, s24, 16384
    v_add_u32 v1, s24, v0
    v_and_b32 v72, 15, v71
    v_lshrrev_b32 v73, 4, v71
    v_and_b32 v74, 1, v71
    v_mov_b32 v75, 0x4444
    v_mov_b32 v76, 0xeeee
    v_cmp_eq_u32 vcc, 1, v74
    s_nop 1
    v_cndmask_b32 v2, v75, v76, vcc
    s_mul_i32 s24, s3, 1536
    s_add_u32 s24, s24, 10240
    v_lshlrev_b32 v74, 7, v73
    v_lshlrev_b32 v75, 2, v72
    v_add3_u32 v3, v74, v75, s24
    v_and_b32 v74, 7, v72
    v_lshlrev_b32 v74, 6, v74
    v_lshlrev_b32 v75, 4, v73
    v_add3_u32 v4, v74, v75, s24
    v_lshrrev_b32 v74, 2, v72
    v_lshlrev_b32 v74, 1, v74
    v_and_b32 v76, 1, v72
    v_add_u32 v74, v74, v76
    v_lshlrev_b32 v74, 6, v74
    v_add3_u32 v5, v74, v75, s24
    v_add_u32 v5, 512, v5
    v_and_b32 v74, 7, v72
    v_lshlrev_b32 v75, 3, v73
    v_add_u32 v74, v74, v75
    v_mul_u32_u24 v74, 48, v74
    v_lshrrev_b32 v75, 3, v72
    v_mul_u32_u24 v75, 3072, v75
    v_add_u32 v74, v74, v75
    v_add_u32 v6, 10240, v74
    s_lshr_b32 s24, s3, 1
    s_lshl_b32 s24, s24, 10
    s_and_b32 s25, s3, 1
    s_lshl_b32 s25, s25, 9
    s_add_u32 s24, s24, s25
    s_add_u32 s24, s24, 0
    v_lshrrev_b32 v74, 1, v73
    v_lshlrev_b32 v74, 4, v74
    v_and_b32 v75, 7, v72
    v_lshlrev_b32 v75, 1, v75
    v_add_u32 v74, v74, v75
    v_and_b32 v75, 1, v73
    v_add_u32 v74, v74, v75
    v_lshlrev_b32 v74, 4, v74
    v_add_u32 v7, s24, v74
    v_lshrrev_b32 v74, 2, v72
    v_lshlrev_b32 v74, 7, v74
    v_lshlrev_b32 v75, 5, v73
    v_and_b32 v76, 3, v72
    v_lshlrev_b32 v76, 3, v76
    v_add3_u32 v8, v74, v75, v76
    v_lshlrev_b32 v74, 1, v73
    v_lshrrev_b32 v75, 3, v72
    v_add_u32 v74, v74, v75
    v_lshlrev_b32 v74, 9, v74
    v_and_b32 v75, 7, v72
    v_lshlrev_b32 v75, 4, v75
    v_add_u32 v9, v74, v75
    v_and_b32 v74, 6, v72
    v_add_u32 v74, v74, v73
    v_lshlrev_b32 v74, 4, v74
    v_and_b32 v75, 1, v72
    v_lshlrev_b32 v75, 3, v75
    v_add_u32 v10, v74, v75
    v_and_b32 v74, 48, v71
    v_and_b32 v75, 7, v71
    v_lshlrev_b32 v75, 1, v75
    v_bfe_u32 v76, v71, 3, 1
    v_add3_u32 v74, v74, v75, v76
    v_lshlrev_b32 v74, 4, v74
    s_lshl_b32 s24, s3, 10
    v_add_u32 v11, s24, v74
    s_load_dwordx2 s[56:57], s[0:1], 8
    s_waitcnt lgkmcnt(0)
    s_mov_b32 s12, s56
    s_mov_b32 s13, s57
    s_mov_b32 s14, 0x2800
    s_mov_b32 s15, 0x20000
    s_mul_i32 s52, s18, 5
    v_add_u32 v72, 0, v70
    v_min_u32 v72, 639, v72
    v_lshrrev_b32 v73, 6, v72
    v_add_u32 v73, s52, v73
    v_subrev_u32 v79, 10, v73
    v_cmp_le_u32 vcc, 10, v73
    s_nop 1
    v_cndmask_b32 v73, v73, v79, vcc
    v_and_b32 v74, 63, v72
    v_bfe_u32 v75, v74, 1, 3
    v_and_b32 v76, 1, v74
    v_lshrrev_b32 v77, 4, v74
    v_lshlrev_b32 v78, 6, v73
    v_lshrrev_b32 v79, 1, v77
    v_lshlrev_b32 v79, 5, v79
    v_add_u32 v78, v78, v79
    v_and_b32 v79, 1, v77
    v_lshlrev_b32 v79, 3, v79
    v_add_u32 v78, v78, v79
    v_lshlrev_b32 v79, 2, v76
    v_add_u32 v78, v78, v79
    v_mul_u32_u24 v75, 1280, v75
    v_lshlrev_b32 v78, 1, v78
    v_add_u32 v78, v78, v75
    buffer_load_dwordx2 v[80:81], v78, s[12:15], 0 offen
    buffer_load_dwordx2 v[82:83], v78, s[12:15], 0 offen offset:32
    v_add_u32 v72, 256, v70
    v_min_u32 v72, 639, v72
    v_lshrrev_b32 v73, 6, v72
    v_add_u32 v73, s52, v73
    v_subrev_u32 v79, 10, v73
    v_cmp_le_u32 vcc, 10, v73
    s_nop 1
    v_cndmask_b32 v73, v73, v79, vcc
    v_and_b32 v74, 63, v72
    v_bfe_u32 v75, v74, 1, 3
    v_and_b32 v76, 1, v74
    v_lshrrev_b32 v77, 4, v74
    v_lshlrev_b32 v78, 6, v73
    v_lshrrev_b32 v79, 1, v77
    v_lshlrev_b32 v79, 5, v79
    v_add_u32 v78, v78, v79
    v_and_b32 v79, 1, v77
    v_lshlrev_b32 v79, 3, v79
    v_add_u32 v78, v78, v79
    v_lshlrev_b32 v79, 2, v76
    v_add_u32 v78, v78, v79
    v_mul_u32_u24 v75, 1280, v75
    v_lshlrev_b32 v78, 1, v78
    v_add_u32 v78, v78, v75
    buffer_load_dwordx2 v[84:85], v78, s[12:15], 0 offen
    buffer_load_dwordx2 v[86:87], v78, s[12:15], 0 offen offset:32
    v_add_u32 v72, 512, v70
    v_min_u32 v72, 639, v72
    v_lshrrev_b32 v73, 6, v72
    v_add_u32 v73, s52, v73
    v_subrev_u32 v79, 10, v73
    v_cmp_le_u32 vcc, 10, v73
    s_nop 1
    v_cndmask_b32 v73, v73, v79, vcc
    v_and_b32 v74, 63, v72
    v_bfe_u32 v75, v74, 1, 3
    v_and_b32 v76, 1, v74
    v_lshrrev_b32 v77, 4, v74
    v_lshlrev_b32 v78, 6, v73
    v_lshrrev_b32 v79, 1, v77
    v_lshlrev_b32 v79, 5, v79
    v_add_u32 v78, v78, v79
    v_and_b32 v79, 1, v77
    v_lshlrev_b32 v79, 3, v79
    v_add_u32 v78, v78, v79
    v_lshlrev_b32 v79, 2, v76
    v_add_u32 v78, v78, v79
    v_mul_u32_u24 v75, 1280, v75
    v_lshlrev_b32 v78, 1, v78
    v_add_u32 v78, v78, v75
    buffer_load_dwordx2 v[66:67], v78, s[12:15], 0 offen
    buffer_load_dwordx2 v[68:69], v78, s[12:15], 0 offen offset:32
    v_mov_b32 v60, -1
    v_mov_b32 v61, -1
    v_mov_b32 v62, -1
    v_mov_b32 v63, -1
    v_and_b32 v65, 0x1f0, v0
    v_lshrrev_b32 v64, 9, v0
    v_lshlrev_b32 v64, 14, v64
    v_add_u32 v64, v64, v65
    s_add_u32 s25, s45, 0
    buffer_store_dwordx4 v[60:63], v64, s[8:11], s25 offen sc1
    s_add_u32 s24, s25, s59
    buffer_store_dwordx4 v[60:63], v65, s[8:11], s24 offen sc1
    s_add_u32 s25, s45, 163840
    buffer_store_dwordx4 v[60:63], v64, s[8:11], s25 offen sc1
    s_add_u32 s24, s25, s59
    buffer_store_dwordx4 v[60:63], v65, s[8:11], s24 offen sc1
    s_add_u32 s25, s45, 327680
    buffer_store_dwordx4 v[60:63], v64, s[8:11], s25 offen sc1
    s_add_u32 s24, s25, s59
    buffer_store_dwordx4 v[60:63], v65, s[8:11], s24 offen sc1
    s_cmp_eq_u32 s48, 0
    s_cbranch_scc1 L_ch_norst0
    s_mov_b64 exec, 0xff
    s_add_u32 s24, s46, s19
    s_add_u32 s24, s24, 0
    s_add_u32 s25, s24, s49
    buffer_store_dwordx4 v[60:63], v0, s[8:11], s24 offen sc1
    buffer_store_dwordx4 v[60:63], v0, s[8:11], s25 offen sc1
    s_add_u32 s24, s46, s19
    s_add_u32 s24, s24, 8192
    s_add_u32 s25, s24, s49
    buffer_store_dwordx4 v[60:63], v0, s[8:11], s24 offen sc1
    buffer_store_dwordx4 v[60:63], v0, s[8:11], s25 offen sc1
    s_add_u32 s24, s46, s19
    s_add_u32 s24, s24, 16384
    s_add_u32 s25, s24, s49
    buffer_store_dwordx4 v[60:63], v0, s[8:11], s24 offen sc1
    buffer_store_dwordx4 v[60:63], v0, s[8:11], s25 offen sc1
    s_add_u32 s24, s46, s19
    s_add_u32 s24, s24, 24576
    s_add_u32 s25, s24, s49
    buffer_store_dwordx4 v[60:63], v0, s[8:11], s24 offen sc1
    buffer_store_dwordx4 v[60:63], v0, s[8:11], s25 offen sc1
    s_mov_b64 exec, -1
L_ch_norst0:
    v_lshrrev_b32 v72, 4, v70
    v_and_b32 v73, 15, v70
    v_lshlrev_b32 v74, 13, v72
    v_lshlrev_b32 v75, 4, v73
    v_add_u32 v60, v74, v75
    v_mul_u32_u24 v74, 1280, v72
    v_lshrrev_b32 v76, 2, v73
    v_mul_u32_u24 v77, 192, v76
    v_cmp_eq_u32 vcc, 3, v76
    v_mov_b32 v78, 512
    s_nop 0
    v_cndmask_b32 v77, v77, v78, vcc
    v_and_b32 v78, 3, v73
    v_lshlrev_b32 v78, 4, v78
    v_add3_u32 v61, v74, v77, v78
    v_cmp_le_u32 vcc, 2, v76
    v_mov_b32 v78, 64
    s_nop 0
    v_cndmask_b32 v78, 0, v78, vcc
    v_sub_u32 v65, v61, v78
    v_mul_u32_u24 v74, 272, v72
    v_add_u32 v62, v74, v75
    v_and_b32 v72, 15, v71
    v_lshrrev_b32 v73, 4, v71
    v_lshrrev_b32 v74, 2, v72
    v_and_b32 v75, 3, v72
    v_lshlrev_b32 v75, 3, v75
    v_lshrrev_b32 v76, 1, v73
    v_lshlrev_b32 v76, 3, v76
    v_and_b32 v77, 1, v73
    v_lshlrev_b32 v77, 1, v77
    v_add_u32 v76, v76, v77
    v_and_b32 v77, 1, v74
    v_lshlrev_b32 v77, 4, v77
    v_add_u32 v76, v76, v77
    v_lshrrev_b32 v77, 1, v74
    v_lshlrev_b32 v77, 2, v77
    v_add_u32 v76, v76, v77
    v_mul_u32_u24 v76, 272, v76
    s_lshl_b32 s24, s3, 6
    v_add3_u32 v63, v76, v75, s24
    v_and_b32 v76, 1, v73
    v_lshlrev_b32 v76, 4, v76
    v_lshrrev_b32 v77, 1, v73
    v_lshlrev_b32 v77, 3, v77
    v_add_u32 v76, v76, v77
    v_and_b32 v77, 1, v74
    v_add_u32 v76, v76, v77
    v_lshrrev_b32 v77, 1, v74
    v_lshlrev_b32 v77, 2, v77
    v_add_u32 v76, v76, v77
    v_mul_u32_u24 v76, 272, v76
    v_add3_u32 v64, v76, v75, s24
    s_lshl_b32 s52, s16, 8
    s_mul_i32 s53, s18, 2621440
    s_mul_i32 s54, s16, 163840
    s_mul_i32 s24, s18, 640
    s_add_u32 s54, s54, s24
    s_load_dwordx2 s[56:57], s[0:1], 24
    s_waitcnt lgkmcnt(0)
    s_mov_b32 s12, s56
    s_mov_b32 s13, s57
    s_mov_b32 s14, 0x500000
    s_mov_b32 s15, 0x20000
    s_add_u32 s24, s53, 0
    s_cmp_ge_u32 s24, 5242880
    s_cselect_b32 s25, 5242880, 0
    s_sub_u32 s24, s24, s25
    s_add_u32 s24, s24, s52
    s_add_u32 s25, s24, 131072
    buffer_load_dwordx4 v[12:15], v60, s[12:15], s24 offen
    buffer_load_dwordx4 v[16:19], v60, s[12:15], s25 offen
    s_add_u32 s24, s53, 262144
    s_cmp_ge_u32 s24, 5242880
    s_cselect_b32 s25, 5242880, 0
    s_sub_u32 s24, s24, s25
    s_add_u32 s24, s24, s52
    s_add_u32 s25, s24, 131072
    buffer_load_dwordx4 v[20:23], v60, s[12:15], s24 offen
    buffer_load_dwordx4 v[24:27], v60, s[12:15], s25 offen
    s_add_u32 s24, s53, 524288
    s_cmp_ge_u32 s24, 5242880
    s_cselect_b32 s25, 5242880, 0
    s_sub_u32 s24, s24, s25
    s_add_u32 s24, s24, s52
    s_add_u32 s25, s24, 131072
    buffer_load_dwordx4 v[28:31], v60, s[12:15], s24 offen
    buffer_load_dwordx4 v[32:35], v60, s[12:15], s25 offen
    s_add_u32 s24, s53, 786432
    s_cmp_ge_u32 s24, 5242880
    s_cselect_b32 s25, 5242880, 0
    s_sub_u32 s24, s24, s25
    s_add_u32 s24, s24, s52
    s_add_u32 s25, s24, 131072
    buffer_load_dwordx4 v[36:39], v60, s[12:15], s24 offen
    buffer_load_dwordx4 v[40:43], v60, s[12:15], s25 offen
    s_add_u32 s24, s53, 1048576
    s_cmp_ge_u32 s24, 5242880
    s_cselect_b32 s25, 5242880, 0
    s_sub_u32 s24, s24, s25
    s_add_u32 s24, s24, s52
    s_add_u32 s25, s24, 131072
    buffer_load_dwordx4 v[44:47], v60, s[12:15], s24 offen
    buffer_load_dwordx4 v[48:51], v60, s[12:15], s25 offen
    s_add_u32 s24, s53, 1310720
    s_cmp_ge_u32 s24, 5242880
    s_cselect_b32 s25, 5242880, 0
    s_sub_u32 s24, s24, s25
    s_add_u32 s24, s24, s52
    s_add_u32 s25, s24, 131072
    buffer_load_dwordx4 v[52:55], v60, s[12:15], s24 offen
    buffer_load_dwordx4 v[56:59], v60, s[12:15], s25 offen
    s_waitcnt vmcnt(10)
    s_waitcnt lgkmcnt(0)
    s_barrier
    s_cmp_lg_u32 s3, 0
    s_cbranch_scc1 L_ch_noarr
    v_mov_b32 v72, 48
    v_mov_b32 v73, 1
    s_mov_b64 exec, 1
    global_atomic_add v72, v73, s[4:5]
    s_mov_b64 exec, -1
L_ch_noarr:
    ds_write_b128 v62, v[12:15] offset:0
    ds_write_b128 v62, v[16:19] offset:4352
    s_waitcnt lgkmcnt(0)
    s_barrier
    s_add_u32 s24, s53, 1572864
    s_cmp_ge_u32 s24, 5242880
    s_cselect_b32 s25, 5242880, 0
    s_sub_u32 s24, s24, s25
    s_add_u32 s24, s24, s52
    s_add_u32 s25, s24, 131072
    buffer_load_dwordx4 v[12:15], v60, s[12:15], s24 offen
    buffer_load_dwordx4 v[16:19], v60, s[12:15], s25 offen
    ds_read_b64_tr_b16 v[104:105], v63 offset:0
    ds_read_b64_tr_b16 v[106:107], v63 offset:272
    ds_read_b64_tr_b16 v[76:77], v63 offset:32
    ds_read_b64_tr_b16 v[78:79], v63 offset:304
    s_waitcnt lgkmcnt(0)
    ds_write_b128 v1, v[76:79] offset:0
    s_waitcnt vmcnt(10)
    s_waitcnt lgkmcnt(0)
    s_barrier
    ds_write_b128 v62, v[20:23] offset:0
    ds_write_b128 v62, v[24:27] offset:4352
    s_waitcnt lgkmcnt(0)
    s_barrier
    s_add_u32 s24, s53, 1835008
    s_cmp_ge_u32 s24, 5242880
    s_cselect_b32 s25, 5242880, 0
    s_sub_u32 s24, s24, s25
    s_add_u32 s24, s24, s52
    s_add_u32 s25, s24, 131072
    buffer_load_dwordx4 v[20:23], v60, s[12:15], s24 offen
    buffer_load_dwordx4 v[24:27], v60, s[12:15], s25 offen
    ds_read_b64_tr_b16 v[108:109], v63 offset:0
    ds_read_b64_tr_b16 v[110:111], v63 offset:272
    ds_read_b64_tr_b16 v[76:77], v63 offset:32
    ds_read_b64_tr_b16 v[78:79], v63 offset:304
    s_waitcnt lgkmcnt(0)
    ds_write_b128 v1, v[76:79] offset:1024
    s_waitcnt vmcnt(10)
    s_waitcnt lgkmcnt(0)
    s_barrier
    ds_write_b128 v62, v[28:31] offset:0
    ds_write_b128 v62, v[32:35] offset:4352
    s_waitcnt lgkmcnt(0)
    s_barrier
    s_add_u32 s24, s53, 2097152
    s_cmp_ge_u32 s24, 5242880
    s_cselect_b32 s25, 5242880, 0
    s_sub_u32 s24, s24, s25
    s_add_u32 s24, s24, s52
    s_add_u32 s25, s24, 131072
    buffer_load_dwordx4 v[28:31], v60, s[12:15], s24 offen
    buffer_load_dwordx4 v[32:35], v60, s[12:15], s25 offen
    ds_read_b64_tr_b16 v[136:137], v63 offset:0
    ds_read_b64_tr_b16 v[138:139], v63 offset:272
    ds_read_b64_tr_b16 v[76:77], v63 offset:32
    ds_read_b64_tr_b16 v[78:79], v63 offset:304
    s_waitcnt lgkmcnt(0)
    ds_write_b128 v1, v[76:79] offset:4096
    s_waitcnt vmcnt(10)
    s_waitcnt lgkmcnt(0)
    s_barrier
    ds_write_b128 v62, v[36:39] offset:0
    ds_write_b128 v62, v[40:43] offset:4352
    s_waitcnt lgkmcnt(0)
    s_barrier
    s_add_u32 s24, s53, 2359296
    s_cmp_ge_u32 s24, 5242880
    s_cselect_b32 s25, 5242880, 0
    s_sub_u32 s24, s24, s25
    s_add_u32 s24, s24, s52
    s_add_u32 s25, s24, 131072
    buffer_load_dwordx4 v[36:39], v60, s[12:15], s24 offen
    buffer_load_dwordx4 v[40:43], v60, s[12:15], s25 offen
    ds_read_b64_tr_b16 v[140:141], v63 offset:0
    ds_read_b64_tr_b16 v[142:143], v63 offset:272
    ds_read_b64_tr_b16 v[76:77], v63 offset:32
    ds_read_b64_tr_b16 v[78:79], v63 offset:304
    s_waitcnt lgkmcnt(0)
    ds_write_b128 v1, v[76:79] offset:5120
    s_waitcnt vmcnt(10)
    s_waitcnt lgkmcnt(0)
    s_barrier
    ds_write_b128 v62, v[44:47] offset:0
    ds_write_b128 v62, v[48:51] offset:4352
    s_waitcnt lgkmcnt(0)
    s_barrier
    s_add_u32 s24, s53, 2621440
    s_cmp_ge_u32 s24, 5242880
    s_cselect_b32 s25, 5242880, 0
    s_sub_u32 s24, s24, s25
    s_add_u32 s24, s24, s52
    s_add_u32 s25, s24, 131072
    buffer_load_dwordx4 v[44:47], v60, s[12:15], s24 offen
    buffer_load_dwordx4 v[48:51], v60, s[12:15], s25 offen
    ds_read_b64_tr_b16 v[168:169], v63 offset:0
    ds_read_b64_tr_b16 v[170:171], v63 offset:272
    ds_read_b64_tr_b16 v[76:77], v63 offset:32
    ds_read_b64_tr_b16 v[78:79], v63 offset:304
    s_waitcnt lgkmcnt(0)
    ds_write_b128 v1, v[76:79] offset:8192
    s_waitcnt vmcnt(10)
    s_waitcnt lgkmcnt(0)
    s_barrier
    ds_write_b128 v62, v[52:55] offset:0
    ds_write_b128 v62, v[56:59] offset:4352
    s_waitcnt lgkmcnt(0)
    s_barrier
    s_add_u32 s24, s53, 2883584
    s_cmp_ge_u32 s24, 5242880
    s_cselect_b32 s25, 5242880, 0
    s_sub_u32 s24, s24, s25
    s_add_u32 s24, s24, s52
    s_add_u32 s25, s24, 131072
    buffer_load_dwordx4 v[52:55], v60, s[12:15], s24 offen
    buffer_load_dwordx4 v[56:59], v60, s[12:15], s25 offen
    ds_read_b64_tr_b16 v[172:173], v63 offset:0
    ds_read_b64_tr_b16 v[174:175], v63 offset:272
    ds_read_b64_tr_b16 v[76:77], v63 offset:32
    ds_read_b64_tr_b16 v[78:79], v63 offset:304
    s_waitcnt lgkmcnt(0)
    ds_write_b128 v1, v[76:79] offset:9216
    s_waitcnt vmcnt(10)
    s_waitcnt lgkmcnt(0)
    s_barrier
    ds_write_b128 v62, v[12:15] offset:0
    ds_write_b128 v62, v[16:19] offset:4352
    s_waitcnt lgkmcnt(0)
    s_barrier
    s_add_u32 s24, s53, 3145728
    s_cmp_ge_u32 s24, 5242880
    s_cselect_b32 s25, 5242880, 0
    s_sub_u32 s24, s24, s25
    s_add_u32 s24, s24, s52
    s_add_u32 s25, s24, 131072
    buffer_load_dwordx4 v[12:15], v60, s[12:15], s24 offen
    buffer_load_dwordx4 v[16:19], v60, s[12:15], s25 offen
    ds_read_b64_tr_b16 v[200:201], v63 offset:0
    ds_read_b64_tr_b16 v[202:203], v63 offset:272
    ds_read_b64_tr_b16 v[76:77], v63 offset:32
    ds_read_b64_tr_b16 v[78:79], v63 offset:304
    s_waitcnt lgkmcnt(0)
    ds_write_b128 v1, v[76:79] offset:12288
    s_waitcnt vmcnt(10)
    s_waitcnt lgkmcnt(0)
    s_barrier
    ds_write_b128 v62, v[20:23] offset:0
    ds_write_b128 v62, v[24:27] offset:4352
    s_waitcnt lgkmcnt(0)
    s_barrier
    s_add_u32 s24, s53, 3407872
    s_cmp_ge_u32 s24, 5242880
    s_cselect_b32 s25, 5242880, 0
    s_sub_u32 s24, s24, s25
    s_add_u32 s24, s24, s52
    s_add_u32 s25, s24, 131072
    buffer_load_dwordx4 v[20:23], v60, s[12:15], s24 offen
    buffer_load_dwordx4 v[24:27], v60, s[12:15], s25 offen
    ds_read_b64_tr_b16 v[204:205], v63 offset:0
    ds_read_b64_tr_b16 v[206:207], v63 offset:272
    ds_read_b64_tr_b16 v[76:77], v63 offset:32
    ds_read_b64_tr_b16 v[78:79], v63 offset:304
    s_waitcnt lgkmcnt(0)
    ds_write_b128 v1, v[76:79] offset:13312
    s_waitcnt vmcnt(10)
    s_waitcnt lgkmcnt(0)
    s_barrier
    ds_write_b128 v62, v[28:31] offset:0
    ds_write_b128 v62, v[32:35] offset:4352
    s_waitcnt lgkmcnt(0)
    s_barrier
    s_add_u32 s24, s53, 3670016
    s_cmp_ge_u32 s24, 5242880
    s_cselect_b32 s25, 5242880, 0
    s_sub_u32 s24, s24, s25
    s_add_u32 s24, s24, s52
    s_add_u32 s25, s24, 131072
    buffer_load_dwordx4 v[28:31], v60, s[12:15], s24 offen
    buffer_load_dwordx4 v[32:35], v60, s[12:15], s25 offen
    ds_read_b64_tr_b16 v[240:241], v63 offset:0
    ds_read_b64_tr_b16 v[242:243], v63 offset:272
    ds_read_b64_tr_b16 v[76:77], v63 offset:32
    ds_read_b64_tr_b16 v[78:79], v63 offset:304
    s_waitcnt lgkmcnt(0)
    ds_write_b128 v1, v[76:79] offset:14336
    s_waitcnt vmcnt(10)
    s_waitcnt lgkmcnt(0)
    s_barrier
    ds_write_b128 v62, v[36:39] offset:0
    ds_write_b128 v62, v[40:43] offset:4352
    s_waitcnt lgkmcnt(0)
    s_barrier
    s_add_u32 s24, s53, 3932160
    s_cmp_ge_u32 s24, 5242880
    s_cselect_b32 s25, 5242880, 0
    s_sub_u32 s24, s24, s25
    s_add_u32 s24, s24, s52
    s_add_u32 s25, s24, 131072
    buffer_load_dwordx4 v[36:39], v60, s[12:15], s24 offen
    buffer_load_dwordx4 v[40:43], v60, s[12:15], s25 offen
    ds_read_b64_tr_b16 v[244:245], v63 offset:0
    ds_read_b64_tr_b16 v[246:247], v63 offset:272
    ds_read_b64_tr_b16 v[76:77], v63 offset:32
    ds_read_b64_tr_b16 v[78:79], v63 offset:304
    s_waitcnt lgkmcnt(0)
    ds_write_b128 v1, v[76:79] offset:15360
    s_waitcnt vmcnt(10)
    s_waitcnt lgkmcnt(0)
    s_barrier
    ds_write_b128 v62, v[44:47] offset:0
    ds_write_b128 v62, v[48:51] offset:4352
    s_waitcnt lgkmcnt(0)
    s_barrier
    s_add_u32 s24, s53, 4194304
    s_cmp_ge_u32 s24, 5242880
    s_cselect_b32 s25, 5242880, 0
    s_sub_u32 s24, s24, s25
    s_add_u32 s24, s24, s52
    s_add_u32 s25, s24, 131072
    buffer_load_dwordx4 v[44:47], v60, s[12:15], s24 offen
    buffer_load_dwordx4 v[48:51], v60, s[12:15], s25 offen
    ds_read_b64_tr_b16 a[24:25], v63 offset:0
    ds_read_b64_tr_b16 a[26:27], v63 offset:272
    ds_read_b64_tr_b16 v[76:77], v63 offset:32
    ds_read_b64_tr_b16 v[78:79], v63 offset:304
    s_waitcnt lgkmcnt(0)
    ds_write_b128 v1, v[76:79] offset:16384
    s_waitcnt vmcnt(10)
    s_waitcnt lgkmcnt(0)
    s_barrier
    ds_write_b128 v62, v[52:55] offset:0
    ds_write_b128 v62, v[56:59] offset:4352
    s_waitcnt lgkmcnt(0)
    s_barrier
    s_add_u32 s24, s53, 4456448
    s_cmp_ge_u32 s24, 5242880
    s_cselect_b32 s25, 5242880, 0
    s_sub_u32 s24, s24, s25
    s_add_u32 s24, s24, s52
    s_add_u32 s25, s24, 131072
    buffer_load_dwordx4 v[52:55], v60, s[12:15], s24 offen
    buffer_load_dwordx4 v[56:59], v60, s[12:15], s25 offen
    ds_read_b64_tr_b16 a[28:29], v63 offset:0
    ds_read_b64_tr_b16 a[30:31], v63 offset:272
    ds_read_b64_tr_b16 v[76:77], v63 offset:32
    ds_read_b64_tr_b16 v[78:79], v63 offset:304
    s_waitcnt lgkmcnt(0)
    ds_write_b128 v1, v[76:79] offset:17408
    s_waitcnt vmcnt(10)
    s_waitcnt lgkmcnt(0)
    s_barrier
    ds_write_b128 v62, v[12:15] offset:0
    ds_write_b128 v62, v[16:19] offset:4352
    s_waitcnt lgkmcnt(0)
    s_barrier
    s_add_u32 s24, s53, 4718592
    s_cmp_ge_u32 s24, 5242880
    s_cselect_b32 s25, 5242880, 0
    s_sub_u32 s24, s24, s25
    s_add_u32 s24, s24, s52
    s_add_u32 s25, s24, 131072
    buffer_load_dwordx4 v[12:15], v60, s[12:15], s24 offen
    buffer_load_dwordx4 v[16:19], v60, s[12:15], s25 offen
    ds_read_b64_tr_b16 a[64:65], v63 offset:0
    ds_read_b64_tr_b16 a[66:67], v63 offset:272
    ds_read_b64_tr_b16 v[76:77], v63 offset:32
    ds_read_b64_tr_b16 v[78:79], v63 offset:304
    s_waitcnt lgkmcnt(0)
    ds_write_b128 v1, v[76:79] offset:18432
    s_waitcnt vmcnt(10)
    s_waitcnt lgkmcnt(0)
    s_barrier
    ds_write_b128 v62, v[20:23] offset:0
    ds_write_b128 v62, v[24:27] offset:4352
    s_waitcnt lgkmcnt(0)
    s_barrier
    s_add_u32 s24, s53, 4980736
    s_cmp_ge_u32 s24, 5242880
    s_cselect_b32 s25, 5242880, 0
    s_sub_u32 s24, s24, s25
    s_add_u32 s24, s24, s52
    s_add_u32 s25, s24, 131072
    buffer_load_dwordx4 v[20:23], v60, s[12:15], s24 offen
    buffer_load_dwordx4 v[24:27], v60, s[12:15], s25 offen
    ds_read_b64_tr_b16 a[68:69], v63 offset:0
    ds_read_b64_tr_b16 a[70:71], v63 offset:272
    ds_read_b64_tr_b16 v[76:77], v63 offset:32
    ds_read_b64_tr_b16 v[78:79], v63 offset:304
    s_waitcnt lgkmcnt(0)
    ds_write_b128 v1, v[76:79] offset:19456
    s_waitcnt vmcnt(10)
    s_waitcnt lgkmcnt(0)
    s_barrier
    ds_write_b128 v62, v[28:31] offset:0
    ds_write_b128 v62, v[32:35] offset:4352
    s_waitcnt lgkmcnt(0)
    s_barrier
    s_load_dwordx2 s[56:57], s[0:1], 16
    s_waitcnt lgkmcnt(0)
    s_mov_b32 s12, s56
    s_mov_b32 s13, s57
    s_mov_b32 s14, 0x500000
    s_mov_b32 s15, 0x20000
    s_add_u32 s24, s53, 0
    s_cmp_ge_u32 s24, 5242880
    s_cselect_b32 s25, 5242880, 0
    s_sub_u32 s24, s24, s25
    s_add_u32 s24, s24, s52
    s_add_u32 s25, s24, 131072
    buffer_load_dwordx4 v[28:31], v60, s[12:15], s24 offen
    buffer_load_dwordx4 v[32:35], v60, s[12:15], s25 offen
    ds_read_b64_tr_b16 a[104:105], v63 offset:0
    ds_read_b64_tr_b16 a[106:107], v63 offset:272
    ds_read_b64_tr_b16 v[76:77], v63 offset:32
    ds_read_b64_tr_b16 v[78:79], v63 offset:304
    s_waitcnt lgkmcnt(0)
    ds_write_b128 v1, v[76:79] offset:20480
    s_waitcnt vmcnt(10)
    s_waitcnt lgkmcnt(0)
    s_barrier
    ds_write_b128 v62, v[36:39] offset:0
    ds_write_b128 v62, v[40:43] offset:4352
    s_waitcnt lgkmcnt(0)
    s_barrier
    s_add_u32 s24, s53, 262144
    s_cmp_ge_u32 s24, 5242880
    s_cselect_b32 s25, 5242880, 0
    s_sub_u32 s24, s24, s25
    s_add_u32 s24, s24, s52
    s_add_u32 s25, s24, 131072
    buffer_load_dwordx4 v[36:39], v60, s[12:15], s24 offen
    buffer_load_dwordx4 v[40:43], v60, s[12:15], s25 offen
    ds_read_b64_tr_b16 a[108:109], v63 offset:0
    ds_read_b64_tr_b16 a[110:111], v63 offset:272
    ds_read_b64_tr_b16 v[76:77], v63 offset:32
    ds_read_b64_tr_b16 v[78:79], v63 offset:304
    s_waitcnt lgkmcnt(0)
    ds_write_b128 v1, v[76:79] offset:21504
    s_waitcnt vmcnt(10)
    s_waitcnt lgkmcnt(0)
    s_barrier
    ds_write_b128 v62, v[44:47] offset:0
    ds_write_b128 v62, v[48:51] offset:4352
    s_waitcnt lgkmcnt(0)
    s_barrier
    s_add_u32 s24, s53, 524288
    s_cmp_ge_u32 s24, 5242880
    s_cselect_b32 s25, 5242880, 0
    s_sub_u32 s24, s24, s25
    s_add_u32 s24, s24, s52
    s_add_u32 s25, s24, 131072
    buffer_load_dwordx4 v[44:47], v60, s[12:15], s24 offen
    buffer_load_dwordx4 v[48:51], v60, s[12:15], s25 offen
    ds_read_b64_tr_b16 a[144:145], v63 offset:0
    ds_read_b64_tr_b16 a[146:147], v63 offset:272
    ds_read_b64_tr_b16 v[76:77], v63 offset:32
    ds_read_b64_tr_b16 v[78:79], v63 offset:304
    s_waitcnt lgkmcnt(0)
    ds_write_b128 v1, v[76:79] offset:22528
    s_waitcnt vmcnt(10)
    s_waitcnt lgkmcnt(0)
    s_barrier
    ds_write_b128 v62, v[52:55] offset:0
    ds_write_b128 v62, v[56:59] offset:4352
    s_waitcnt lgkmcnt(0)
    s_barrier
    s_add_u32 s24, s53, 786432
    s_cmp_ge_u32 s24, 5242880
    s_cselect_b32 s25, 5242880, 0
    s_sub_u32 s24, s24, s25
    s_add_u32 s24, s24, s52
    s_add_u32 s25, s24, 131072
    buffer_load_dwordx4 v[52:55], v60, s[12:15], s24 offen
    buffer_load_dwordx4 v[56:59], v60, s[12:15], s25 offen
    ds_read_b64_tr_b16 a[148:149], v63 offset:0
    ds_read_b64_tr_b16 a[150:151], v63 offset:272
    ds_read_b64_tr_b16 v[76:77], v63 offset:32
    ds_read_b64_tr_b16 v[78:79], v63 offset:304
    s_waitcnt lgkmcnt(0)
    ds_write_b128 v1, v[76:79] offset:23552
    s_waitcnt vmcnt(10)
    s_waitcnt lgkmcnt(0)
    s_barrier
    ds_write_b128 v62, v[12:15] offset:0
    ds_write_b128 v62, v[16:19] offset:4352
    s_waitcnt lgkmcnt(0)
    s_barrier
    s_add_u32 s24, s53, 1048576
    s_cmp_ge_u32 s24, 5242880
    s_cselect_b32 s25, 5242880, 0
    s_sub_u32 s24, s24, s25
    s_add_u32 s24, s24, s52
    s_add_u32 s25, s24, 131072
    buffer_load_dwordx4 v[12:15], v60, s[12:15], s24 offen
    buffer_load_dwordx4 v[16:19], v60, s[12:15], s25 offen
    ds_read_b64_tr_b16 a[184:185], v63 offset:0
    ds_read_b64_tr_b16 a[186:187], v63 offset:272
    ds_read_b64_tr_b16 v[76:77], v63 offset:32
    ds_read_b64_tr_b16 v[78:79], v63 offset:304
    s_waitcnt lgkmcnt(0)
    ds_write_b128 v1, v[76:79] offset:24576
    s_waitcnt vmcnt(10)
    s_waitcnt lgkmcnt(0)
    s_barrier
    ds_write_b128 v62, v[20:23] offset:0
    ds_write_b128 v62, v[24:27] offset:4352
    s_waitcnt lgkmcnt(0)
    s_barrier
    s_add_u32 s24, s53, 1310720
    s_cmp_ge_u32 s24, 5242880
    s_cselect_b32 s25, 5242880, 0
    s_sub_u32 s24, s24, s25
    s_add_u32 s24, s24, s52
    s_add_u32 s25, s24, 131072
    buffer_load_dwordx4 v[20:23], v60, s[12:15], s24 offen
    buffer_load_dwordx4 v[24:27], v60, s[12:15], s25 offen
    ds_read_b64_tr_b16 a[188:189], v63 offset:0
    ds_read_b64_tr_b16 a[190:191], v63 offset:272
    ds_read_b64_tr_b16 v[76:77], v63 offset:32
    ds_read_b64_tr_b16 v[78:79], v63 offset:304
    s_waitcnt lgkmcnt(0)
    ds_write_b128 v1, v[76:79] offset:25600
    s_waitcnt vmcnt(10)
    s_waitcnt lgkmcnt(0)
    s_barrier
    ds_write_b128 v62, v[28:31] offset:0
    ds_write_b128 v62, v[32:35] offset:4352
    s_waitcnt lgkmcnt(0)
    s_barrier
    s_add_u32 s24, s53, 1572864
    s_cmp_ge_u32 s24, 5242880
    s_cselect_b32 s25, 5242880, 0
    s_sub_u32 s24, s24, s25
    s_add_u32 s24, s24, s52
    s_add_u32 s25, s24, 131072
    buffer_load_dwordx4 v[28:31], v60, s[12:15], s24 offen
    buffer_load_dwordx4 v[32:35], v60, s[12:15], s25 offen
    ds_read_b64_tr_b16 v[88:89], v63 offset:0
    ds_read_b64_tr_b16 v[90:91], v63 offset:272
    ds_read_b64_tr_b16 v[96:97], v63 offset:32
    ds_read_b64_tr_b16 v[98:99], v63 offset:304
    s_waitcnt vmcnt(10)
    s_waitcnt lgkmcnt(0)
    s_barrier
    ds_write_b128 v62, v[36:39] offset:0
    ds_write_b128 v62, v[40:43] offset:4352
    s_waitcnt lgkmcnt(0)
    s_barrier
    s_add_u32 s24, s53, 1835008
    s_cmp_ge_u32 s24, 5242880
    s_cselect_b32 s25, 5242880, 0
    s_sub_u32 s24, s24, s25
    s_add_u32 s24, s24, s52
    s_add_u32 s25, s24, 131072
    buffer_load_dwordx4 v[36:39], v60, s[12:15], s24 offen
    buffer_load_dwordx4 v[40:43], v60, s[12:15], s25 offen
    ds_read_b64_tr_b16 v[92:93], v63 offset:0
    ds_read_b64_tr_b16 v[94:95], v63 offset:272
    ds_read_b64_tr_b16 v[100:101], v63 offset:32
    ds_read_b64_tr_b16 v[102:103], v63 offset:304
    s_waitcnt vmcnt(10)
    s_waitcnt lgkmcnt(0)
    s_barrier
    ds_write_b128 v62, v[44:47] offset:0
    ds_write_b128 v62, v[48:51] offset:4352
    s_waitcnt lgkmcnt(0)
    s_barrier
    s_add_u32 s24, s53, 2097152
    s_cmp_ge_u32 s24, 5242880
    s_cselect_b32 s25, 5242880, 0
    s_sub_u32 s24, s24, s25
    s_add_u32 s24, s24, s52
    s_add_u32 s25, s24, 131072
    buffer_load_dwordx4 v[44:47], v60, s[12:15], s24 offen
    buffer_load_dwordx4 v[48:51], v60, s[12:15], s25 offen
    ds_read_b64_tr_b16 v[120:121], v63 offset:0
    ds_read_b64_tr_b16 v[122:123], v63 offset:272
    ds_read_b64_tr_b16 v[128:129], v63 offset:32
    ds_read_b64_tr_b16 v[130:131], v63 offset:304
    s_waitcnt vmcnt(10)
    s_waitcnt lgkmcnt(0)
    s_barrier
    ds_write_b128 v62, v[52:55] offset:0
    ds_write_b128 v62, v[56:59] offset:4352
    s_waitcnt lgkmcnt(0)
    s_barrier
    s_add_u32 s24, s53, 2359296
    s_cmp_ge_u32 s24, 5242880
    s_cselect_b32 s25, 5242880, 0
    s_sub_u32 s24, s24, s25
    s_add_u32 s24, s24, s52
    s_add_u32 s25, s24, 131072
    buffer_load_dwordx4 v[52:55], v60, s[12:15], s24 offen
    buffer_load_dwordx4 v[56:59], v60, s[12:15], s25 offen
    ds_read_b64_tr_b16 v[124:125], v63 offset:0
    ds_read_b64_tr_b16 v[126:127], v63 offset:272
    ds_read_b64_tr_b16 v[132:133], v63 offset:32
    ds_read_b64_tr_b16 v[134:135], v63 offset:304
    s_waitcnt vmcnt(10)
    s_waitcnt lgkmcnt(0)
    s_barrier
    ds_write_b128 v62, v[12:15] offset:0
    ds_write_b128 v62, v[16:19] offset:4352
    s_waitcnt lgkmcnt(0)
    s_barrier
    s_add_u32 s24, s53, 2621440
    s_cmp_ge_u32 s24, 5242880
    s_cselect_b32 s25, 5242880, 0
    s_sub_u32 s24, s24, s25
    s_add_u32 s24, s24, s52
    s_add_u32 s25, s24, 131072
    buffer_load_dwordx4 v[12:15], v60, s[12:15], s24 offen
    buffer_load_dwordx4 v[16:19], v60, s[12:15], s25 offen
    ds_read_b64_tr_b16 v[152:153], v63 offset:0
    ds_read_b64_tr_b16 v[154:155], v63 offset:272
    ds_read_b64_tr_b16 v[160:161], v63 offset:32
    ds_read_b64_tr_b16 v[162:163], v63 offset:304
    s_waitcnt vmcnt(10)
    s_waitcnt lgkmcnt(0)
    s_barrier
    ds_write_b128 v62, v[20:23] offset:0
    ds_write_b128 v62, v[24:27] offset:4352
    s_waitcnt lgkmcnt(0)
    s_barrier
    s_add_u32 s24, s53, 2883584
    s_cmp_ge_u32 s24, 5242880
    s_cselect_b32 s25, 5242880, 0
    s_sub_u32 s24, s24, s25
    s_add_u32 s24, s24, s52
    s_add_u32 s25, s24, 131072
    buffer_load_dwordx4 v[20:23], v60, s[12:15], s24 offen
    buffer_load_dwordx4 v[24:27], v60, s[12:15], s25 offen
    ds_read_b64_tr_b16 v[156:157], v63 offset:0
    ds_read_b64_tr_b16 v[158:159], v63 offset:272
    ds_read_b64_tr_b16 v[164:165], v63 offset:32
    ds_read_b64_tr_b16 v[166:167], v63 offset:304
    s_waitcnt vmcnt(10)
    s_waitcnt lgkmcnt(0)
    s_barrier
    ds_write_b128 v62, v[28:31] offset:0
    ds_write_b128 v62, v[32:35] offset:4352
    s_waitcnt lgkmcnt(0)
    s_barrier
    s_add_u32 s24, s53, 3145728
    s_cmp_ge_u32 s24, 5242880
    s_cselect_b32 s25, 5242880, 0
    s_sub_u32 s24, s24, s25
    s_add_u32 s24, s24, s52
    s_add_u32 s25, s24, 131072
    buffer_load_dwordx4 v[28:31], v60, s[12:15], s24 offen
    buffer_load_dwordx4 v[32:35], v60, s[12:15], s25 offen
    ds_read_b64_tr_b16 v[184:185], v63 offset:0
    ds_read_b64_tr_b16 v[186:187], v63 offset:272
    ds_read_b64_tr_b16 v[192:193], v63 offset:32
    ds_read_b64_tr_b16 v[194:195], v63 offset:304
    s_waitcnt vmcnt(10)
    s_waitcnt lgkmcnt(0)
    s_barrier
    ds_write_b128 v62, v[36:39] offset:0
    ds_write_b128 v62, v[40:43] offset:4352
    s_waitcnt lgkmcnt(0)
    s_barrier
    s_add_u32 s24, s53, 3407872
    s_cmp_ge_u32 s24, 5242880
    s_cselect_b32 s25, 5242880, 0
    s_sub_u32 s24, s24, s25
    s_add_u32 s24, s24, s52
    s_add_u32 s25, s24, 131072
    buffer_load_dwordx4 v[36:39], v60, s[12:15], s24 offen
    buffer_load_dwordx4 v[40:43], v60, s[12:15], s25 offen
    ds_read_b64_tr_b16 v[188:189], v63 offset:0
    ds_read_b64_tr_b16 v[190:191], v63 offset:272
    ds_read_b64_tr_b16 v[196:197], v63 offset:32
    ds_read_b64_tr_b16 v[198:199], v63 offset:304
    s_waitcnt vmcnt(10)
    s_waitcnt lgkmcnt(0)
    s_barrier
    ds_write_b128 v62, v[44:47] offset:0
    ds_write_b128 v62, v[48:51] offset:4352
    s_waitcnt lgkmcnt(0)
    s_barrier
    s_add_u32 s24, s53, 3670016
    s_cmp_ge_u32 s24, 5242880
    s_cselect_b32 s25, 5242880, 0
    s_sub_u32 s24, s24, s25
    s_add_u32 s24, s24, s52
    s_add_u32 s25, s24, 131072
    buffer_load_dwordx4 v[44:47], v60, s[12:15], s24 offen
    buffer_load_dwordx4 v[48:51], v60, s[12:15], s25 offen
    ds_read_b64_tr_b16 v[224:225], v63 offset:0
    ds_read_b64_tr_b16 v[226:227], v63 offset:272
    ds_read_b64_tr_b16 v[232:233], v63 offset:32
    ds_read_b64_tr_b16 v[234:235], v63 offset:304
    s_waitcnt vmcnt(10)
    s_waitcnt lgkmcnt(0)
    s_barrier
    ds_write_b128 v62, v[52:55] offset:0
    ds_write_b128 v62, v[56:59] offset:4352
    s_waitcnt lgkmcnt(0)
    s_barrier
    s_add_u32 s24, s53, 3932160
    s_cmp_ge_u32 s24, 5242880
    s_cselect_b32 s25, 5242880, 0
    s_sub_u32 s24, s24, s25
    s_add_u32 s24, s24, s52
    s_add_u32 s25, s24, 131072
    buffer_load_dwordx4 v[52:55], v60, s[12:15], s24 offen
    buffer_load_dwordx4 v[56:59], v60, s[12:15], s25 offen
    ds_read_b64_tr_b16 v[228:229], v63 offset:0
    ds_read_b64_tr_b16 v[230:231], v63 offset:272
    ds_read_b64_tr_b16 v[236:237], v63 offset:32
    ds_read_b64_tr_b16 v[238:239], v63 offset:304
    s_waitcnt vmcnt(10)
    s_waitcnt lgkmcnt(0)
    s_barrier
    ds_write_b128 v62, v[12:15] offset:0
    ds_write_b128 v62, v[16:19] offset:4352
    s_waitcnt lgkmcnt(0)
    s_barrier
    s_add_u32 s24, s53, 4194304
    s_cmp_ge_u32 s24, 5242880
    s_cselect_b32 s25, 5242880, 0
    s_sub_u32 s24, s24, s25
    s_add_u32 s24, s24, s52
    s_add_u32 s25, s24, 131072
    buffer_load_dwordx4 v[12:15], v60, s[12:15], s24 offen
    buffer_load_dwordx4 v[16:19], v60, s[12:15], s25 offen
    ds_read_b64_tr_b16 a[8:9], v63 offset:0
    ds_read_b64_tr_b16 a[10:11], v63 offset:272
    ds_read_b64_tr_b16 a[16:17], v63 offset:32
    ds_read_b64_tr_b16 a[18:19], v63 offset:304
    s_waitcnt vmcnt(10)
    s_waitcnt lgkmcnt(0)
    s_barrier
    ds_write_b128 v62, v[20:23] offset:0
    ds_write_b128 v62, v[24:27] offset:4352
    s_waitcnt lgkmcnt(0)
    s_barrier
    s_add_u32 s24, s53, 4456448
    s_cmp_ge_u32 s24, 5242880
    s_cselect_b32 s25, 5242880, 0
    s_sub_u32 s24, s24, s25
    s_add_u32 s24, s24, s52
    s_add_u32 s25, s24, 131072
    buffer_load_dwordx4 v[20:23], v60, s[12:15], s24 offen
    buffer_load_dwordx4 v[24:27], v60, s[12:15], s25 offen
    ds_read_b64_tr_b16 a[12:13], v63 offset:0
    ds_read_b64_tr_b16 a[14:15], v63 offset:272
    ds_read_b64_tr_b16 a[20:21], v63 offset:32
    ds_read_b64_tr_b16 a[22:23], v63 offset:304
    s_waitcnt vmcnt(10)
    s_waitcnt lgkmcnt(0)
    s_barrier
    ds_write_b128 v62, v[28:31] offset:0
    ds_write_b128 v62, v[32:35] offset:4352
    s_waitcnt lgkmcnt(0)
    s_barrier
    s_add_u32 s24, s53, 4718592
    s_cmp_ge_u32 s24, 5242880
    s_cselect_b32 s25, 5242880, 0
    s_sub_u32 s24, s24, s25
    s_add_u32 s24, s24, s52
    s_add_u32 s25, s24, 131072
    buffer_load_dwordx4 v[28:31], v60, s[12:15], s24 offen
    buffer_load_dwordx4 v[32:35], v60, s[12:15], s25 offen
    ds_read_b64_tr_b16 a[48:49], v63 offset:0
    ds_read_b64_tr_b16 a[50:51], v63 offset:272
    ds_read_b64_tr_b16 a[56:57], v63 offset:32
    ds_read_b64_tr_b16 a[58:59], v63 offset:304
    s_waitcnt vmcnt(10)
    s_waitcnt lgkmcnt(0)
    s_barrier
    ds_write_b128 v62, v[36:39] offset:0
    ds_write_b128 v62, v[40:43] offset:4352
    s_waitcnt lgkmcnt(0)
    s_barrier
    s_add_u32 s24, s53, 4980736
    s_cmp_ge_u32 s24, 5242880
    s_cselect_b32 s25, 5242880, 0
    s_sub_u32 s24, s24, s25
    s_add_u32 s24, s24, s52
    s_add_u32 s25, s24, 131072
    buffer_load_dwordx4 v[36:39], v60, s[12:15], s24 offen
    buffer_load_dwordx4 v[40:43], v60, s[12:15], s25 offen
    ds_read_b64_tr_b16 a[52:53], v63 offset:0
    ds_read_b64_tr_b16 a[54:55], v63 offset:272
    ds_read_b64_tr_b16 a[60:61], v63 offset:32
    ds_read_b64_tr_b16 a[62:63], v63 offset:304
    s_waitcnt vmcnt(10)
    s_waitcnt lgkmcnt(0)
    s_barrier
    ds_write_b128 v62, v[44:47] offset:0
    ds_write_b128 v62, v[48:51] offset:4352
    s_waitcnt lgkmcnt(0)
    s_barrier
    s_load_dwordx2 s[56:57], s[0:1], 32
    s_waitcnt lgkmcnt(0)
    s_mov_b32 s12, s56
    s_mov_b32 s13, s57
    s_mov_b32 s14, 0x500000
    s_mov_b32 s15, 0x20000
    s_add_u32 s24, s53, 0
    s_cmp_ge_u32 s24, 5242880
    s_cselect_b32 s25, 5242880, 0
    s_sub_u32 s24, s24, s25
    s_add_u32 s24, s24, s52
    s_add_u32 s25, s24, 131072
    buffer_load_dwordx4 v[44:47], v60, s[12:15], s24 offen
    buffer_load_dwordx4 v[48:51], v60, s[12:15], s25 offen
    ds_read_b64_tr_b16 a[88:89], v63 offset:0
    ds_read_b64_tr_b16 a[90:91], v63 offset:272
    ds_read_b64_tr_b16 a[96:97], v63 offset:32
    ds_read_b64_tr_b16 a[98:99], v63 offset:304
    s_waitcnt vmcnt(10)
    s_waitcnt lgkmcnt(0)
    s_barrier
    ds_write_b128 v62, v[52:55] offset:0
    ds_write_b128 v62, v[56:59] offset:4352
    s_waitcnt lgkmcnt(0)
    s_barrier
    s_add_u32 s24, s53, 262144
    s_cmp_ge_u32 s24, 5242880
    s_cselect_b32 s25, 5242880, 0
    s_sub_u32 s24, s24, s25
    s_add_u32 s24, s24, s52
    s_add_u32 s25, s24, 131072
    buffer_load_dwordx4 v[52:55], v60, s[12:15], s24 offen
    buffer_load_dwordx4 v[56:59], v60, s[12:15], s25 offen
    ds_read_b64_tr_b16 a[92:93], v63 offset:0
    ds_read_b64_tr_b16 a[94:95], v63 offset:272
    ds_read_b64_tr_b16 a[100:101], v63 offset:32
    ds_read_b64_tr_b16 a[102:103], v63 offset:304
    s_waitcnt vmcnt(10)
    s_waitcnt lgkmcnt(0)
    s_barrier
    v_mov_b32 v72, 0
    global_load_dword v71, v72, s[4:5] offset:44 sc1
    ds_write_b128 v62, v[12:15] offset:0
    ds_write_b128 v62, v[16:19] offset:4352
    s_waitcnt lgkmcnt(0)
    s_barrier
    s_add_u32 s24, s53, 524288
    s_cmp_ge_u32 s24, 5242880
    s_cselect_b32 s25, 5242880, 0
    s_sub_u32 s24, s24, s25
    s_add_u32 s24, s24, s52
    s_add_u32 s25, s24, 131072
    buffer_load_dwordx4 v[12:15], v60, s[12:15], s24 offen
    buffer_load_dwordx4 v[16:19], v60, s[12:15], s25 offen
    ds_read_b64_tr_b16 a[128:129], v63 offset:0
    ds_read_b64_tr_b16 a[130:131], v63 offset:272
    ds_read_b64_tr_b16 a[136:137], v63 offset:32
    ds_read_b64_tr_b16 a[138:139], v63 offset:304
    s_waitcnt vmcnt(10)
    s_waitcnt lgkmcnt(0)
    s_barrier
    ds_write_b128 v62, v[20:23] offset:0
    ds_write_b128 v62, v[24:27] offset:4352
    s_waitcnt lgkmcnt(0)
    s_barrier
    s_add_u32 s24, s53, 786432
    s_cmp_ge_u32 s24, 5242880
    s_cselect_b32 s25, 5242880, 0
    s_sub_u32 s24, s24, s25
    s_add_u32 s24, s24, s52
    s_add_u32 s25, s24, 131072
    buffer_load_dwordx4 v[20:23], v60, s[12:15], s24 offen
    buffer_load_dwordx4 v[24:27], v60, s[12:15], s25 offen
    ds_read_b64_tr_b16 a[132:133], v63 offset:0
    ds_read_b64_tr_b16 a[134:135], v63 offset:272
    ds_read_b64_tr_b16 a[140:141], v63 offset:32
    ds_read_b64_tr_b16 a[142:143], v63 offset:304
    s_waitcnt vmcnt(10)
    s_waitcnt lgkmcnt(0)
    s_barrier
    ds_write_b128 v62, v[28:31] offset:0
    ds_write_b128 v62, v[32:35] offset:4352
    s_waitcnt lgkmcnt(0)
    s_barrier
    s_add_u32 s24, s53, 1048576
    s_cmp_ge_u32 s24, 5242880
    s_cselect_b32 s25, 5242880, 0
    s_sub_u32 s24, s24, s25
    s_add_u32 s24, s24, s52
    s_add_u32 s25, s24, 131072
    buffer_load_dwordx4 v[28:31], v60, s[12:15], s24 offen
    buffer_load_dwordx4 v[32:35], v60, s[12:15], s25 offen
    ds_read_b64_tr_b16 a[168:169], v63 offset:0
    ds_read_b64_tr_b16 a[170:171], v63 offset:272
    ds_read_b64_tr_b16 a[176:177], v63 offset:32
    ds_read_b64_tr_b16 a[178:179], v63 offset:304
    s_waitcnt vmcnt(10)
    s_waitcnt lgkmcnt(0)
    s_barrier
    ds_write_b128 v62, v[36:39] offset:0
    ds_write_b128 v62, v[40:43] offset:4352
    s_waitcnt lgkmcnt(0)
    s_barrier
    s_add_u32 s24, s53, 1310720
    s_cmp_ge_u32 s24, 5242880
    s_cselect_b32 s25, 5242880, 0
    s_sub_u32 s24, s24, s25
    s_add_u32 s24, s24, s52
    s_add_u32 s25, s24, 131072
    buffer_load_dwordx4 v[36:39], v60, s[12:15], s24 offen
    buffer_load_dwordx4 v[40:43], v60, s[12:15], s25 offen
    ds_read_b64_tr_b16 a[172:173], v63 offset:0
    ds_read_b64_tr_b16 a[174:175], v63 offset:272
    ds_read_b64_tr_b16 a[180:181], v63 offset:32
    ds_read_b64_tr_b16 a[182:183], v63 offset:304
    s_waitcnt vmcnt(10)
    s_waitcnt lgkmcnt(0)
    s_barrier
    ds_write_b128 v62, v[44:47] offset:0
    ds_write_b128 v62, v[48:51] offset:4352
    s_waitcnt lgkmcnt(0)
    s_barrier
    s_add_u32 s24, s53, 1572864
    s_cmp_ge_u32 s24, 5242880
    s_cselect_b32 s25, 5242880, 0
    s_sub_u32 s24, s24, s25
    s_add_u32 s24, s24, s52
    s_add_u32 s25, s24, 131072
    buffer_load_dwordx4 v[44:47], v60, s[12:15], s24 offen
    buffer_load_dwordx4 v[48:51], v60, s[12:15], s25 offen
    ds_read_b64_tr_b16 v[112:113], v63 offset:0
    ds_read_b64_tr_b16 v[114:115], v63 offset:272
    ds_read_b64_tr_b16 v[76:77], v63 offset:32
    ds_read_b64_tr_b16 v[78:79], v63 offset:304
    s_waitcnt lgkmcnt(0)
    ds_write_b128 v1, v[76:79] offset:2048
    s_waitcnt vmcnt(10)
    s_waitcnt lgkmcnt(0)
    s_barrier
    ds_write_b128 v62, v[52:55] offset:0
    ds_write_b128 v62, v[56:59] offset:4352
    s_waitcnt lgkmcnt(0)
    s_barrier
    s_add_u32 s24, s53, 1835008
    s_cmp_ge_u32 s24, 5242880
    s_cselect_b32 s25, 5242880, 0
    s_sub_u32 s24, s24, s25
    s_add_u32 s24, s24, s52
    s_add_u32 s25, s24, 131072
    buffer_load_dwordx4 v[52:55], v60, s[12:15], s24 offen
    buffer_load_dwordx4 v[56:59], v60, s[12:15], s25 offen
    ds_read_b64_tr_b16 v[116:117], v63 offset:0
    ds_read_b64_tr_b16 v[118:119], v63 offset:272
    ds_read_b64_tr_b16 v[76:77], v63 offset:32
    ds_read_b64_tr_b16 v[78:79], v63 offset:304
    s_waitcnt lgkmcnt(0)
    ds_write_b128 v1, v[76:79] offset:3072
    s_waitcnt vmcnt(10)
    s_waitcnt lgkmcnt(0)
    s_barrier
    ds_write_b128 v62, v[12:15] offset:0
    ds_write_b128 v62, v[16:19] offset:4352
    s_waitcnt lgkmcnt(0)
    s_barrier
    s_add_u32 s24, s53, 2097152
    s_cmp_ge_u32 s24, 5242880
    s_cselect_b32 s25, 5242880, 0
    s_sub_u32 s24, s24, s25
    s_add_u32 s24, s24, s52
    s_add_u32 s25, s24, 131072
    buffer_load_dwordx4 v[12:15], v60, s[12:15], s24 offen
    buffer_load_dwordx4 v[16:19], v60, s[12:15], s25 offen
    ds_read_b64_tr_b16 v[144:145], v63 offset:0
    ds_read_b64_tr_b16 v[146:147], v63 offset:272
    ds_read_b64_tr_b16 v[76:77], v63 offset:32
    ds_read_b64_tr_b16 v[78:79], v63 offset:304
    s_waitcnt lgkmcnt(0)
    ds_write_b128 v1, v[76:79] offset:6144
    s_waitcnt vmcnt(10)
    s_waitcnt lgkmcnt(0)
    s_barrier
    ds_write_b128 v62, v[20:23] offset:0
    ds_write_b128 v62, v[24:27] offset:4352
    s_waitcnt lgkmcnt(0)
    s_barrier
    s_add_u32 s24, s53, 2359296
    s_cmp_ge_u32 s24, 5242880
    s_cselect_b32 s25, 5242880, 0
    s_sub_u32 s24, s24, s25
    s_add_u32 s24, s24, s52
    s_add_u32 s25, s24, 131072
    buffer_load_dwordx4 v[20:23], v60, s[12:15], s24 offen
    buffer_load_dwordx4 v[24:27], v60, s[12:15], s25 offen
    ds_read_b64_tr_b16 v[148:149], v63 offset:0
    ds_read_b64_tr_b16 v[150:151], v63 offset:272
    ds_read_b64_tr_b16 v[76:77], v63 offset:32
    ds_read_b64_tr_b16 v[78:79], v63 offset:304
    s_waitcnt lgkmcnt(0)
    ds_write_b128 v1, v[76:79] offset:7168
    s_waitcnt vmcnt(10)
    s_waitcnt lgkmcnt(0)
    s_barrier
    ds_write_b128 v62, v[28:31] offset:0
    ds_write_b128 v62, v[32:35] offset:4352
    s_waitcnt lgkmcnt(0)
    s_barrier
    s_add_u32 s24, s53, 2621440
    s_cmp_ge_u32 s24, 5242880
    s_cselect_b32 s25, 5242880, 0
    s_sub_u32 s24, s24, s25
    s_add_u32 s24, s24, s52
    s_add_u32 s25, s24, 131072
    buffer_load_dwordx4 v[28:31], v60, s[12:15], s24 offen
    buffer_load_dwordx4 v[32:35], v60, s[12:15], s25 offen
    ds_read_b64_tr_b16 v[176:177], v63 offset:0
    ds_read_b64_tr_b16 v[178:179], v63 offset:272
    ds_read_b64_tr_b16 v[76:77], v63 offset:32
    ds_read_b64_tr_b16 v[78:79], v63 offset:304
    s_waitcnt lgkmcnt(0)
    ds_write_b128 v1, v[76:79] offset:10240
    s_waitcnt vmcnt(10)
    s_waitcnt lgkmcnt(0)
    s_barrier
    ds_write_b128 v62, v[36:39] offset:0
    ds_write_b128 v62, v[40:43] offset:4352
    s_waitcnt lgkmcnt(0)
    s_barrier
    s_add_u32 s24, s53, 2883584
    s_cmp_ge_u32 s24, 5242880
    s_cselect_b32 s25, 5242880, 0
    s_sub_u32 s24, s24, s25
    s_add_u32 s24, s24, s52
    s_add_u32 s25, s24, 131072
    buffer_load_dwordx4 v[36:39], v60, s[12:15], s24 offen
    buffer_load_dwordx4 v[40:43], v60, s[12:15], s25 offen
    ds_read_b64_tr_b16 v[180:181], v63 offset:0
    ds_read_b64_tr_b16 v[182:183], v63 offset:272
    ds_read_b64_tr_b16 v[76:77], v63 offset:32
    ds_read_b64_tr_b16 v[78:79], v63 offset:304
    s_waitcnt lgkmcnt(0)
    ds_write_b128 v1, v[76:79] offset:11264
    s_waitcnt vmcnt(10)
    s_waitcnt lgkmcnt(0)
    s_barrier
    ds_write_b128 v62, v[44:47] offset:0
    ds_write_b128 v62, v[48:51] offset:4352
    s_waitcnt lgkmcnt(0)
    s_barrier
    s_add_u32 s24, s53, 3145728
    s_cmp_ge_u32 s24, 5242880
    s_cselect_b32 s25, 5242880, 0
    s_sub_u32 s24, s24, s25
    s_add_u32 s24, s24, s52
    s_add_u32 s25, s24, 131072
    buffer_load_dwordx4 v[44:47], v60, s[12:15], s24 offen
    buffer_load_dwordx4 v[48:51], v60, s[12:15], s25 offen
    ds_read_b64_tr_b16 v[216:217], v63 offset:0
    ds_read_b64_tr_b16 v[218:219], v63 offset:272
    ds_read_b64_tr_b16 v[208:209], v63 offset:32
    ds_read_b64_tr_b16 v[210:211], v63 offset:304
    s_waitcnt vmcnt(10)
    s_waitcnt lgkmcnt(0)
    s_barrier
    ds_write_b128 v62, v[52:55] offset:0
    ds_write_b128 v62, v[56:59] offset:4352
    s_waitcnt lgkmcnt(0)
    s_barrier
    s_add_u32 s24, s53, 3407872
    s_cmp_ge_u32 s24, 5242880
    s_cselect_b32 s25, 5242880, 0
    s_sub_u32 s24, s24, s25
    s_add_u32 s24, s24, s52
    s_add_u32 s25, s24, 131072
    buffer_load_dwordx4 v[52:55], v60, s[12:15], s24 offen
    buffer_load_dwordx4 v[56:59], v60, s[12:15], s25 offen
    ds_read_b64_tr_b16 v[220:221], v63 offset:0
    ds_read_b64_tr_b16 v[222:223], v63 offset:272
    ds_read_b64_tr_b16 v[212:213], v63 offset:32
    ds_read_b64_tr_b16 v[214:215], v63 offset:304
    s_waitcnt vmcnt(10)
    s_waitcnt lgkmcnt(0)
    s_barrier
    ds_write_b128 v62, v[12:15] offset:0
    ds_write_b128 v62, v[16:19] offset:4352
    s_waitcnt lgkmcnt(0)
    s_barrier
    s_add_u32 s24, s53, 3670016
    s_cmp_ge_u32 s24, 5242880
    s_cselect_b32 s25, 5242880, 0
    s_sub_u32 s24, s24, s25
    s_add_u32 s24, s24, s52
    s_add_u32 s25, s24, 131072
    buffer_load_dwordx4 v[12:15], v60, s[12:15], s24 offen
    buffer_load_dwordx4 v[16:19], v60, s[12:15], s25 offen
    ds_read_b64_tr_b16 a[0:1], v63 offset:0
    ds_read_b64_tr_b16 a[2:3], v63 offset:272
    ds_read_b64_tr_b16 v[248:249], v63 offset:32
    ds_read_b64_tr_b16 v[250:251], v63 offset:304
    s_waitcnt vmcnt(10)
    s_waitcnt lgkmcnt(0)
    s_barrier
    ds_write_b128 v62, v[20:23] offset:0
    ds_write_b128 v62, v[24:27] offset:4352
    s_waitcnt lgkmcnt(0)
    s_barrier
    s_add_u32 s24, s53, 3932160
    s_cmp_ge_u32 s24, 5242880
    s_cselect_b32 s25, 5242880, 0
    s_sub_u32 s24, s24, s25
    s_add_u32 s24, s24, s52
    s_add_u32 s25, s24, 131072
    buffer_load_dwordx4 v[20:23], v60, s[12:15], s24 offen
    buffer_load_dwordx4 v[24:27], v60, s[12:15], s25 offen
    ds_read_b64_tr_b16 a[4:5], v63 offset:0
    ds_read_b64_tr_b16 a[6:7], v63 offset:272
    ds_read_b64_tr_b16 v[252:253], v63 offset:32
    ds_read_b64_tr_b16 v[254:255], v63 offset:304
    s_waitcnt vmcnt(10)
    s_waitcnt lgkmcnt(0)
    s_barrier
    ds_write_b128 v62, v[28:31] offset:0
    ds_write_b128 v62, v[32:35] offset:4352
    s_waitcnt lgkmcnt(0)
    s_barrier
    s_add_u32 s24, s53, 4194304
    s_cmp_ge_u32 s24, 5242880
    s_cselect_b32 s25, 5242880, 0
    s_sub_u32 s24, s24, s25
    s_add_u32 s24, s24, s52
    s_add_u32 s25, s24, 131072
    buffer_load_dwordx4 v[28:31], v60, s[12:15], s24 offen
    buffer_load_dwordx4 v[32:35], v60, s[12:15], s25 offen
    ds_read_b64_tr_b16 a[32:33], v63 offset:0
    ds_read_b64_tr_b16 a[34:35], v63 offset:272
    ds_read_b64_tr_b16 a[40:41], v63 offset:32
    ds_read_b64_tr_b16 a[42:43], v63 offset:304
    s_waitcnt vmcnt(10)
    s_waitcnt lgkmcnt(0)
    s_barrier
    ds_write_b128 v62, v[36:39] offset:0
    ds_write_b128 v62, v[40:43] offset:4352
    s_waitcnt lgkmcnt(0)
    s_barrier
    s_add_u32 s24, s53, 4456448
    s_cmp_ge_u32 s24, 5242880
    s_cselect_b32 s25, 5242880, 0
    s_sub_u32 s24, s24, s25
    s_add_u32 s24, s24, s52
    s_add_u32 s25, s24, 131072
    buffer_load_dwordx4 v[36:39], v60, s[12:15], s24 offen
    buffer_load_dwordx4 v[40:43], v60, s[12:15], s25 offen
    ds_read_b64_tr_b16 a[36:37], v63 offset:0
    ds_read_b64_tr_b16 a[38:39], v63 offset:272
    ds_read_b64_tr_b16 a[44:45], v63 offset:32
    ds_read_b64_tr_b16 a[46:47], v63 offset:304
    s_waitcnt vmcnt(10)
    s_waitcnt lgkmcnt(0)
    s_barrier
    ds_write_b128 v62, v[44:47] offset:0
    ds_write_b128 v62, v[48:51] offset:4352
    s_waitcnt lgkmcnt(0)
    s_barrier
    s_add_u32 s24, s53, 4718592
    s_cmp_ge_u32 s24, 5242880
    s_cselect_b32 s25, 5242880, 0
    s_sub_u32 s24, s24, s25
    s_add_u32 s24, s24, s52
    s_add_u32 s25, s24, 131072
    buffer_load_dwordx4 v[44:47], v60, s[12:15], s24 offen
    buffer_load_dwordx4 v[48:51], v60, s[12:15], s25 offen
    ds_read_b64_tr_b16 a[72:73], v63 offset:0
    ds_read_b64_tr_b16 a[74:75], v63 offset:272
    ds_read_b64_tr_b16 a[80:81], v63 offset:32
    ds_read_b64_tr_b16 a[82:83], v63 offset:304
    s_waitcnt vmcnt(10)
    s_waitcnt lgkmcnt(0)
    s_barrier
    ds_write_b128 v62, v[52:55] offset:0
    ds_write_b128 v62, v[56:59] offset:4352
    s_waitcnt lgkmcnt(0)
    s_barrier
    s_add_u32 s24, s53, 4980736
    s_cmp_ge_u32 s24, 5242880
    s_cselect_b32 s25, 5242880, 0
    s_sub_u32 s24, s24, s25
    s_add_u32 s24, s24, s52
    s_add_u32 s25, s24, 131072
    buffer_load_dwordx4 v[52:55], v60, s[12:15], s24 offen
    buffer_load_dwordx4 v[56:59], v60, s[12:15], s25 offen
    ds_read_b64_tr_b16 a[76:77], v63 offset:0
    ds_read_b64_tr_b16 a[78:79], v63 offset:272
    ds_read_b64_tr_b16 a[84:85], v63 offset:32
    ds_read_b64_tr_b16 a[86:87], v63 offset:304
    s_waitcnt vmcnt(10)
    s_waitcnt lgkmcnt(0)
    s_barrier
    ds_write_b128 v62, v[12:15] offset:0
    ds_write_b128 v62, v[16:19] offset:4352
    s_waitcnt lgkmcnt(0)
    s_barrier
    s_load_dwordx2 s[56:57], s[0:1], 40
    s_waitcnt lgkmcnt(0)
    s_mov_b32 s12, s56
    s_mov_b32 s13, s57
    s_mov_b32 s14, 0x500000
    s_mov_b32 s15, 0x20000
    s_add_u32 s24, s54, 0
    s_add_u32 s25, s24, 20480
    buffer_load_dwordx4 v[12:15], v61, s[12:15], s24 offen
    buffer_load_dwordx4 v[16:19], v61, s[12:15], s25 offen
    ds_read_b64_tr_b16 a[112:113], v63 offset:0
    ds_read_b64_tr_b16 a[114:115], v63 offset:272
    ds_read_b64_tr_b16 a[120:121], v63 offset:32
    ds_read_b64_tr_b16 a[122:123], v63 offset:304
    s_waitcnt vmcnt(10)
    s_waitcnt lgkmcnt(0)
    s_barrier
    ds_write_b128 v62, v[20:23] offset:0
    ds_write_b128 v62, v[24:27] offset:4352
    s_waitcnt lgkmcnt(0)
    s_barrier
    s_add_u32 s24, s54, 40960
    s_add_u32 s25, s24, 20480
    buffer_load_dwordx4 v[20:23], v61, s[12:15], s24 offen
    buffer_load_dwordx4 v[24:27], v61, s[12:15], s25 offen
    ds_read_b64_tr_b16 a[116:117], v63 offset:0
    ds_read_b64_tr_b16 a[118:119], v63 offset:272
    ds_read_b64_tr_b16 a[124:125], v63 offset:32
    ds_read_b64_tr_b16 a[126:127], v63 offset:304
    s_waitcnt vmcnt(10)
    s_waitcnt lgkmcnt(0)
    s_barrier
    ds_write_b128 v62, v[28:31] offset:0
    ds_write_b128 v62, v[32:35] offset:4352
    s_waitcnt lgkmcnt(0)
    s_barrier
    s_add_u32 s24, s54, 81920
    s_add_u32 s25, s24, 20480
    buffer_load_dwordx4 v[28:31], v61, s[12:15], s24 offen
    buffer_load_dwordx4 v[32:35], v61, s[12:15], s25 offen
    ds_read_b64_tr_b16 a[152:153], v63 offset:0
    ds_read_b64_tr_b16 a[154:155], v63 offset:272
    ds_read_b64_tr_b16 a[160:161], v63 offset:32
    ds_read_b64_tr_b16 a[162:163], v63 offset:304
    s_waitcnt vmcnt(10)
    s_waitcnt lgkmcnt(0)
    s_barrier
    ds_write_b128 v62, v[36:39] offset:0
    ds_write_b128 v62, v[40:43] offset:4352
    s_waitcnt lgkmcnt(0)
    s_barrier
    s_add_u32 s24, s54, 122880
    s_add_u32 s25, s24, 20480
    buffer_load_dwordx4 v[36:39], v61, s[12:15], s24 offen
    buffer_load_dwordx4 v[40:43], v61, s[12:15], s25 offen
    ds_read_b64_tr_b16 a[156:157], v63 offset:0
    ds_read_b64_tr_b16 a[158:159], v63 offset:272
    ds_read_b64_tr_b16 a[164:165], v63 offset:32
    ds_read_b64_tr_b16 a[166:167], v63 offset:304
    s_waitcnt vmcnt(10)
    s_waitcnt lgkmcnt(0)
    s_barrier
    ds_write_b128 v62, v[44:47] offset:0
    ds_write_b128 v62, v[48:51] offset:4352
    s_waitcnt lgkmcnt(0)
    s_barrier
    s_add_u32 s24, s54, 64
    s_add_u32 s25, s24, 20480
    buffer_load_dwordx4 v[44:47], v61, s[12:15], s24 offen
    buffer_load_dwordx4 v[48:51], v61, s[12:15], s25 offen
    ds_read_b64_tr_b16 a[192:193], v63 offset:0
    ds_read_b64_tr_b16 a[194:195], v63 offset:272
    ds_read_b64_tr_b16 a[200:201], v63 offset:32
    ds_read_b64_tr_b16 a[202:203], v63 offset:304
    s_waitcnt vmcnt(10)
    s_waitcnt lgkmcnt(0)
    s_barrier
    ds_write_b128 v62, v[52:55] offset:0
    ds_write_b128 v62, v[56:59] offset:4352
    s_waitcnt lgkmcnt(0)
    s_barrier
    s_add_u32 s24, s54, 41024
    s_add_u32 s25, s24, 20480
    buffer_load_dwordx4 v[52:55], v61, s[12:15], s24 offen
    buffer_load_dwordx4 v[56:59], v61, s[12:15], s25 offen
    ds_read_b64_tr_b16 a[196:197], v63 offset:0
    ds_read_b64_tr_b16 a[198:199], v63 offset:272
    ds_read_b64_tr_b16 a[204:205], v63 offset:32
    ds_read_b64_tr_b16 a[206:207], v63 offset:304
    s_waitcnt vmcnt(10)
    s_waitcnt lgkmcnt(0)
    s_barrier
    ds_write_b128 v62, v[12:15] offset:0
    ds_write_b128 v62, v[16:19] offset:4352
    s_waitcnt lgkmcnt(0)
    s_barrier
    s_add_u32 s24, s54, 81984
    s_add_u32 s25, s24, 20480
    buffer_load_dwordx4 v[12:15], v61, s[12:15], s24 offen
    buffer_load_dwordx4 v[16:19], v61, s[12:15], s25 offen
    ds_read_b64_tr_b16 a[208:209], v64 offset:0
    ds_read_b64_tr_b16 a[210:211], v64 offset:544
    ds_read_b64_tr_b16 v[76:77], v64 offset:32
    ds_read_b64_tr_b16 v[78:79], v64 offset:576
    s_waitcnt lgkmcnt(0)
    ds_write_b128 v1, v[76:79] offset:26624
    s_waitcnt vmcnt(10)
    s_waitcnt lgkmcnt(0)
    s_barrier
    ds_write_b128 v62, v[20:23] offset:0
    ds_write_b128 v62, v[24:27] offset:4352
    s_waitcnt lgkmcnt(0)
    s_barrier
    s_add_u32 s24, s54, 122944
    s_add_u32 s25, s24, 20480
    buffer_load_dwordx4 v[20:23], v61, s[12:15], s24 offen
    buffer_load_dwordx4 v[24:27], v61, s[12:15], s25 offen
    ds_read_b64_tr_b16 a[212:213], v64 offset:0
    ds_read_b64_tr_b16 a[214:215], v64 offset:544
    ds_read_b64_tr_b16 v[76:77], v64 offset:32
    ds_read_b64_tr_b16 v[78:79], v64 offset:576
    s_waitcnt lgkmcnt(0)
    ds_write_b128 v1, v[76:79] offset:27648
    s_waitcnt vmcnt(10)
    s_waitcnt lgkmcnt(0)
    s_barrier
    ds_write_b128 v62, v[28:31] offset:0
    ds_write_b128 v62, v[32:35] offset:4352
    s_waitcnt lgkmcnt(0)
    s_barrier
    s_add_u32 s24, s54, 128
    s_add_u32 s25, s24, 20480
    buffer_load_dwordx4 v[28:31], v65, s[12:15], s24 offen
    buffer_load_dwordx4 v[32:35], v65, s[12:15], s25 offen
    ds_read_b64_tr_b16 a[216:217], v64 offset:0
    ds_read_b64_tr_b16 a[218:219], v64 offset:544
    ds_read_b64_tr_b16 v[76:77], v64 offset:32
    ds_read_b64_tr_b16 v[78:79], v64 offset:576
    s_waitcnt lgkmcnt(0)
    ds_write_b128 v1, v[76:79] offset:28672
    s_waitcnt vmcnt(10)
    s_waitcnt lgkmcnt(0)
    s_barrier
    ds_write_b128 v62, v[36:39] offset:0
    ds_write_b128 v62, v[40:43] offset:4352
    s_waitcnt lgkmcnt(0)
    s_barrier
    s_add_u32 s24, s54, 41088
    s_add_u32 s25, s24, 20480
    buffer_load_dwordx4 v[36:39], v65, s[12:15], s24 offen
    buffer_load_dwordx4 v[40:43], v65, s[12:15], s25 offen
    ds_read_b64_tr_b16 a[220:221], v64 offset:0
    ds_read_b64_tr_b16 a[222:223], v64 offset:544
    ds_read_b64_tr_b16 v[76:77], v64 offset:32
    ds_read_b64_tr_b16 v[78:79], v64 offset:576
    s_waitcnt lgkmcnt(0)
    ds_write_b128 v1, v[76:79] offset:29696
    s_waitcnt vmcnt(10)
    s_waitcnt lgkmcnt(0)
    s_barrier
    ds_write_b128 v62, v[44:47] offset:0
    ds_write_b128 v62, v[48:51] offset:4352
    s_waitcnt lgkmcnt(0)
    s_barrier
    s_add_u32 s24, s54, 82048
    s_add_u32 s25, s24, 20480
    buffer_load_dwordx4 v[44:47], v65, s[12:15], s24 offen
    buffer_load_dwordx4 v[48:51], v65, s[12:15], s25 offen
    ds_read_b64_tr_b16 a[224:225], v64 offset:0
    ds_read_b64_tr_b16 a[226:227], v64 offset:544
    ds_read_b64_tr_b16 a[232:233], v64 offset:32
    ds_read_b64_tr_b16 a[234:235], v64 offset:576
    s_waitcnt vmcnt(10)
    s_waitcnt lgkmcnt(0)
    s_barrier
    ds_write_b128 v62, v[52:55] offset:0
    ds_write_b128 v62, v[56:59] offset:4352
    s_waitcnt lgkmcnt(0)
    s_barrier
    s_add_u32 s24, s54, 123008
    s_add_u32 s25, s24, 20480
    buffer_load_dwordx4 v[52:55], v65, s[12:15], s24 offen
    buffer_load_dwordx4 v[56:59], v65, s[12:15], s25 offen
    ds_read_b64_tr_b16 a[228:229], v64 offset:0
    ds_read_b64_tr_b16 a[230:231], v64 offset:544
    ds_read_b64_tr_b16 a[236:237], v64 offset:32
    ds_read_b64_tr_b16 a[238:239], v64 offset:576
    s_waitcnt vmcnt(10)
    s_waitcnt lgkmcnt(0)
    s_barrier
    ds_write_b128 v62, v[12:15] offset:0
    ds_write_b128 v62, v[16:19] offset:4352
    s_waitcnt lgkmcnt(0)
    s_barrier
    ds_read_b64_tr_b16 a[240:241], v64 offset:0
    ds_read_b64_tr_b16 a[242:243], v64 offset:544
    ds_read_b64_tr_b16 a[248:249], v64 offset:32
    ds_read_b64_tr_b16 a[250:251], v64 offset:576
    s_waitcnt vmcnt(8)
    s_waitcnt lgkmcnt(0)
    s_barrier
    ds_write_b128 v62, v[20:23] offset:0
    ds_write_b128 v62, v[24:27] offset:4352
    s_waitcnt lgkmcnt(0)
    s_barrier
    ds_read_b64_tr_b16 a[244:245], v64 offset:0
    ds_read_b64_tr_b16 a[246:247], v64 offset:544
    ds_read_b64_tr_b16 a[252:253], v64 offset:32
    ds_read_b64_tr_b16 a[254:255], v64 offset:576
    s_waitcnt vmcnt(6)
    s_waitcnt lgkmcnt(0)
    s_barrier
    ds_write_b128 v62, v[28:31] offset:0
    ds_write_b128 v62, v[32:35] offset:4352
    s_waitcnt lgkmcnt(0)
    s_barrier
    ds_read_b64_tr_b16 v[72:73], v64 offset:0
    ds_read_b64_tr_b16 v[74:75], v64 offset:544
    s_waitcnt lgkmcnt(0)
    s_cmp_ge_u32 s3, 2
    s_cbranch_scc1 L_ch_noc_28
    ds_write_b128 v1, v[72:75] offset:30720
L_ch_noc_28:
    ds_read_b64_tr_b16 v[76:77], v64 offset:32
    ds_read_b64_tr_b16 v[78:79], v64 offset:576
    s_waitcnt lgkmcnt(0)
    s_cmp_ge_u32 s3, 2
    s_cbranch_scc1 L_ch_noc_29
    ds_write_b128 v1, v[76:79] offset:32768
L_ch_noc_29:
    s_waitcnt vmcnt(4)
    s_waitcnt lgkmcnt(0)
    s_barrier
    ds_write_b128 v62, v[36:39] offset:0
    ds_write_b128 v62, v[40:43] offset:4352
    s_waitcnt lgkmcnt(0)
    s_barrier
    ds_read_b64_tr_b16 v[72:73], v64 offset:0
    ds_read_b64_tr_b16 v[74:75], v64 offset:544
    s_waitcnt lgkmcnt(0)
    s_cmp_ge_u32 s3, 2
    s_cbranch_scc1 L_ch_noc_30
    ds_write_b128 v1, v[72:75] offset:31744
L_ch_noc_30:
    ds_read_b64_tr_b16 v[76:77], v64 offset:32
    ds_read_b64_tr_b16 v[78:79], v64 offset:576
    s_waitcnt lgkmcnt(0)
    s_cmp_ge_u32 s3, 2
    s_cbranch_scc1 L_ch_noc_31
    ds_write_b128 v1, v[76:79] offset:33792
L_ch_noc_31:
    s_waitcnt vmcnt(2)
    s_waitcnt lgkmcnt(0)
    s_barrier
    ds_write_b128 v62, v[44:47] offset:0
    ds_write_b128 v62, v[48:51] offset:4352
    s_waitcnt lgkmcnt(0)
    s_barrier
    ds_read_b64_tr_b16 v[72:73], v64 offset:0
    ds_read_b64_tr_b16 v[74:75], v64 offset:544
    s_waitcnt lgkmcnt(0)
    s_cmp_ge_u32 s3, 2
    s_cbranch_scc1 L_ch_noc_32
    ds_write_b128 v1, v[72:75] offset:34816
L_ch_noc_32:
    ds_read_b64_tr_b16 v[76:77], v64 offset:32
    ds_read_b64_tr_b16 v[78:79], v64 offset:576
    s_waitcnt lgkmcnt(0)
    s_cmp_ge_u32 s3, 2
    s_cbranch_scc1 L_ch_noc_33
    ds_write_b128 v1, v[76:79] offset:36864
L_ch_noc_33:
    s_waitcnt vmcnt(0)
    s_waitcnt lgkmcnt(0)
    s_barrier
    ds_write_b128 v62, v[52:55] offset:0
    ds_write_b128 v62, v[56:59] offset:4352
    s_waitcnt lgkmcnt(0)
    s_barrier
    ds_read_b64_tr_b16 v[72:73], v64 offset:0
    ds_read_b64_tr_b16 v[74:75], v64 offset:544
    s_waitcnt lgkmcnt(0)
    s_cmp_ge_u32 s3, 2
    s_cbranch_scc1 L_ch_noc_34
    ds_write_b128 v1, v[72:75] offset:35840
L_ch_noc_34:
    ds_read_b64_tr_b16 v[76:77], v64 offset:32
    ds_read_b64_tr_b16 v[78:79], v64 offset:576
    s_waitcnt lgkmcnt(0)
    s_cmp_ge_u32 s3, 2
    s_cbranch_scc1 L_ch_noc_35
    ds_write_b128 v1, v[76:79] offset:37888
L_ch_noc_35:
    s_waitcnt vmcnt(0) lgkmcnt(0)
    s_barrier
    s_mov_b32 s24, 0x05040100
    s_mov_b32 s25, 0x07060302
    v_add_u32 v72, 0, v70
    v_min_u32 v72, 639, v72
    v_lshlrev_b32 v72, 4, v72
    v_perm_b32 v60, v82, v80, s24
    v_perm_b32 v61, v82, v80, s25
    v_perm_b32 v62, v83, v81, s24
    v_perm_b32 v63, v83, v81, s25
    ds_write_b128 v72, v[60:63] offset:0
    v_add_u32 v72, 256, v70
    v_min_u32 v72, 639, v72
    v_lshlrev_b32 v72, 4, v72
    v_perm_b32 v60, v86, v84, s24
    v_perm_b32 v61, v86, v84, s25
    v_perm_b32 v62, v87, v85, s24
    v_perm_b32 v63, v87, v85, s25
    ds_write_b128 v72, v[60:63] offset:0
    v_add_u32 v72, 512, v70
    v_min_u32 v72, 639, v72
    v_lshlrev_b32 v72, 4, v72
    v_perm_b32 v60, v68, v66, s24
    v_perm_b32 v61, v68, v66, s25
    v_perm_b32 v62, v69, v67, s24
    v_perm_b32 v63, v69, v67, s25
    ds_write_b128 v72, v[60:63] offset:0
    s_waitcnt lgkmcnt(0)
    s_barrier
    v_readfirstlane_b32 s53, v71
    s_nop 0
    s_cmp_ge_u32 s53, 55
    s_cselect_b32 s53, 1, 0
    s_mov_b32 s28, 0
    v_mov_b32 v60, 0
    s_mov_b32 s54, 69206016
L_ch_ss:
    global_load_dwordx2 v[62:63], v60, s[4:5] sc1
    global_load_dwordx2 v[64:65], v60, s[4:5] offset:44 sc1
    buffer_load_dword v61, off, s[8:11], s54 sc1
    s_add_u32 s28, s28, 1
    s_waitcnt vmcnt(0)
    v_readfirstlane_b32 s25, v64
    v_readfirstlane_b32 s24, v65
    v_readfirstlane_b32 s26, v62
    v_readfirstlane_b32 s27, v63
    v_readfirstlane_b32 s52, v61
    s_cmp_ge_u32 s28, 200000
    s_cbranch_scc1 L_ch_ss_done
    s_cmp_lt_u32 s24, 64
    s_cbranch_scc1 L_ch_ss
    s_cmp_lt_u32 s25, 55
    s_cbranch_scc1 L_ch_ss
    s_cmp_lg_u32 s53, 1
    s_mov_b32 s53, 1
    s_cbranch_scc1 L_ch_ss
    s_cmp_lt_u32 s52, 32
    s_cbranch_scc1 L_ch_ss
L_ch_ss_done:
    s_min_u32 s26, s26, s27
    s_cmp_ge_u32 s26, 32
    s_cselect_b32 s55, 1, 0
    s_mov_b32 s54, 1
    s_and_b32 s24, s16, 3
    s_lshl_b32 s24, s24, 7
    s_add_u32 s57, s24, 69271040
    s_cmp_eq_u32 s3, 3
    s_cselect_b32 s12, 2048, 0
    s_mov_b32 s56, -2048
    s_cselect_b32 s56, -1024, s56
    s_lshl_b32 s13, s3, 11
    s_cmp_eq_u32 s3, 2
    s_cselect_b32 s14, 0, 1024
    s_lshl_b32 s15, s3, 10
    s_add_u32 s15, s15, 5120
    s_cmp_eq_u32 s55, 0
    s_cbranch_scc1 L_ch_slow
    v_mov_b64 v[28:29], 0
    v_mov_b64 v[30:31], 0
    v_mov_b64 v[32:33], 0
    v_mov_b64 v[34:35], 0
    v_mov_b64 v[36:37], 0
    v_mov_b64 v[38:39], 0
    v_mov_b64 v[40:41], 0
    v_mov_b64 v[42:43], 0
    v_mov_b64 v[56:57], 0
    v_mov_b64 v[58:59], 0
    v_mov_b64 v[60:61], 0
    v_mov_b64 v[62:63], 0
    ds_read_b128 v[64:67], v1 offset:0
    ds_read_b128 v[68:71], v1 offset:1024
    ds_read_b128 v[72:75], v1 offset:2048
    ds_read_b128 v[76:79], v1 offset:3072
L_ch_step:
    ds_read_b128 v[44:47], v0 offset:0
    buffer_load_dwordx4 v[12:15], v0, s[8:11], s22 offen sc1
    ds_read_b128 v[48:51], v0 offset:1024
    ds_read_b128 v[52:55], v0 offset:2048
    s_waitcnt lgkmcnt(2)
    v_smfmac_f32_16x16x64_bf16 v[28:31], v[44:47], v[88:95], v2
    buffer_load_dwordx4 v[16:19], v0, s[8:11], s22 offen offset:1024 sc1
    v_smfmac_f32_16x16x64_bf16 v[40:43], v[44:47], v[64:71], v2
    ds_read_b128 v[64:67], v1 offset:4096
    ds_read_b128 v[68:71], v1 offset:5120
    v_smfmac_f32_16x16x64_bf16 v[32:35], v[44:47], v[96:103], v2
    v_smfmac_f32_16x16x64_bf16 v[36:39], v[44:47], v[104:111], v2
    buffer_load_dwordx4 v[20:23], v0, s[8:11], s23 offen sc1
    v_smfmac_f32_16x16x64_bf16 v[60:63], v[44:47], v[72:79], v2
    ds_read_b128 v[72:75], v1 offset:6144
    ds_read_b128 v[76:79], v1 offset:7168
    v_smfmac_f32_16x16x64_bf16 v[56:59], v[44:47], v[112:119], v2
    ds_read_b128 v[44:47], v0 offset:3072
    s_waitcnt lgkmcnt(6)
    v_smfmac_f32_16x16x64_bf16 v[28:31], v[48:51], v[120:127], v2
    buffer_load_dwordx4 v[24:27], v0, s[8:11], s23 offen offset:1024 sc1
    s_waitcnt lgkmcnt(3)
    v_smfmac_f32_16x16x64_bf16 v[40:43], v[48:51], v[64:71], v2
    ds_read_b128 v[64:67], v1 offset:8192
    ds_read_b128 v[68:71], v1 offset:9216
    v_smfmac_f32_16x16x64_bf16 v[32:35], v[48:51], v[128:135], v2
    v_smfmac_f32_16x16x64_bf16 v[36:39], v[48:51], v[136:143], v2
    s_waitcnt lgkmcnt(3)
    v_smfmac_f32_16x16x64_bf16 v[60:63], v[48:51], v[72:79], v2
    ds_read_b128 v[72:75], v1 offset:10240
    ds_read_b128 v[76:79], v1 offset:11264
    v_smfmac_f32_16x16x64_bf16 v[56:59], v[48:51], v[144:151], v2
    ds_read_b128 v[48:51], v0 offset:4096
    v_smfmac_f32_16x16x64_bf16 v[28:31], v[52:55], v[152:159], v2
    s_waitcnt lgkmcnt(3)
    v_smfmac_f32_16x16x64_bf16 v[40:43], v[52:55], v[64:71], v2
    ds_read_b128 v[64:67], v1 offset:12288
    ds_read_b128 v[68:71], v1 offset:13312
    v_smfmac_f32_16x16x64_bf16 v[32:35], v[52:55], v[160:167], v2
    v_smfmac_f32_16x16x64_bf16 v[36:39], v[52:55], v[168:175], v2
    s_waitcnt lgkmcnt(3)
    v_smfmac_f32_16x16x64_bf16 v[60:63], v[52:55], v[72:79], v2
    ds_read_b128 v[72:75], v1 offset:14336
    ds_read_b128 v[76:79], v1 offset:15360
    v_smfmac_f32_16x16x64_bf16 v[56:59], v[52:55], v[176:183], v2
    v_smfmac_f32_16x16x64_bf16 v[28:31], v[44:47], v[184:191], v2
    s_waitcnt lgkmcnt(2)
    v_smfmac_f32_16x16x64_bf16 v[40:43], v[44:47], v[64:71], v2
    ds_read_b128 v[64:67], v1 offset:16384
    ds_read_b128 v[68:71], v1 offset:17408
    v_smfmac_f32_16x16x64_bf16 v[32:35], v[44:47], v[192:199], v2
    v_smfmac_f32_16x16x64_bf16 v[36:39], v[44:47], v[200:207], v2
    v_smfmac_f32_16x16x64_bf16 v[60:63], v[44:47], v[208:215], v2
    v_smfmac_f32_16x16x64_bf16 v[56:59], v[44:47], v[216:223], v2
    s_cmp_eq_u32 s17, 0
    s_cbranch_scc1 L_ch_norem
    s_cmp_eq_u32 s3, 3
    s_cbranch_scc1 L_ch_remb
    s_mov_b32 s28, 0
    s_waitcnt vmcnt(4)
L_ch_chkr:
    v_max3_u32 v52, v80, v81, v82
    v_max3_u32 v53, v83, v84, v85
    v_max3_u32 v52, v52, v86, v87
    v_max_u32 v52, v52, v53
    v_cmp_eq_u32 vcc, -1, v52
    v_add_u32 v54, s15, v11
    s_cmp_eq_u64 vcc, 0
    s_cbranch_scc1 L_ch_gotr
    s_add_u32 s28, s28, 1
    s_add_u32 s74, s74, 1
    s_cmp_ge_u32 s28, 30000
    s_cselect_b32 s29, 1, s29
    s_cmp_lg_u32 s29, 0
    s_cbranch_scc1 L_ch_gotr
    buffer_load_dwordx4 v[80:83], v0, s[8:11], s34 offen sc1
    buffer_load_dwordx4 v[84:87], v0, s[8:11], s35 offen sc1
    s_waitcnt vmcnt(0)
    s_branch L_ch_chkr
L_ch_gotr:
    ds_write_b128 v54, v[80:83]
    s_cmp_eq_u32 s3, 2
    s_cbranch_scc1 L_ch_remb
    ds_write_b128 v54, v[84:87] offset:1024
L_ch_remb:
L_ch_norem:
    v_smfmac_f32_16x16x64_bf16 v[28:31], v[48:51], v[224:231], v2
    v_smfmac_f32_16x16x64_bf16 v[32:35], v[48:51], v[232:239], v2
    v_smfmac_f32_16x16x64_bf16 v[36:39], v[48:51], v[240:247], v2
    s_waitcnt lgkmcnt(0)
    s_barrier
    ds_read_b128 v[52:55], v0 offset:5120
    ds_read_b128 v[44:47], v0 offset:6144
    v_smfmac_f32_16x16x64_bf16 v[40:43], v[48:51], v[72:79], v2
    ds_read_b128 v[72:75], v1 offset:18432
    ds_read_b128 v[76:79], v1 offset:19456
    v_smfmac_f32_16x16x64_bf16 v[60:63], v[48:51], v[248:255], v2
    v_smfmac_f32_16x16x64_bf16 v[56:59], v[48:51], a[0:7], v2
    ds_read_b128 v[48:51], v0 offset:7168
    s_waitcnt lgkmcnt(4)
    v_smfmac_f32_16x16x64_bf16 v[28:31], v[52:55], a[8:15], v2
    v_smfmac_f32_16x16x64_bf16 v[40:43], v[52:55], v[64:71], v2
    ds_read_b128 v[64:67], v1 offset:20480
    ds_read_b128 v[68:71], v1 offset:21504
    v_smfmac_f32_16x16x64_bf16 v[32:35], v[52:55], a[16:23], v2
    v_smfmac_f32_16x16x64_bf16 v[36:39], v[52:55], a[24:31], v2
    ds_read_b128 v[52:55], v0 offset:8192
    s_waitcnt lgkmcnt(6)
    v_smfmac_f32_16x16x64_bf16 v[28:31], v[44:47], a[48:55], v2
    s_waitcnt lgkmcnt(4)
    v_smfmac_f32_16x16x64_bf16 v[40:43], v[44:47], v[72:79], v2
    ds_read_b128 v[72:75], v1 offset:22528
    ds_read_b128 v[76:79], v1 offset:23552
    v_smfmac_f32_16x16x64_bf16 v[32:35], v[44:47], a[56:63], v2
    v_smfmac_f32_16x16x64_bf16 v[36:39], v[44:47], a[64:71], v2
    ds_read_b128 v[44:47], v0 offset:9216
    s_waitcnt lgkmcnt(6)
    v_smfmac_f32_16x16x64_bf16 v[28:31], v[48:51], a[88:95], v2
    s_waitcnt lgkmcnt(4)
    v_smfmac_f32_16x16x64_bf16 v[40:43], v[48:51], v[64:71], v2
    ds_read_b128 v[64:67], v1 offset:24576
    ds_read_b128 v[68:71], v1 offset:25600
    v_smfmac_f32_16x16x64_bf16 v[32:35], v[48:51], a[96:103], v2
    v_smfmac_f32_16x16x64_bf16 v[36:39], v[48:51], a[104:111], v2
    s_waitcnt lgkmcnt(5)
    v_smfmac_f32_16x16x64_bf16 v[28:31], v[52:55], a[128:135], v2
    s_waitcnt lgkmcnt(3)
    v_smfmac_f32_16x16x64_bf16 v[40:43], v[52:55], v[72:79], v2
    ds_read_b128 v[76:79], v0 offset:6144
    v_smfmac_f32_16x16x64_bf16 v[32:35], v[52:55], a[136:143], v2
    v_smfmac_f32_16x16x64_bf16 v[36:39], v[52:55], a[144:151], v2
    s_waitcnt lgkmcnt(3)
    v_smfmac_f32_16x16x64_bf16 v[28:31], v[44:47], a[168:175], v2
    s_waitcnt lgkmcnt(1)
    v_smfmac_f32_16x16x64_bf16 v[40:43], v[44:47], v[64:71], v2
    ds_read_b128 v[68:71], v0 offset:5120
    v_smfmac_f32_16x16x64_bf16 v[32:35], v[44:47], a[176:183], v2
    v_smfmac_f32_16x16x64_bf16 v[36:39], v[44:47], a[184:191], v2
    v_smfmac_f32_16x16x64_bf16 v[56:59], v[48:51], a[112:119], v2
    v_smfmac_f32_16x16x64_bf16 v[60:63], v[48:51], a[120:127], v2
    v_add_f32 v28, v28, v29
    v_add_f32 v30, v30, v31
    v_add_f32 v32, v32, v33
    v_add_f32 v34, v34, v35
    v_add_f32 v36, v36, v37
    v_add_f32 v38, v38, v39
    v_add_f32 v40, v40, v41
    v_add_f32 v42, v42, v43
    v_cvt_pk_bf16_f32 v29, v28, v32
    v_cvt_pk_bf16_f32 v31, v30, v34
    ds_write2_b32 v3, v29, v31 offset0:0 offset1:16
    v_cvt_pk_bf16_f32 v37, v36, v40
    v_cvt_pk_bf16_f32 v39, v38, v42
    ds_write2_b32 v3, v37, v39 offset0:128 offset1:144
    ds_read_b128 v[28:31], v4
    ds_read_b128 v[32:35], v5
    v_smfmac_f32_16x16x64_bf16 v[56:59], v[52:55], a[152:159], v2
    v_smfmac_f32_16x16x64_bf16 v[60:63], v[52:55], a[160:167], v2
    v_smfmac_f32_16x16x64_bf16 v[56:59], v[44:47], a[192:199], v2
    v_smfmac_f32_16x16x64_bf16 v[60:63], v[44:47], a[200:207], v2
    s_waitcnt lgkmcnt(0)
    s_waitcnt vmcnt(0)
    v_mfma_f32_16x16x32_bf16 v[64:67], v[16:19], v[28:31], 0
    v_mfma_f32_16x16x32_bf16 v[40:43], v[12:15], v[28:31], 0
    v_mfma_f32_16x16x32_bf16 v[36:39], v[32:35], v[28:31], 0
    v_add_u32 v12, s47, v6
    v_smfmac_f32_16x16x64_bf16 v[56:59], v[68:71], a[32:39], v2
    s_mov_b64 exec, s[32:33]
    ds_write_b128 v12, v[64:67] offset:32
    ds_write_b128 v12, v[40:43] offset:16
    s_nop 0
    ds_write_b64 v12, v[36:37]
    s_mov_b64 exec, -1
    v_smfmac_f32_16x16x64_bf16 v[60:63], v[68:71], a[40:47], v2
    s_cmp_lg_u32 s3, 0
    s_cbranch_scc1 L_ch_nosig_36
    s_cmp_eq_u32 s17, 0
    s_cbranch_scc1 L_ch_nosig_36
    s_lshl_b32 s24, s17, 9
    s_add_u32 s24, s24, s57
    s_mov_b64 exec, 1
    buffer_atomic_add v2, off, s[8:11], s24
    s_mov_b64 exec, -1
L_ch_nosig_36:
    v_mov_b64 v[28:29], -1
    v_smfmac_f32_16x16x64_bf16 v[56:59], v[76:79], a[72:79], v2
    v_mov_b64 v[30:31], -1
    s_add_u32 s24, s20, 16384
    s_and_b32 s24, s24, 32767
    s_add_u32 s24, s24, s19
    v_smfmac_f32_16x16x64_bf16 v[60:63], v[76:79], a[80:87], v2
    s_add_u32 s24, s24, s46
    s_add_u32 s25, s24, s49
    s_cmp_eq_u32 s48, 0
    s_cbranch_scc1 L_ch_norm
    s_mov_b64 exec, 0xff
    buffer_store_dwordx4 v[28:31], v0, s[8:11], s24 offen
    buffer_store_dwordx4 v[28:31], v0, s[8:11], s25 offen sc1
    s_mov_b64 exec, -1
L_ch_norm:
    s_waitcnt lgkmcnt(0)
    s_barrier
    ds_read_b64 v[36:37], v6
    ds_read_b64 v[38:39], v6 offset:1536
    ds_read_b128 v[40:43], v6 offset:16
    ds_read_b128 v[28:31], v6 offset:1552
    ds_read_b128 v[64:67], v6 offset:32
    ds_read_b128 v[68:71], v6 offset:1568
    s_cmp_lg_u32 s18, 0
    s_cbranch_scc1 L_ch_nokm
    buffer_store_dwordx4 v[32:35], v0, s[8:11], s30 offen sc1
L_ch_nokm:
    v_add_f32 v56, v56, v57
    v_add_f32 v58, v58, v59
    v_add_f32 v60, v60, v61
    v_add_f32 v62, v62, v63
    v_cvt_pk_bf16_f32 v56, v56, v58
    v_cvt_pk_bf16_f32 v57, v60, v62
    v_lshrrev_b32 v60, 1, v0
    v_mov_b32 v58, v57
    v_mov_b32 v59, v56
    s_cmp_lg_u32 s18, 1
    s_cbranch_scc1 L_ch_novm
    buffer_store_dwordx2 v[56:57], v60, s[8:11], s58 offen sc1
L_ch_novm:
    s_cmp_eq_u32 s17, 63
    s_cbranch_scc1 L_ch_done
    s_waitcnt lgkmcnt(4)
    v_pk_add_f32 v[36:37], v[36:37], v[38:39]
    s_waitcnt lgkmcnt(2)
    v_pk_add_f32 v[40:41], v[40:41], v[28:29]
    v_pk_add_f32 v[42:43], v[42:43], v[30:31]
    s_waitcnt lgkmcnt(0)
    v_pk_add_f32 v[64:65], v[64:65], v[68:69]
    v_pk_add_f32 v[66:67], v[66:67], v[70:71]
    ds_read_b128 v[80:83], v1 offset:26624
    ds_read_b128 v[84:87], v1 offset:27648
    v_add_f32_dpp v36, v36, v36 row_ror:8 row_mask:0xf bank_mask:0xf
    v_add_f32_dpp v37, v37, v37 row_ror:8 row_mask:0xf bank_mask:0xf
    v_add_f32_dpp v40, v40, v40 row_ror:8 row_mask:0xf bank_mask:0xf
    v_add_f32_dpp v41, v41, v41 row_ror:8 row_mask:0xf bank_mask:0xf
    v_add_f32_dpp v42, v42, v42 row_ror:8 row_mask:0xf bank_mask:0xf
    v_add_f32_dpp v43, v43, v43 row_ror:8 row_mask:0xf bank_mask:0xf
    v_add_f32_dpp v64, v64, v64 row_ror:8 row_mask:0xf bank_mask:0xf
    v_add_f32_dpp v65, v65, v65 row_ror:8 row_mask:0xf bank_mask:0xf
    v_add_f32_dpp v66, v66, v66 row_ror:8 row_mask:0xf bank_mask:0xf
    v_add_f32_dpp v67, v67, v67 row_ror:8 row_mask:0xf bank_mask:0xf
    v_max3_f32 v38, v36, v37, v40
    v_max3_f32 v39, v41, v42, v43
    v_max3_f32 v28, v64, v65, v66
    v_max3_f32 v38, v38, v39, v67
    v_max_f32 v38, v38, v28
    v_mov_b32 v39, v38
    v_mov_b32 v33, 0
    ds_read_b128 v[72:75], v1 offset:28672
    ds_read_b128 v[76:79], v1 offset:29696
    v_permlane32_swap_b32 v39, v38
    v_max_f32 v38, v38, v39
    v_mov_b32 v39, v38
    s_nop 1
    v_permlane16_swap_b32 v39, v38
    v_max_f32 v38, v38, v39
    v_mul_f32 v38, s31, v38
    v_pk_fma_f32 v[36:37], v[36:37], s[42:43], v[38:39] op_sel_hi:[1,1,0] neg_lo:[0,0,1] neg_hi:[0,0,1]
    v_pk_fma_f32 v[40:41], v[40:41], s[42:43], v[38:39] op_sel_hi:[1,1,0] neg_lo:[0,0,1] neg_hi:[0,0,1]
    v_pk_fma_f32 v[42:43], v[42:43], s[42:43], v[38:39] op_sel_hi:[1,1,0] neg_lo:[0,0,1] neg_hi:[0,0,1]
    v_pk_fma_f32 v[64:65], v[64:65], s[42:43], v[38:39] op_sel_hi:[1,1,0] neg_lo:[0,0,1] neg_hi:[0,0,1]
    v_pk_fma_f32 v[66:67], v[66:67], s[42:43], v[38:39] op_sel_hi:[1,1,0] neg_lo:[0,0,1] neg_hi:[0,0,1]
    v_exp_f32 v40, v40
    v_exp_f32 v41, v41
    v_exp_f32 v42, v42
    v_exp_f32 v43, v43
    v_exp_f32 v64, v64
    v_exp_f32 v65, v65
    v_exp_f32 v66, v66
    v_exp_f32 v67, v67
    v_cvt_pk_bf16_f32 v28, v40, v41
    v_cvt_pk_bf16_f32 v29, v42, v43
    v_exp_f32 v36, v36
    v_exp_f32 v37, v37
    v_cvt_pk_bf16_f32 v30, v64, v65
    v_cvt_pk_bf16_f32 v31, v66, v67
    v_pk_add_f32 v[34:35], v[40:41], v[42:43]
    v_pk_add_f32 v[38:39], v[64:65], v[66:67]
    v_cvt_pk_bf16_f32 v32, v36, v37
    v_pk_add_f32 v[34:35], v[34:35], v[38:39]
    v_pk_add_f32 v[34:35], v[34:35], v[36:37]
    v_mfma_f32_16x16x32_bf16 v[40:43], v[20:23], v[28:31], 0
    v_add_f32 v34, v34, v35
    v_mov_b32 v35, v34
    v_mfma_f32_16x16x32_bf16 v[64:67], v[24:27], v[28:31], 0
    v_mfma_f32_16x16x16_bf16 v[40:43], v[56:57], v[32:33], v[40:43]
    v_permlane32_swap_b32 v35, v34
    v_add_f32 v34, v34, v35
    v_mfma_f32_16x16x16_bf16 v[64:67], v[58:59], v[32:33], v[64:67]
    v_mov_b32 v35, v34
    ds_read_b128 v[56:59], v1 offset:30720
    ds_read_b128 v[60:63], v1 offset:31744
    v_permlane16_swap_b32 v35, v34
    v_add_f32 v34, v34, v35
    v_rcp_f32 v34, v34
    v_mov_b64 v[44:45], 0
    v_mov_b64 v[46:47], 0
    v_mov_b64 v[48:49], 0
    v_mov_b64 v[50:51], 0
    v_pk_mul_f32 v[40:41], v[40:41], v[34:35] op_sel_hi:[1,0]
    v_pk_mul_f32 v[42:43], v[42:43], v[34:35] op_sel_hi:[1,0]
    v_pk_mul_f32 v[64:65], v[64:65], v[34:35] op_sel_hi:[1,0]
    v_pk_mul_f32 v[66:67], v[66:67], v[34:35] op_sel_hi:[1,0]
    v_cvt_pk_bf16_f32 v32, v40, v41
    v_cvt_pk_bf16_f32 v33, v42, v43
    v_cvt_pk_bf16_f32 v34, v64, v65
    v_cvt_pk_bf16_f32 v35, v66, v67
    s_mov_b64 exec, s[32:33]
    ds_write_b128 v7, v[32:35]
    s_mov_b64 exec, -1
    ds_read_b128 v[64:67], v1 offset:32768
    ds_read_b128 v[68:71], v1 offset:33792
    v_mov_b64 v[36:37], 0
    v_mov_b64 v[38:39], 0
    v_mov_b64 v[40:41], 0
    v_mov_b64 v[42:43], 0
    v_mov_b64 v[12:13], 0
    v_mov_b64 v[14:15], 0
    v_mov_b64 v[16:17], 0
    v_mov_b64 v[18:19], 0
    v_mov_b64 v[52:53], -1
    v_mov_b64 v[54:55], -1
    v_and_b32 v29, 0x1f0, v0
    v_lshrrev_b32 v28, 9, v0
    v_lshlrev_b32 v28, 14, v28
    v_add_u32 v28, v28, v29
    s_add_u32 s24, s45, s41
    s_add_u32 s25, s24, s59
    buffer_store_dwordx4 v[52:55], v28, s[8:11], s24 offen
    buffer_store_dwordx4 v[52:55], v29, s[8:11], s25 offen
    s_waitcnt lgkmcnt(2)
    s_barrier
    ds_read_b128 v[28:31], v0 offset:0
    ds_read_b128 v[32:35], v0 offset:1024
    s_waitcnt lgkmcnt(1)
    v_smfmac_f32_16x16x64_bf16 v[36:39], v[28:31], a[208:215], v2
    v_smfmac_f32_16x16x64_bf16 v[40:43], v[28:31], v[80:87], v2
    ds_read_b128 v[80:83], v1 offset:34816
    ds_read_b128 v[84:87], v1 offset:35840
    s_waitcnt lgkmcnt(2)
    v_smfmac_f32_16x16x64_bf16 v[36:39], v[32:35], a[216:223], v2
    v_smfmac_f32_16x16x64_bf16 v[40:43], v[32:35], v[72:79], v2
    ds_read_b128 v[72:75], v1 offset:36864
    ds_read_b128 v[76:79], v1 offset:37888
    v_smfmac_f32_16x16x64_bf16 v[44:47], v[28:31], a[224:231], v2
    v_smfmac_f32_16x16x64_bf16 v[48:51], v[28:31], a[232:239], v2
    v_add_f32 v36, v36, v37
    v_add_f32 v38, v38, v39
    v_add_f32 v40, v40, v41
    v_add_f32 v42, v42, v43
    v_smfmac_f32_16x16x64_bf16 v[44:47], v[32:35], a[240:247], v2
    v_cvt_pk_bf16_f32 v52, v36, v40
    v_cvt_pk_bf16_f32 v53, v38, v42
    buffer_store_dwordx2 v[52:53], v8, s[8:11], s44 offen
    v_smfmac_f32_16x16x64_bf16 v[48:51], v[32:35], a[248:255], v2
    s_cmp_eq_u32 s51, 0
    s_cbranch_scc1 L_ch_g2two
    v_smfmac_f32_16x16x64_bf16 v[12:15], v[28:31], v[56:63], v2
    v_smfmac_f32_16x16x64_bf16 v[16:19], v[28:31], v[64:71], v2
    v_add_f32 v44, v44, v45
    v_add_f32 v46, v46, v47
    v_add_f32 v48, v48, v49
    v_add_f32 v50, v50, v51
    s_waitcnt lgkmcnt(2)
    v_smfmac_f32_16x16x64_bf16 v[12:15], v[32:35], v[80:87], v2
    v_cvt_pk_bf16_f32 v54, v44, v48
    v_cvt_pk_bf16_f32 v55, v46, v50
    s_add_u32 s24, s44, 16384
    buffer_store_dwordx2 v[54:55], v8, s[8:11], s24 offen
    s_waitcnt lgkmcnt(0)
    v_smfmac_f32_16x16x64_bf16 v[16:19], v[32:35], v[72:79], v2
    s_nop 1
    v_add_f32 v12, v12, v13
    v_add_f32 v14, v14, v15
    s_nop 3
    v_add_f32 v16, v16, v17
    v_add_f32 v18, v18, v19
    v_cvt_pk_bf16_f32 v52, v12, v16
    v_cvt_pk_bf16_f32 v53, v14, v18
    s_add_u32 s24, s44, 32768
    buffer_store_dwordx2 v[52:53], v8, s[8:11], s24 offen
    s_branch L_ch_g2end
L_ch_g2two:
    s_nop 1
    v_add_f32 v44, v44, v45
    v_add_f32 v46, v46, v47
    s_nop 1
    v_add_f32 v48, v48, v49
    v_add_f32 v50, v50, v51
    v_cvt_pk_bf16_f32 v54, v44, v48
    v_cvt_pk_bf16_f32 v55, v46, v50
    s_add_u32 s24, s44, 16384
    buffer_store_dwordx2 v[54:55], v8, s[8:11], s24 offen
L_ch_g2end:
    s_waitcnt lgkmcnt(0)
    s_add_u32 s26, s19, s20
    s_add_u32 s52, s26, s12
    s_add_u32 s53, s26, 4096
    s_add_u32 s34, s26, s50
    s_add_u32 s34, s34, s13
    s_add_u32 s35, s34, s14
    s_add_u32 s26, s26, s46
    s_add_u32 s27, s26, s49
    s_cmp_eq_u32 s48, 0
    s_cbranch_scc1 L_ch_hop2
    s_add_u32 s36, s40, s21
    s_add_u32 s37, s36, 4096
    s_add_u32 s38, s36, 8192
    s_add_u32 s39, s36, 12288
    v_lshrrev_b32 v52, 4, v0
    v_and_b32 v52, 15, v52
    v_lshrrev_b32 v53, 1, v52
    v_and_b32 v54, 1, v52
    v_mov_b32 v55, 0x3f80
    v_lshlrev_b32 v54, 4, v54
    v_lshlrev_b32 v55, v54, v55
    v_cmp_eq_u32 vcc, 0, v53
    s_nop 1
    v_cndmask_b32 v44, 0, v55, vcc
    v_cmp_eq_u32 vcc, 1, v53
    s_nop 1
    v_cndmask_b32 v45, 0, v55, vcc
    v_cmp_eq_u32 vcc, 2, v53
    s_nop 1
    v_cndmask_b32 v46, 0, v55, vcc
    v_cmp_eq_u32 vcc, 3, v53
    s_nop 1
    v_cndmask_b32 v47, 0, v55, vcc
    s_mov_b32 s28, 0
    buffer_load_dwordx4 v[64:67], v9, s[8:11], s36 offen sc1
    buffer_load_dwordx4 v[68:71], v9, s[8:11], s37 offen sc1
    buffer_load_dwordx4 v[72:75], v9, s[8:11], s38 offen sc1
    buffer_load_dwordx4 v[76:79], v9, s[8:11], s39 offen sc1
    s_add_u32 s17, s17, 1
    s_add_u32 s30, s30, 131072
    s_add_u32 s58, s58, 65536
    s_add_u32 s22, s22, 262144
    s_add_u32 s23, s23, 262144
    s_add_u32 s21, s21, 163840
    s_cmp_eq_u32 s21, 491520
    s_cselect_b32 s21, 0, s21
    s_add_u32 s41, s41, 163840
    s_cmp_eq_u32 s41, 491520
    s_cselect_b32 s41, 0, s41
    s_add_u32 s44, s45, s21
    s_add_u32 s20, s20, 8192
    s_and_b32 s20, s20, 32767
    v_mov_b64 v[28:29], 0
    v_mov_b64 v[30:31], 0
    v_mov_b64 v[32:33], 0
    v_mov_b64 v[34:35], 0
    v_mov_b64 v[36:37], 0
    v_mov_b64 v[38:39], 0
    v_mov_b64 v[40:41], 0
    v_mov_b64 v[42:43], 0
    v_mov_b64 v[56:57], 0
    v_mov_b64 v[58:59], 0
    v_mov_b64 v[60:61], 0
    v_mov_b64 v[62:63], 0
    buffer_load_dwordx4 v[12:15], v9, s[8:11], s36 offen sc1
    buffer_load_dwordx4 v[16:19], v9, s[8:11], s37 offen sc1
    buffer_load_dwordx4 v[20:23], v9, s[8:11], s38 offen sc1
    buffer_load_dwordx4 v[24:27], v9, s[8:11], s39 offen sc1
L_ch_poll1:
    s_waitcnt vmcnt(7)
    v_mfma_f32_16x16x32_bf16 v[48:51], v[44:47], v[64:67], 0
    s_waitcnt vmcnt(6)
    v_mfma_f32_16x16x32_bf16 v[48:51], v[44:47], v[68:71], v[48:51]
    s_waitcnt vmcnt(5)
    v_mfma_f32_16x16x32_bf16 v[48:51], v[44:47], v[72:75], v[48:51]
    s_waitcnt vmcnt(4)
    v_mfma_f32_16x16x32_bf16 v[48:51], v[44:47], v[76:79], v[48:51]
    s_add_u32 s28, s28, 1
    s_add_u32 s72, s72, 1
    s_cmp_ge_u32 s28, 30000
    s_cselect_b32 s29, 1, s29
    s_nop 3
    v_cmp_u_f32 vcc, v48, v48
    v_add_f32_dpp v48, v48, v48 row_ror:8 row_mask:0xf bank_mask:0xf
    v_add_f32_dpp v49, v49, v49 row_ror:8 row_mask:0xf bank_mask:0xf
    v_add_f32_dpp v50, v50, v50 row_ror:8 row_mask:0xf bank_mask:0xf
    v_add_f32_dpp v51, v51, v51 row_ror:8 row_mask:0xf bank_mask:0xf
    s_cmp_eq_u64 vcc, 0
    s_cbranch_scc1 L_ch_got1
    s_cmp_lg_u32 s29, 0
    s_cbranch_scc1 L_ch_got1
    buffer_load_dwordx4 v[64:67], v9, s[8:11], s36 offen sc1
    buffer_load_dwordx4 v[68:71], v9, s[8:11], s37 offen sc1
    buffer_load_dwordx4 v[72:75], v9, s[8:11], s38 offen sc1
    buffer_load_dwordx4 v[76:79], v9, s[8:11], s39 offen sc1
    s_waitcnt vmcnt(7)
    v_mfma_f32_16x16x32_bf16 v[48:51], v[44:47], v[12:15], 0
    s_waitcnt vmcnt(6)
    v_mfma_f32_16x16x32_bf16 v[48:51], v[44:47], v[16:19], v[48:51]
    s_waitcnt vmcnt(5)
    v_mfma_f32_16x16x32_bf16 v[48:51], v[44:47], v[20:23], v[48:51]
    s_waitcnt vmcnt(4)
    v_mfma_f32_16x16x32_bf16 v[48:51], v[44:47], v[24:27], v[48:51]
    s_add_u32 s28, s28, 1
    s_add_u32 s72, s72, 1
    s_cmp_ge_u32 s28, 30000
    s_cselect_b32 s29, 1, s29
    s_nop 3
    v_cmp_u_f32 vcc, v48, v48
    v_add_f32_dpp v48, v48, v48 row_ror:8 row_mask:0xf bank_mask:0xf
    v_add_f32_dpp v49, v49, v49 row_ror:8 row_mask:0xf bank_mask:0xf
    v_add_f32_dpp v50, v50, v50 row_ror:8 row_mask:0xf bank_mask:0xf
    v_add_f32_dpp v51, v51, v51 row_ror:8 row_mask:0xf bank_mask:0xf
    s_cmp_eq_u64 vcc, 0
    s_cbranch_scc1 L_ch_got1
    s_cmp_lg_u32 s29, 0
    s_cbranch_scc1 L_ch_got1
    buffer_load_dwordx4 v[12:15], v9, s[8:11], s36 offen sc1
    buffer_load_dwordx4 v[16:19], v9, s[8:11], s37 offen sc1
    buffer_load_dwordx4 v[20:23], v9, s[8:11], s38 offen sc1
    buffer_load_dwordx4 v[24:27], v9, s[8:11], s39 offen sc1
    s_branch L_ch_poll1
L_ch_got1:
    v_cvt_pk_bf16_f32 v52, v48, v49
    v_cvt_pk_bf16_f32 v53, v50, v51
    s_nop 1
    v_permlane16_swap_b32 v52, v53
    s_mov_b64 exec, 0x00ff00ff
    buffer_store_dwordx2 v[52:53], v10, s[8:11], s27 offen sc1
    buffer_store_dwordx2 v[52:53], v10, s[8:11], s26 offen
    s_mov_b64 exec, -1
    s_branch L_ch_pubd
L_ch_hop2:
    s_cmp_lt_u32 s3, 2
    s_cbranch_scc1 L_ch_w1nr
    s_add_u32 s36, s17, 1
    s_cmp_lt_u32 s36, s54
    s_cbranch_scc1 L_cht23_kvok
    s_mov_b32 s28, 0
    s_lshl_b32 s24, s36, 9
    s_add_u32 s24, s24, 69206016
    s_add_u32 s25, s36, 7
    s_min_u32 s25, s25, 63
    s_lshl_b32 s25, s25, 9
    s_add_u32 s25, s25, 69206016
L_cht23_kvp:
    buffer_load_dword v78, off, s[8:11], s24 sc1
    buffer_load_dword v79, off, s[8:11], s25 sc1
    s_add_u32 s28, s28, 1
    s_waitcnt vmcnt(0)
    v_readfirstlane_b32 s26, v78
    v_readfirstlane_b32 s27, v79
    s_cmp_ge_u32 s28, 200000
    s_cbranch_scc1 L_cht23_kvall
    s_cmp_ge_u32 s27, 32
    s_cbranch_scc1 L_cht23_kvall
    s_cmp_lt_u32 s26, 32
    s_cbranch_scc1 L_cht23_kvp
    s_add_u32 s54, s36, 1
    s_branch L_cht23_kvok
L_cht23_kvall:
    s_add_u32 s54, s36, 8
L_cht23_kvok:
    s_branch L_ch_pubd
L_ch_w1nr:
    s_add_u32 s17, s17, 1
    s_add_u32 s30, s30, 131072
    s_add_u32 s58, s58, 65536
    s_add_u32 s22, s22, 262144
    s_add_u32 s23, s23, 262144
    s_add_u32 s21, s21, 163840
    s_cmp_eq_u32 s21, 491520
    s_cselect_b32 s21, 0, s21
    s_add_u32 s41, s41, 163840
    s_cmp_eq_u32 s41, 491520
    s_cselect_b32 s41, 0, s41
    s_add_u32 s44, s45, s21
    s_add_u32 s20, s20, 8192
    s_and_b32 s20, s20, 32767
    v_mov_b64 v[28:29], 0
    v_mov_b64 v[30:31], 0
    v_mov_b64 v[32:33], 0
    v_mov_b64 v[34:35], 0
    v_mov_b64 v[36:37], 0
    v_mov_b64 v[38:39], 0
    v_mov_b64 v[40:41], 0
    v_mov_b64 v[42:43], 0
    v_mov_b64 v[56:57], 0
    v_mov_b64 v[58:59], 0
    v_mov_b64 v[60:61], 0
    v_mov_b64 v[62:63], 0
L_ch_pubd:
    s_barrier
    s_cmp_eq_u32 s3, 2
    s_cbranch_scc1 L_ch_gw2
    s_cmp_eq_u32 s3, 3
    s_cbranch_scc1 L_ch_gw3
    s_barrier
    buffer_load_dwordx4 v[80:83], v0, s[8:11], s34 offen sc1
    buffer_load_dwordx4 v[84:87], v0, s[8:11], s35 offen sc1
    s_waitcnt vmcnt(4)
    s_branch L_ch_got2
L_ch_gw2:
    s_add_u32 s17, s17, 1
    s_add_u32 s30, s30, 131072
    s_add_u32 s58, s58, 65536
    s_add_u32 s22, s22, 262144
    s_add_u32 s23, s23, 262144
    s_add_u32 s21, s21, 163840
    s_cmp_eq_u32 s21, 491520
    s_cselect_b32 s21, 0, s21
    s_add_u32 s41, s41, 163840
    s_cmp_eq_u32 s41, 491520
    s_cselect_b32 s41, 0, s41
    s_add_u32 s44, s45, s21
    s_add_u32 s20, s20, 8192
    s_and_b32 s20, s20, 32767
    v_mov_b64 v[28:29], 0
    v_mov_b64 v[30:31], 0
    v_mov_b64 v[32:33], 0
    v_mov_b64 v[34:35], 0
    v_mov_b64 v[36:37], 0
    v_mov_b64 v[38:39], 0
    v_mov_b64 v[40:41], 0
    v_mov_b64 v[42:43], 0
    v_mov_b64 v[56:57], 0
    v_mov_b64 v[58:59], 0
    v_mov_b64 v[60:61], 0
    v_mov_b64 v[62:63], 0
    s_mov_b32 s28, 0
L_ch_p2w2:
    buffer_load_dwordx4 v[44:47], v0, s[8:11], s52 offen sc1
    buffer_load_dwordx4 v[48:51], v0, s[8:11], s52 offen offset:1024 sc1
    buffer_load_dwordx4 v[52:55], v0, s[8:11], s53 offen sc1
    s_add_u32 s28, s28, 1
    s_add_u32 s73, s73, 1
    s_cmp_ge_u32 s28, 30000
    s_cselect_b32 s29, 1, s29
    s_waitcnt vmcnt(0)
    v_max3_u32 v76, v44, v45, v46
    v_max3_u32 v77, v47, v48, v49
    v_max3_u32 v76, v76, v50, v51
    v_max3_u32 v77, v77, v52, v53
    v_max3_u32 v76, v76, v54, v55
    v_max_u32 v76, v76, v77
    v_cmp_eq_u32 vcc, -1, v76
    v_add_u32 v78, s56, v11
    s_cmp_eq_u64 vcc, 0
    s_cbranch_scc1 L_ch_g2aw2
    s_cmp_lg_u32 s29, 0
    s_cbranch_scc1 L_ch_g2aw2
    s_branch L_ch_p2w2
L_ch_g2aw2:
    s_barrier
    ds_write_b128 v78, v[44:47]
    ds_write_b128 v78, v[48:51] offset:1024
    ds_write_b128 v78, v[52:55] offset:4096
    buffer_load_dwordx4 v[80:83], v0, s[8:11], s34 offen sc1
    buffer_load_dwordx4 v[84:87], v0, s[8:11], s35 offen sc1
    s_waitcnt lgkmcnt(0)
    s_branch L_ch_got2
L_ch_gw3:
    s_add_u32 s17, s17, 1
    s_add_u32 s30, s30, 131072
    s_add_u32 s58, s58, 65536
    s_add_u32 s22, s22, 262144
    s_add_u32 s23, s23, 262144
    s_add_u32 s21, s21, 163840
    s_cmp_eq_u32 s21, 491520
    s_cselect_b32 s21, 0, s21
    s_add_u32 s41, s41, 163840
    s_cmp_eq_u32 s41, 491520
    s_cselect_b32 s41, 0, s41
    s_add_u32 s44, s45, s21
    s_add_u32 s20, s20, 8192
    s_and_b32 s20, s20, 32767
    v_mov_b64 v[28:29], 0
    v_mov_b64 v[30:31], 0
    v_mov_b64 v[32:33], 0
    v_mov_b64 v[34:35], 0
    v_mov_b64 v[36:37], 0
    v_mov_b64 v[38:39], 0
    v_mov_b64 v[40:41], 0
    v_mov_b64 v[42:43], 0
    v_mov_b64 v[56:57], 0
    v_mov_b64 v[58:59], 0
    v_mov_b64 v[60:61], 0
    v_mov_b64 v[62:63], 0
    s_mov_b32 s28, 0
L_ch_p2w3:
    buffer_load_dwordx4 v[44:47], v0, s[8:11], s52 offen sc1
    buffer_load_dwordx4 v[48:51], v0, s[8:11], s52 offen offset:1024 sc1
    s_add_u32 s28, s28, 1
    s_add_u32 s73, s73, 1
    s_cmp_ge_u32 s28, 30000
    s_cselect_b32 s29, 1, s29
    s_waitcnt vmcnt(0)
    v_max3_u32 v76, v44, v45, v46
    v_max3_u32 v77, v47, v48, v49
    v_max3_u32 v76, v76, v50, v51
    v_max_u32 v76, v76, v77
    v_cmp_eq_u32 vcc, -1, v76
    v_add_u32 v78, s56, v11
    s_cmp_eq_u64 vcc, 0
    s_cbranch_scc1 L_ch_g2aw3
    s_cmp_lg_u32 s29, 0
    s_cbranch_scc1 L_ch_g2aw3
    s_branch L_ch_p2w3
L_ch_g2aw3:
    s_barrier
    ds_write_b128 v78, v[44:47]
    ds_write_b128 v78, v[48:51] offset:1024
    s_waitcnt lgkmcnt(0)
    s_branch L_ch_got2
L_ch_got2:
    ds_read_b128 v[64:67], v1 offset:0
    ds_read_b128 v[68:71], v1 offset:1024
    ds_read_b128 v[72:75], v1 offset:2048
    ds_read_b128 v[76:79], v1 offset:3072
    s_barrier
    s_branch L_ch_step
L_ch_done:
    s_waitcnt vmcnt(0)
    s_barrier
    s_cmp_lg_u32 s3, 0
    s_cbranch_scc1 L_ch_nofin
    s_add_u32 s24, s57, 32768
    s_mov_b64 exec, 1
    buffer_atomic_add v2, off, s[8:11], s24
    s_mov_b64 exec, -1
L_ch_nofin:
    s_branch L_ch_fin
L_ch_slow:
    v_mov_b64 v[28:29], 0
    v_mov_b64 v[30:31], 0
    v_mov_b64 v[32:33], 0
    v_mov_b64 v[34:35], 0
    v_mov_b64 v[36:37], 0
    v_mov_b64 v[38:39], 0
    v_mov_b64 v[40:41], 0
    v_mov_b64 v[42:43], 0
    v_mov_b64 v[56:57], 0
    v_mov_b64 v[58:59], 0
    v_mov_b64 v[60:61], 0
    v_mov_b64 v[62:63], 0
    ds_read_b128 v[64:67], v1 offset:0
    ds_read_b128 v[68:71], v1 offset:1024
    ds_read_b128 v[72:75], v1 offset:2048
    ds_read_b128 v[76:79], v1 offset:3072
L_cs_step:
    ds_read_b128 v[44:47], v0 offset:0
    buffer_load_dwordx4 v[12:15], v0, s[8:11], s22 offen sc1
    ds_read_b128 v[48:51], v0 offset:1024
    ds_read_b128 v[52:55], v0 offset:2048
    s_waitcnt lgkmcnt(2)
    v_smfmac_f32_16x16x64_bf16 v[28:31], v[44:47], v[88:95], v2
    buffer_load_dwordx4 v[16:19], v0, s[8:11], s22 offen offset:1024 sc1
    v_smfmac_f32_16x16x64_bf16 v[40:43], v[44:47], v[64:71], v2
    ds_read_b128 v[64:67], v1 offset:4096
    ds_read_b128 v[68:71], v1 offset:5120
    v_smfmac_f32_16x16x64_bf16 v[32:35], v[44:47], v[96:103], v2
    v_smfmac_f32_16x16x64_bf16 v[36:39], v[44:47], v[104:111], v2
    buffer_load_dwordx4 v[20:23], v0, s[8:11], s23 offen sc1
    v_smfmac_f32_16x16x64_bf16 v[60:63], v[44:47], v[72:79], v2
    ds_read_b128 v[72:75], v1 offset:6144
    ds_read_b128 v[76:79], v1 offset:7168
    v_smfmac_f32_16x16x64_bf16 v[56:59], v[44:47], v[112:119], v2
    ds_read_b128 v[44:47], v0 offset:3072
    s_waitcnt lgkmcnt(6)
    v_smfmac_f32_16x16x64_bf16 v[28:31], v[48:51], v[120:127], v2
    buffer_load_dwordx4 v[24:27], v0, s[8:11], s23 offen offset:1024 sc1
    s_waitcnt lgkmcnt(3)
    v_smfmac_f32_16x16x64_bf16 v[40:43], v[48:51], v[64:71], v2
    ds_read_b128 v[64:67], v1 offset:8192
    ds_read_b128 v[68:71], v1 offset:9216
    v_smfmac_f32_16x16x64_bf16 v[32:35], v[48:51], v[128:135], v2
    v_smfmac_f32_16x16x64_bf16 v[36:39], v[48:51], v[136:143], v2
    s_waitcnt lgkmcnt(3)
    v_smfmac_f32_16x16x64_bf16 v[60:63], v[48:51], v[72:79], v2
    ds_read_b128 v[72:75], v1 offset:10240
    ds_read_b128 v[76:79], v1 offset:11264
    v_smfmac_f32_16x16x64_bf16 v[56:59], v[48:51], v[144:151], v2
    ds_read_b128 v[48:51], v0 offset:4096
    v_smfmac_f32_16x16x64_bf16 v[28:31], v[52:55], v[152:159], v2
    s_waitcnt lgkmcnt(3)
    v_smfmac_f32_16x16x64_bf16 v[40:43], v[52:55], v[64:71], v2
    ds_read_b128 v[64:67], v1 offset:12288
    ds_read_b128 v[68:71], v1 offset:13312
    v_smfmac_f32_16x16x64_bf16 v[32:35], v[52:55], v[160:167], v2
    v_smfmac_f32_16x16x64_bf16 v[36:39], v[52:55], v[168:175], v2
    s_waitcnt lgkmcnt(3)
    v_smfmac_f32_16x16x64_bf16 v[60:63], v[52:55], v[72:79], v2
    ds_read_b128 v[72:75], v1 offset:14336
    ds_read_b128 v[76:79], v1 offset:15360
    v_smfmac_f32_16x16x64_bf16 v[56:59], v[52:55], v[176:183], v2
    v_smfmac_f32_16x16x64_bf16 v[28:31], v[44:47], v[184:191], v2
    s_waitcnt lgkmcnt(2)
    v_smfmac_f32_16x16x64_bf16 v[40:43], v[44:47], v[64:71], v2
    ds_read_b128 v[64:67], v1 offset:16384
    ds_read_b128 v[68:71], v1 offset:17408
    v_smfmac_f32_16x16x64_bf16 v[32:35], v[44:47], v[192:199], v2
    v_smfmac_f32_16x16x64_bf16 v[36:39], v[44:47], v[200:207], v2
    v_smfmac_f32_16x16x64_bf16 v[60:63], v[44:47], v[208:215], v2
    v_smfmac_f32_16x16x64_bf16 v[56:59], v[44:47], v[216:223], v2
    s_cmp_eq_u32 s17, 0
    s_cbranch_scc1 L_cs_norem
    s_cmp_eq_u32 s3, 3
    s_cbranch_scc1 L_cs_remb
    s_mov_b32 s28, 0
    s_waitcnt vmcnt(4)
L_cs_chkr:
    v_max3_u32 v52, v80, v81, v82
    v_max3_u32 v53, v83, v84, v85
    v_max3_u32 v52, v52, v86, v87
    v_max_u32 v52, v52, v53
    v_cmp_eq_u32 vcc, -1, v52
    v_add_u32 v54, s15, v11
    s_cmp_eq_u64 vcc, 0
    s_cbranch_scc1 L_cs_gotr
    s_add_u32 s28, s28, 1
    s_add_u32 s74, s74, 1
    s_cmp_ge_u32 s28, 30000
    s_cselect_b32 s29, 1, s29
    s_cmp_lg_u32 s29, 0
    s_cbranch_scc1 L_cs_gotr
    buffer_load_dwordx4 v[80:83], v0, s[8:11], s34 offen sc1
    buffer_load_dwordx4 v[84:87], v0, s[8:11], s35 offen sc1
    s_waitcnt vmcnt(0)
    s_branch L_cs_chkr
L_cs_gotr:
    ds_write_b128 v54, v[80:83]
    s_cmp_eq_u32 s3, 2
    s_cbranch_scc1 L_cs_remb
    ds_write_b128 v54, v[84:87] offset:1024
L_cs_remb:
L_cs_norem:
    v_smfmac_f32_16x16x64_bf16 v[28:31], v[48:51], v[224:231], v2
    v_smfmac_f32_16x16x64_bf16 v[32:35], v[48:51], v[232:239], v2
    v_smfmac_f32_16x16x64_bf16 v[36:39], v[48:51], v[240:247], v2
    s_waitcnt lgkmcnt(0)
    s_barrier
    ds_read_b128 v[52:55], v0 offset:5120
    ds_read_b128 v[44:47], v0 offset:6144
    v_smfmac_f32_16x16x64_bf16 v[40:43], v[48:51], v[72:79], v2
    ds_read_b128 v[72:75], v1 offset:18432
    ds_read_b128 v[76:79], v1 offset:19456
    v_smfmac_f32_16x16x64_bf16 v[60:63], v[48:51], v[248:255], v2
    v_smfmac_f32_16x16x64_bf16 v[56:59], v[48:51], a[0:7], v2
    ds_read_b128 v[48:51], v0 offset:7168
    s_waitcnt lgkmcnt(4)
    v_smfmac_f32_16x16x64_bf16 v[28:31], v[52:55], a[8:15], v2
    v_smfmac_f32_16x16x64_bf16 v[40:43], v[52:55], v[64:71], v2
    ds_read_b128 v[64:67], v1 offset:20480
    ds_read_b128 v[68:71], v1 offset:21504
    v_smfmac_f32_16x16x64_bf16 v[32:35], v[52:55], a[16:23], v2
    v_smfmac_f32_16x16x64_bf16 v[36:39], v[52:55], a[24:31], v2
    ds_read_b128 v[52:55], v0 offset:8192
    s_waitcnt lgkmcnt(6)
    v_smfmac_f32_16x16x64_bf16 v[28:31], v[44:47], a[48:55], v2
    s_waitcnt lgkmcnt(4)
    v_smfmac_f32_16x16x64_bf16 v[40:43], v[44:47], v[72:79], v2
    ds_read_b128 v[72:75], v1 offset:22528
    ds_read_b128 v[76:79], v1 offset:23552
    v_smfmac_f32_16x16x64_bf16 v[32:35], v[44:47], a[56:63], v2
    v_smfmac_f32_16x16x64_bf16 v[36:39], v[44:47], a[64:71], v2
    ds_read_b128 v[44:47], v0 offset:9216
    s_waitcnt lgkmcnt(6)
    v_smfmac_f32_16x16x64_bf16 v[28:31], v[48:51], a[88:95], v2
    s_waitcnt lgkmcnt(4)
    v_smfmac_f32_16x16x64_bf16 v[40:43], v[48:51], v[64:71], v2
    ds_read_b128 v[64:67], v1 offset:24576
    ds_read_b128 v[68:71], v1 offset:25600
    v_smfmac_f32_16x16x64_bf16 v[32:35], v[48:51], a[96:103], v2
    v_smfmac_f32_16x16x64_bf16 v[36:39], v[48:51], a[104:111], v2
    s_waitcnt lgkmcnt(5)
    v_smfmac_f32_16x16x64_bf16 v[28:31], v[52:55], a[128:135], v2
    s_waitcnt lgkmcnt(3)
    v_smfmac_f32_16x16x64_bf16 v[40:43], v[52:55], v[72:79], v2
    ds_read_b128 v[76:79], v0 offset:6144
    v_smfmac_f32_16x16x64_bf16 v[32:35], v[52:55], a[136:143], v2
    v_smfmac_f32_16x16x64_bf16 v[36:39], v[52:55], a[144:151], v2
    s_waitcnt lgkmcnt(3)
    v_smfmac_f32_16x16x64_bf16 v[28:31], v[44:47], a[168:175], v2
    s_waitcnt lgkmcnt(1)
    v_smfmac_f32_16x16x64_bf16 v[40:43], v[44:47], v[64:71], v2
    ds_read_b128 v[68:71], v0 offset:5120
    v_smfmac_f32_16x16x64_bf16 v[32:35], v[44:47], a[176:183], v2
    v_smfmac_f32_16x16x64_bf16 v[36:39], v[44:47], a[184:191], v2
    v_smfmac_f32_16x16x64_bf16 v[56:59], v[48:51], a[112:119], v2
    v_smfmac_f32_16x16x64_bf16 v[60:63], v[48:51], a[120:127], v2
    v_add_f32 v28, v28, v29
    v_add_f32 v30, v30, v31
    v_add_f32 v32, v32, v33
    v_add_f32 v34, v34, v35
    v_add_f32 v36, v36, v37
    v_add_f32 v38, v38, v39
    v_add_f32 v40, v40, v41
    v_add_f32 v42, v42, v43
    v_cvt_pk_bf16_f32 v29, v28, v32
    v_cvt_pk_bf16_f32 v31, v30, v34
    ds_write2_b32 v3, v29, v31 offset0:0 offset1:16
    v_cvt_pk_bf16_f32 v37, v36, v40
    v_cvt_pk_bf16_f32 v39, v38, v42
    ds_write2_b32 v3, v37, v39 offset0:128 offset1:144
    ds_read_b128 v[28:31], v4
    ds_read_b128 v[32:35], v5
    v_smfmac_f32_16x16x64_bf16 v[56:59], v[52:55], a[152:159], v2
    v_smfmac_f32_16x16x64_bf16 v[60:63], v[52:55], a[160:167], v2
    v_smfmac_f32_16x16x64_bf16 v[56:59], v[44:47], a[192:199], v2
    v_smfmac_f32_16x16x64_bf16 v[60:63], v[44:47], a[200:207], v2
    s_waitcnt lgkmcnt(0)
    s_waitcnt vmcnt(0)
    v_mfma_f32_16x16x32_bf16 v[64:67], v[16:19], v[28:31], 0
    v_mfma_f32_16x16x32_bf16 v[40:43], v[12:15], v[28:31], 0
    v_mfma_f32_16x16x32_bf16 v[36:39], v[32:35], v[28:31], 0
    v_add_u32 v12, s47, v6
    v_smfmac_f32_16x16x64_bf16 v[56:59], v[68:71], a[32:39], v2
    s_mov_b64 exec, s[32:33]
    ds_write_b128 v12, v[64:67] offset:32
    ds_write_b128 v12, v[40:43] offset:16
    s_nop 0
    ds_write_b64 v12, v[36:37]
    s_mov_b64 exec, -1
    v_smfmac_f32_16x16x64_bf16 v[60:63], v[68:71], a[40:47], v2
    s_cmp_lg_u32 s3, 0
    s_cbranch_scc1 L_cs_nosig_37
    s_cmp_eq_u32 s17, 0
    s_cbranch_scc1 L_cs_nosig_37
    s_lshl_b32 s24, s17, 9
    s_add_u32 s24, s24, s57
    s_mov_b64 exec, 1
    buffer_atomic_add v2, off, s[8:11], s24
    s_mov_b64 exec, -1
L_cs_nosig_37:
    v_mov_b64 v[28:29], -1
    v_smfmac_f32_16x16x64_bf16 v[56:59], v[76:79], a[72:79], v2
    v_mov_b64 v[30:31], -1
    s_add_u32 s24, s20, 16384
    s_and_b32 s24, s24, 32767
    s_add_u32 s24, s24, s19
    v_smfmac_f32_16x16x64_bf16 v[60:63], v[76:79], a[80:87], v2
    s_add_u32 s24, s24, s46
    s_add_u32 s25, s24, s49
    s_cmp_eq_u32 s48, 0
    s_cbranch_scc1 L_cs_norm
    s_mov_b64 exec, 0xff
    buffer_store_dwordx4 v[28:31], v0, s[8:11], s24 offen sc1
    buffer_store_dwordx4 v[28:31], v0, s[8:11], s25 offen sc1
    s_mov_b64 exec, -1
L_cs_norm:
    s_waitcnt lgkmcnt(0)
    s_barrier
    ds_read_b64 v[36:37], v6
    ds_read_b64 v[38:39], v6 offset:1536
    ds_read_b128 v[40:43], v6 offset:16
    ds_read_b128 v[28:31], v6 offset:1552
    ds_read_b128 v[64:67], v6 offset:32
    ds_read_b128 v[68:71], v6 offset:1568
    s_cmp_lg_u32 s18, 0
    s_cbranch_scc1 L_cs_nokm
    buffer_store_dwordx4 v[32:35], v0, s[8:11], s30 offen sc1
L_cs_nokm:
    v_add_f32 v56, v56, v57
    v_add_f32 v58, v58, v59
    v_add_f32 v60, v60, v61
    v_add_f32 v62, v62, v63
    v_cvt_pk_bf16_f32 v56, v56, v58
    v_cvt_pk_bf16_f32 v57, v60, v62
    v_lshrrev_b32 v60, 1, v0
    v_mov_b32 v58, v57
    v_mov_b32 v59, v56
    s_cmp_lg_u32 s18, 1
    s_cbranch_scc1 L_cs_novm
    buffer_store_dwordx2 v[56:57], v60, s[8:11], s58 offen sc1
L_cs_novm:
    s_cmp_eq_u32 s17, 63
    s_cbranch_scc1 L_cs_done
    s_waitcnt lgkmcnt(4)
    v_pk_add_f32 v[36:37], v[36:37], v[38:39]
    s_waitcnt lgkmcnt(2)
    v_pk_add_f32 v[40:41], v[40:41], v[28:29]
    v_pk_add_f32 v[42:43], v[42:43], v[30:31]
    s_waitcnt lgkmcnt(0)
    v_pk_add_f32 v[64:65], v[64:65], v[68:69]
    v_pk_add_f32 v[66:67], v[66:67], v[70:71]
    ds_read_b128 v[80:83], v1 offset:26624
    ds_read_b128 v[84:87], v1 offset:27648
    v_add_f32_dpp v36, v36, v36 row_ror:8 row_mask:0xf bank_mask:0xf
    v_add_f32_dpp v37, v37, v37 row_ror:8 row_mask:0xf bank_mask:0xf
    v_add_f32_dpp v40, v40, v40 row_ror:8 row_mask:0xf bank_mask:0xf
    v_add_f32_dpp v41, v41, v41 row_ror:8 row_mask:0xf bank_mask:0xf
    v_add_f32_dpp v42, v42, v42 row_ror:8 row_mask:0xf bank_mask:0xf
    v_add_f32_dpp v43, v43, v43 row_ror:8 row_mask:0xf bank_mask:0xf
    v_add_f32_dpp v64, v64, v64 row_ror:8 row_mask:0xf bank_mask:0xf
    v_add_f32_dpp v65, v65, v65 row_ror:8 row_mask:0xf bank_mask:0xf
    v_add_f32_dpp v66, v66, v66 row_ror:8 row_mask:0xf bank_mask:0xf
    v_add_f32_dpp v67, v67, v67 row_ror:8 row_mask:0xf bank_mask:0xf
    v_max3_f32 v38, v36, v37, v40
    v_max3_f32 v39, v41, v42, v43
    v_max3_f32 v28, v64, v65, v66
    v_max3_f32 v38, v38, v39, v67
    v_max_f32 v38, v38, v28
    v_mov_b32 v39, v38
    v_mov_b32 v33, 0
    ds_read_b128 v[72:75], v1 offset:28672
    ds_read_b128 v[76:79], v1 offset:29696
    v_permlane32_swap_b32 v39, v38
    v_max_f32 v38, v38, v39
    v_mov_b32 v39, v38
    s_nop 1
    v_permlane16_swap_b32 v39, v38
    v_max_f32 v38, v38, v39
    v_mul_f32 v38, s31, v38
    v_pk_fma_f32 v[36:37], v[36:37], s[42:43], v[38:39] op_sel_hi:[1,1,0] neg_lo:[0,0,1] neg_hi:[0,0,1]
    v_pk_fma_f32 v[40:41], v[40:41], s[42:43], v[38:39] op_sel_hi:[1,1,0] neg_lo:[0,0,1] neg_hi:[0,0,1]
    v_pk_fma_f32 v[42:43], v[42:43], s[42:43], v[38:39] op_sel_hi:[1,1,0] neg_lo:[0,0,1] neg_hi:[0,0,1]
    v_pk_fma_f32 v[64:65], v[64:65], s[42:43], v[38:39] op_sel_hi:[1,1,0] neg_lo:[0,0,1] neg_hi:[0,0,1]
    v_pk_fma_f32 v[66:67], v[66:67], s[42:43], v[38:39] op_sel_hi:[1,1,0] neg_lo:[0,0,1] neg_hi:[0,0,1]
    v_exp_f32 v40, v40
    v_exp_f32 v41, v41
    v_exp_f32 v42, v42
    v_exp_f32 v43, v43
    v_exp_f32 v64, v64
    v_exp_f32 v65, v65
    v_exp_f32 v66, v66
    v_exp_f32 v67, v67
    v_cvt_pk_bf16_f32 v28, v40, v41
    v_cvt_pk_bf16_f32 v29, v42, v43
    v_exp_f32 v36, v36
    v_exp_f32 v37, v37
    v_cvt_pk_bf16_f32 v30, v64, v65
    v_cvt_pk_bf16_f32 v31, v66, v67
    v_pk_add_f32 v[34:35], v[40:41], v[42:43]
    v_pk_add_f32 v[38:39], v[64:65], v[66:67]
    v_cvt_pk_bf16_f32 v32, v36, v37
    v_pk_add_f32 v[34:35], v[34:35], v[38:39]
    v_pk_add_f32 v[34:35], v[34:35], v[36:37]
    v_mfma_f32_16x16x32_bf16 v[40:43], v[20:23], v[28:31], 0
    v_add_f32 v34, v34, v35
    v_mov_b32 v35, v34
    v_mfma_f32_16x16x32_bf16 v[64:67], v[24:27], v[28:31], 0
    v_mfma_f32_16x16x16_bf16 v[40:43], v[56:57], v[32:33], v[40:43]
    v_permlane32_swap_b32 v35, v34
    v_add_f32 v34, v34, v35
    v_mfma_f32_16x16x16_bf16 v[64:67], v[58:59], v[32:33], v[64:67]
    v_mov_b32 v35, v34
    ds_read_b128 v[56:59], v1 offset:30720
    ds_read_b128 v[60:63], v1 offset:31744
    v_permlane16_swap_b32 v35, v34
    v_add_f32 v34, v34, v35
    v_rcp_f32 v34, v34
    v_mov_b64 v[44:45], 0
    v_mov_b64 v[46:47], 0
    v_mov_b64 v[48:49], 0
    v_mov_b64 v[50:51], 0
    v_pk_mul_f32 v[40:41], v[40:41], v[34:35] op_sel_hi:[1,0]
    v_pk_mul_f32 v[42:43], v[42:43], v[34:35] op_sel_hi:[1,0]
    v_pk_mul_f32 v[64:65], v[64:65], v[34:35] op_sel_hi:[1,0]
    v_pk_mul_f32 v[66:67], v[66:67], v[34:35] op_sel_hi:[1,0]
    v_cvt_pk_bf16_f32 v32, v40, v41
    v_cvt_pk_bf16_f32 v33, v42, v43
    v_cvt_pk_bf16_f32 v34, v64, v65
    v_cvt_pk_bf16_f32 v35, v66, v67
    s_mov_b64 exec, s[32:33]
    ds_write_b128 v7, v[32:35]
    s_mov_b64 exec, -1
    ds_read_b128 v[64:67], v1 offset:32768
    ds_read_b128 v[68:71], v1 offset:33792
    v_mov_b64 v[36:37], 0
    v_mov_b64 v[38:39], 0
    v_mov_b64 v[40:41], 0
    v_mov_b64 v[42:43], 0
    v_mov_b64 v[12:13], 0
    v_mov_b64 v[14:15], 0
    v_mov_b64 v[16:17], 0
    v_mov_b64 v[18:19], 0
    v_mov_b64 v[52:53], -1
    v_mov_b64 v[54:55], -1
    v_and_b32 v29, 0x1f0, v0
    v_lshrrev_b32 v28, 9, v0
    v_lshlrev_b32 v28, 14, v28
    v_add_u32 v28, v28, v29
    s_add_u32 s24, s45, s41
    s_add_u32 s25, s24, s59
    buffer_store_dwordx4 v[52:55], v28, s[8:11], s24 offen sc1
    buffer_store_dwordx4 v[52:55], v29, s[8:11], s25 offen sc1
    s_waitcnt lgkmcnt(2)
    s_barrier
    ds_read_b128 v[28:31], v0 offset:0
    ds_read_b128 v[32:35], v0 offset:1024
    s_waitcnt lgkmcnt(1)
    v_smfmac_f32_16x16x64_bf16 v[36:39], v[28:31], a[208:215], v2
    v_smfmac_f32_16x16x64_bf16 v[40:43], v[28:31], v[80:87], v2
    ds_read_b128 v[80:83], v1 offset:34816
    ds_read_b128 v[84:87], v1 offset:35840
    s_waitcnt lgkmcnt(2)
    v_smfmac_f32_16x16x64_bf16 v[36:39], v[32:35], a[216:223], v2
    v_smfmac_f32_16x16x64_bf16 v[40:43], v[32:35], v[72:79], v2
    ds_read_b128 v[72:75], v1 offset:36864
    ds_read_b128 v[76:79], v1 offset:37888
    v_smfmac_f32_16x16x64_bf16 v[44:47], v[28:31], a[224:231], v2
    v_smfmac_f32_16x16x64_bf16 v[48:51], v[28:31], a[232:239], v2
    v_add_f32 v36, v36, v37
    v_add_f32 v38, v38, v39
    v_add_f32 v40, v40, v41
    v_add_f32 v42, v42, v43
    v_smfmac_f32_16x16x64_bf16 v[44:47], v[32:35], a[240:247], v2
    v_cvt_pk_bf16_f32 v52, v36, v40
    v_cvt_pk_bf16_f32 v53, v38, v42
    buffer_store_dwordx2 v[52:53], v8, s[8:11], s44 offen sc1
    v_smfmac_f32_16x16x64_bf16 v[48:51], v[32:35], a[248:255], v2
    s_cmp_eq_u32 s51, 0
    s_cbranch_scc1 L_cs_g2two
    v_smfmac_f32_16x16x64_bf16 v[12:15], v[28:31], v[56:63], v2
    v_smfmac_f32_16x16x64_bf16 v[16:19], v[28:31], v[64:71], v2
    v_add_f32 v44, v44, v45
    v_add_f32 v46, v46, v47
    v_add_f32 v48, v48, v49
    v_add_f32 v50, v50, v51
    s_waitcnt lgkmcnt(2)
    v_smfmac_f32_16x16x64_bf16 v[12:15], v[32:35], v[80:87], v2
    v_cvt_pk_bf16_f32 v54, v44, v48
    v_cvt_pk_bf16_f32 v55, v46, v50
    s_add_u32 s24, s44, 16384
    buffer_store_dwordx2 v[54:55], v8, s[8:11], s24 offen sc1
    s_waitcnt lgkmcnt(0)
    v_smfmac_f32_16x16x64_bf16 v[16:19], v[32:35], v[72:79], v2
    s_nop 1
    v_add_f32 v12, v12, v13
    v_add_f32 v14, v14, v15
    s_nop 3
    v_add_f32 v16, v16, v17
    v_add_f32 v18, v18, v19
    v_cvt_pk_bf16_f32 v52, v12, v16
    v_cvt_pk_bf16_f32 v53, v14, v18
    s_add_u32 s24, s44, 32768
    buffer_store_dwordx2 v[52:53], v8, s[8:11], s24 offen sc1
    s_branch L_cs_g2end
L_cs_g2two:
    s_nop 1
    v_add_f32 v44, v44, v45
    v_add_f32 v46, v46, v47
    s_nop 1
    v_add_f32 v48, v48, v49
    v_add_f32 v50, v50, v51
    v_cvt_pk_bf16_f32 v54, v44, v48
    v_cvt_pk_bf16_f32 v55, v46, v50
    s_add_u32 s24, s44, 16384
    buffer_store_dwordx2 v[54:55], v8, s[8:11], s24 offen sc1
L_cs_g2end:
    s_waitcnt lgkmcnt(0)
    s_add_u32 s26, s19, s20
    s_add_u32 s52, s26, s12
    s_add_u32 s53, s26, 4096
    s_add_u32 s34, s26, s50
    s_add_u32 s34, s34, s13
    s_add_u32 s35, s34, s14
    s_add_u32 s26, s26, s46
    s_add_u32 s27, s26, s49
    s_cmp_eq_u32 s48, 0
    s_cbranch_scc1 L_cs_hop2
    s_add_u32 s36, s40, s21
    s_add_u32 s37, s36, 4096
    s_add_u32 s38, s36, 8192
    s_add_u32 s39, s36, 12288
    v_lshrrev_b32 v52, 4, v0
    v_and_b32 v52, 15, v52
    v_lshrrev_b32 v53, 1, v52
    v_and_b32 v54, 1, v52
    v_mov_b32 v55, 0x3f80
    v_lshlrev_b32 v54, 4, v54
    v_lshlrev_b32 v55, v54, v55
    v_cmp_eq_u32 vcc, 0, v53
    s_nop 1
    v_cndmask_b32 v44, 0, v55, vcc
    v_cmp_eq_u32 vcc, 1, v53
    s_nop 1
    v_cndmask_b32 v45, 0, v55, vcc
    v_cmp_eq_u32 vcc, 2, v53
    s_nop 1
    v_cndmask_b32 v46, 0, v55, vcc
    v_cmp_eq_u32 vcc, 3, v53
    s_nop 1
    v_cndmask_b32 v47, 0, v55, vcc
    s_mov_b32 s28, 0
    buffer_load_dwordx4 v[64:67], v9, s[8:11], s36 offen sc1
    buffer_load_dwordx4 v[68:71], v9, s[8:11], s37 offen sc1
    buffer_load_dwordx4 v[72:75], v9, s[8:11], s38 offen sc1
    buffer_load_dwordx4 v[76:79], v9, s[8:11], s39 offen sc1
    s_add_u32 s17, s17, 1
    s_add_u32 s30, s30, 131072
    s_add_u32 s58, s58, 65536
    s_add_u32 s22, s22, 262144
    s_add_u32 s23, s23, 262144
    s_add_u32 s21, s21, 163840
    s_cmp_eq_u32 s21, 491520
    s_cselect_b32 s21, 0, s21
    s_add_u32 s41, s41, 163840
    s_cmp_eq_u32 s41, 491520
    s_cselect_b32 s41, 0, s41
    s_add_u32 s44, s45, s21
    s_add_u32 s20, s20, 8192
    s_and_b32 s20, s20, 32767
    v_mov_b64 v[28:29], 0
    v_mov_b64 v[30:31], 0
    v_mov_b64 v[32:33], 0
    v_mov_b64 v[34:35], 0
    v_mov_b64 v[36:37], 0
    v_mov_b64 v[38:39], 0
    v_mov_b64 v[40:41], 0
    v_mov_b64 v[42:43], 0
    v_mov_b64 v[56:57], 0
    v_mov_b64 v[58:59], 0
    v_mov_b64 v[60:61], 0
    v_mov_b64 v[62:63], 0
    buffer_load_dwordx4 v[12:15], v9, s[8:11], s36 offen sc1
    buffer_load_dwordx4 v[16:19], v9, s[8:11], s37 offen sc1
    buffer_load_dwordx4 v[20:23], v9, s[8:11], s38 offen sc1
    buffer_load_dwordx4 v[24:27], v9, s[8:11], s39 offen sc1
L_cs_poll1:
    s_waitcnt vmcnt(7)
    v_mfma_f32_16x16x32_bf16 v[48:51], v[44:47], v[64:67], 0
    s_waitcnt vmcnt(6)
    v_mfma_f32_16x16x32_bf16 v[48:51], v[44:47], v[68:71], v[48:51]
    s_waitcnt vmcnt(5)
    v_mfma_f32_16x16x32_bf16 v[48:51], v[44:47], v[72:75], v[48:51]
    s_waitcnt vmcnt(4)
    v_mfma_f32_16x16x32_bf16 v[48:51], v[44:47], v[76:79], v[48:51]
    s_add_u32 s28, s28, 1
    s_add_u32 s72, s72, 1
    s_cmp_ge_u32 s28, 30000
    s_cselect_b32 s29, 1, s29
    s_nop 3
    v_cmp_u_f32 vcc, v48, v48
    v_add_f32_dpp v48, v48, v48 row_ror:8 row_mask:0xf bank_mask:0xf
    v_add_f32_dpp v49, v49, v49 row_ror:8 row_mask:0xf bank_mask:0xf
    v_add_f32_dpp v50, v50, v50 row_ror:8 row_mask:0xf bank_mask:0xf
    v_add_f32_dpp v51, v51, v51 row_ror:8 row_mask:0xf bank_mask:0xf
    s_cmp_eq_u64 vcc, 0
    s_cbranch_scc1 L_cs_got1
    s_cmp_lg_u32 s29, 0
    s_cbranch_scc1 L_cs_got1
    buffer_load_dwordx4 v[64:67], v9, s[8:11], s36 offen sc1
    buffer_load_dwordx4 v[68:71], v9, s[8:11], s37 offen sc1
    buffer_load_dwordx4 v[72:75], v9, s[8:11], s38 offen sc1
    buffer_load_dwordx4 v[76:79], v9, s[8:11], s39 offen sc1
    s_waitcnt vmcnt(7)
    v_mfma_f32_16x16x32_bf16 v[48:51], v[44:47], v[12:15], 0
    s_waitcnt vmcnt(6)
    v_mfma_f32_16x16x32_bf16 v[48:51], v[44:47], v[16:19], v[48:51]
    s_waitcnt vmcnt(5)
    v_mfma_f32_16x16x32_bf16 v[48:51], v[44:47], v[20:23], v[48:51]
    s_waitcnt vmcnt(4)
    v_mfma_f32_16x16x32_bf16 v[48:51], v[44:47], v[24:27], v[48:51]
    s_add_u32 s28, s28, 1
    s_add_u32 s72, s72, 1
    s_cmp_ge_u32 s28, 30000
    s_cselect_b32 s29, 1, s29
    s_nop 3
    v_cmp_u_f32 vcc, v48, v48
    v_add_f32_dpp v48, v48, v48 row_ror:8 row_mask:0xf bank_mask:0xf
    v_add_f32_dpp v49, v49, v49 row_ror:8 row_mask:0xf bank_mask:0xf
    v_add_f32_dpp v50, v50, v50 row_ror:8 row_mask:0xf bank_mask:0xf
    v_add_f32_dpp v51, v51, v51 row_ror:8 row_mask:0xf bank_mask:0xf
    s_cmp_eq_u64 vcc, 0
    s_cbranch_scc1 L_cs_got1
    s_cmp_lg_u32 s29, 0
    s_cbranch_scc1 L_cs_got1
    buffer_load_dwordx4 v[12:15], v9, s[8:11], s36 offen sc1
    buffer_load_dwordx4 v[16:19], v9, s[8:11], s37 offen sc1
    buffer_load_dwordx4 v[20:23], v9, s[8:11], s38 offen sc1
    buffer_load_dwordx4 v[24:27], v9, s[8:11], s39 offen sc1
    s_branch L_cs_poll1
L_cs_got1:
    v_cvt_pk_bf16_f32 v52, v48, v49
    v_cvt_pk_bf16_f32 v53, v50, v51
    s_nop 1
    v_permlane16_swap_b32 v52, v53
    s_mov_b64 exec, 0x00ff00ff
    buffer_store_dwordx2 v[52:53], v10, s[8:11], s27 offen sc1
    buffer_store_dwordx2 v[52:53], v10, s[8:11], s26 offen sc1
    s_mov_b64 exec, -1
    s_branch L_cs_pubd
L_cs_hop2:
    s_cmp_lt_u32 s3, 2
    s_cbranch_scc1 L_cs_w1nr
    s_add_u32 s36, s17, 1
    s_cmp_lt_u32 s36, s54
    s_cbranch_scc1 L_cst23_kvok
    s_mov_b32 s28, 0
    s_lshl_b32 s24, s36, 9
    s_add_u32 s24, s24, 69206016
    s_add_u32 s25, s36, 7
    s_min_u32 s25, s25, 63
    s_lshl_b32 s25, s25, 9
    s_add_u32 s25, s25, 69206016
L_cst23_kvp:
    buffer_load_dword v78, off, s[8:11], s24 sc1
    buffer_load_dword v79, off, s[8:11], s25 sc1
    s_add_u32 s28, s28, 1
    s_waitcnt vmcnt(0)
    v_readfirstlane_b32 s26, v78
    v_readfirstlane_b32 s27, v79
    s_cmp_ge_u32 s28, 200000
    s_cbranch_scc1 L_cst23_kvall
    s_cmp_ge_u32 s27, 32
    s_cbranch_scc1 L_cst23_kvall
    s_cmp_lt_u32 s26, 32
    s_cbranch_scc1 L_cst23_kvp
    s_add_u32 s54, s36, 1
    s_branch L_cst23_kvok
L_cst23_kvall:
    s_add_u32 s54, s36, 8
L_cst23_kvok:
    s_branch L_cs_pubd
L_cs_w1nr:
    s_add_u32 s17, s17, 1
    s_add_u32 s30, s30, 131072
    s_add_u32 s58, s58, 65536
    s_add_u32 s22, s22, 262144
    s_add_u32 s23, s23, 262144
    s_add_u32 s21, s21, 163840
    s_cmp_eq_u32 s21, 491520
    s_cselect_b32 s21, 0, s21
    s_add_u32 s41, s41, 163840
    s_cmp_eq_u32 s41, 491520
    s_cselect_b32 s41, 0, s41
    s_add_u32 s44, s45, s21
    s_add_u32 s20, s20, 8192
    s_and_b32 s20, s20, 32767
    v_mov_b64 v[28:29], 0
    v_mov_b64 v[30:31], 0
    v_mov_b64 v[32:33], 0
    v_mov_b64 v[34:35], 0
    v_mov_b64 v[36:37], 0
    v_mov_b64 v[38:39], 0
    v_mov_b64 v[40:41], 0
    v_mov_b64 v[42:43], 0
    v_mov_b64 v[56:57], 0
    v_mov_b64 v[58:59], 0
    v_mov_b64 v[60:61], 0
    v_mov_b64 v[62:63], 0
L_cs_pubd:
    s_barrier
    s_cmp_eq_u32 s3, 2
    s_cbranch_scc1 L_cs_gw2
    s_cmp_eq_u32 s3, 3
    s_cbranch_scc1 L_cs_gw3
    s_barrier
    buffer_load_dwordx4 v[80:83], v0, s[8:11], s34 offen sc1
    buffer_load_dwordx4 v[84:87], v0, s[8:11], s35 offen sc1
    s_waitcnt vmcnt(4)
    s_branch L_cs_got2
L_cs_gw2:
    s_add_u32 s17, s17, 1
    s_add_u32 s30, s30, 131072
    s_add_u32 s58, s58, 65536
    s_add_u32 s22, s22, 262144
    s_add_u32 s23, s23, 262144
    s_add_u32 s21, s21, 163840
    s_cmp_eq_u32 s21, 491520
    s_cselect_b32 s21, 0, s21
    s_add_u32 s41, s41, 163840
    s_cmp_eq_u32 s41, 491520
    s_cselect_b32 s41, 0, s41
    s_add_u32 s44, s45, s21
    s_add_u32 s20, s20, 8192
    s_and_b32 s20, s20, 32767
    v_mov_b64 v[28:29], 0
    v_mov_b64 v[30:31], 0
    v_mov_b64 v[32:33], 0
    v_mov_b64 v[34:35], 0
    v_mov_b64 v[36:37], 0
    v_mov_b64 v[38:39], 0
    v_mov_b64 v[40:41], 0
    v_mov_b64 v[42:43], 0
    v_mov_b64 v[56:57], 0
    v_mov_b64 v[58:59], 0
    v_mov_b64 v[60:61], 0
    v_mov_b64 v[62:63], 0
    s_mov_b32 s28, 0
L_cs_p2w2:
    buffer_load_dwordx4 v[44:47], v0, s[8:11], s52 offen sc1
    buffer_load_dwordx4 v[48:51], v0, s[8:11], s52 offen offset:1024 sc1
    buffer_load_dwordx4 v[52:55], v0, s[8:11], s53 offen sc1
    s_add_u32 s28, s28, 1
    s_add_u32 s73, s73, 1
    s_cmp_ge_u32 s28, 30000
    s_cselect_b32 s29, 1, s29
    s_waitcnt vmcnt(0)
    v_max3_u32 v76, v44, v45, v46
    v_max3_u32 v77, v47, v48, v49
    v_max3_u32 v76, v76, v50, v51
    v_max3_u32 v77, v77, v52, v53
    v_max3_u32 v76, v76, v54, v55
    v_max_u32 v76, v76, v77
    v_cmp_eq_u32 vcc, -1, v76
    v_add_u32 v78, s56, v11
    s_cmp_eq_u64 vcc, 0
    s_cbranch_scc1 L_cs_g2aw2
    s_cmp_lg_u32 s29, 0
    s_cbranch_scc1 L_cs_g2aw2
    s_branch L_cs_p2w2
L_cs_g2aw2:
    s_barrier
    ds_write_b128 v78, v[44:47]
    ds_write_b128 v78, v[48:51] offset:1024
    ds_write_b128 v78, v[52:55] offset:4096
    buffer_load_dwordx4 v[80:83], v0, s[8:11], s34 offen sc1
    buffer_load_dwordx4 v[84:87], v0, s[8:11], s35 offen sc1
    s_waitcnt lgkmcnt(0)
    s_branch L_cs_got2
L_cs_gw3:
    s_add_u32 s17, s17, 1
    s_add_u32 s30, s30, 131072
    s_add_u32 s58, s58, 65536
    s_add_u32 s22, s22, 262144
    s_add_u32 s23, s23, 262144
    s_add_u32 s21, s21, 163840
    s_cmp_eq_u32 s21, 491520
    s_cselect_b32 s21, 0, s21
    s_add_u32 s41, s41, 163840
    s_cmp_eq_u32 s41, 491520
    s_cselect_b32 s41, 0, s41
    s_add_u32 s44, s45, s21
    s_add_u32 s20, s20, 8192
    s_and_b32 s20, s20, 32767
    v_mov_b64 v[28:29], 0
    v_mov_b64 v[30:31], 0
    v_mov_b64 v[32:33], 0
    v_mov_b64 v[34:35], 0
    v_mov_b64 v[36:37], 0
    v_mov_b64 v[38:39], 0
    v_mov_b64 v[40:41], 0
    v_mov_b64 v[42:43], 0
    v_mov_b64 v[56:57], 0
    v_mov_b64 v[58:59], 0
    v_mov_b64 v[60:61], 0
    v_mov_b64 v[62:63], 0
    s_mov_b32 s28, 0
L_cs_p2w3:
    buffer_load_dwordx4 v[44:47], v0, s[8:11], s52 offen sc1
    buffer_load_dwordx4 v[48:51], v0, s[8:11], s52 offen offset:1024 sc1
    s_add_u32 s28, s28, 1
    s_add_u32 s73, s73, 1
    s_cmp_ge_u32 s28, 30000
    s_cselect_b32 s29, 1, s29
    s_waitcnt vmcnt(0)
    v_max3_u32 v76, v44, v45, v46
    v_max3_u32 v77, v47, v48, v49
    v_max3_u32 v76, v76, v50, v51
    v_max_u32 v76, v76, v77
    v_cmp_eq_u32 vcc, -1, v76
    v_add_u32 v78, s56, v11
    s_cmp_eq_u64 vcc, 0
    s_cbranch_scc1 L_cs_g2aw3
    s_cmp_lg_u32 s29, 0
    s_cbranch_scc1 L_cs_g2aw3
    s_branch L_cs_p2w3
L_cs_g2aw3:
    s_barrier
    ds_write_b128 v78, v[44:47]
    ds_write_b128 v78, v[48:51] offset:1024
    s_waitcnt lgkmcnt(0)
    s_branch L_cs_got2
L_cs_got2:
    ds_read_b128 v[64:67], v1 offset:0
    ds_read_b128 v[68:71], v1 offset:1024
    ds_read_b128 v[72:75], v1 offset:2048
    ds_read_b128 v[76:79], v1 offset:3072
    s_barrier
    s_branch L_cs_step
L_cs_done:
    s_waitcnt vmcnt(0)
    s_barrier
    s_cmp_lg_u32 s3, 0
    s_cbranch_scc1 L_cs_nofin
    s_add_u32 s24, s57, 32768
    s_mov_b64 exec, 1
    buffer_atomic_add v2, off, s[8:11], s24
    s_mov_b64 exec, -1
L_cs_nofin:
L_ch_fin:
    s_waitcnt vmcnt(0)
    s_branch L_end
L_worker:
    s_cmp_eq_u32 s17, 7
    s_cbranch_scc1 L_end
    s_cmp_lg_u32 s17, 2
    s_cbranch_scc1 L_w_post
    s_mov_b32 s19, s16
    s_mov_b32 s18, 0
    s_mov_b32 s63, 0
    s_lshr_b32 s40, s19, 4
    s_mov_b32 s41, 24
    s_cmp_eq_u32 s40, 1
    s_cselect_b32 s41, 32, s41
    s_cmp_eq_u32 s40, 2
    s_cselect_b32 s41, 16, s41
    s_add_u32 s42, s0, s41
    s_addc_u32 s43, s1, 0
    s_load_dwordx2 s[44:45], s[42:43], 0
    s_and_b32 s46, s19, 15
    s_waitcnt lgkmcnt(0)
    s_mov_b32 s20, s44
    s_mov_b32 s21, s45
    s_mov_b32 s22, 0x500000
    s_mov_b32 s23, 0x20000
    v_and_b32 v1, 63, v0
    v_lshrrev_b32 v2, 5, v0
    v_and_b32 v3, 31, v0
    v_lshlrev_b32 v4, 13, v2
    v_lshlrev_b32 v5, 4, v3
    v_add_u32 v4, v4, v5
    s_lshl_b32 s47, s46, 9
    v_add_u32 v4, s47, v4
    v_mul_u32_u24 v6, 576, v2
    v_add_u32 v6, v6, v5
    v_and_b32 v7, 15, v1
    v_lshrrev_b32 v8, 2, v7
    v_lshrrev_b32 v9, 5, v1
    v_lshlrev_b32 v9, 3, v9
    v_add_u32 v8, v8, v9
    v_mul_u32_u24 v8, 576, v8
    v_and_b32 v9, 3, v7
    v_lshlrev_b32 v9, 3, v9
    v_add_u32 v8, v8, v9
    v_bfe_u32 v9, v1, 4, 1
    v_lshlrev_b32 v9, 5, v9
    v_add_u32 v8, v8, v9
    s_lshl_b32 s47, s3, 7
    v_add_u32 v8, s47, v8
    s_mov_b32 s48, 0
    buffer_load_dwordx4 v[20:23], v4, s[20:23], s48 offen
    s_add_u32 s48, s48, 65536
    buffer_load_dwordx4 v[24:27], v4, s[20:23], s48 offen
    s_add_u32 s48, s48, 65536
    buffer_load_dwordx4 v[28:31], v4, s[20:23], s48 offen
    s_add_u32 s48, s48, 65536
    buffer_load_dwordx4 v[32:35], v4, s[20:23], s48 offen
    s_add_u32 s48, s48, 65536
    buffer_load_dwordx4 v[36:39], v4, s[20:23], s48 offen
    s_add_u32 s48, s48, 65536
    buffer_load_dwordx4 v[40:43], v4, s[20:23], s48 offen
    s_add_u32 s48, s48, 65536
    buffer_load_dwordx4 v[44:47], v4, s[20:23], s48 offen
    s_add_u32 s48, s48, 65536
    buffer_load_dwordx4 v[48:51], v4, s[20:23], s48 offen
    s_add_u32 s48, s48, 65536
    buffer_load_dwordx4 v[52:55], v4, s[20:23], s48 offen
    s_add_u32 s48, s48, 65536
    buffer_load_dwordx4 v[56:59], v4, s[20:23], s48 offen
    s_add_u32 s48, s48, 65536
    buffer_load_dwordx4 v[60:63], v4, s[20:23], s48 offen
    s_add_u32 s48, s48, 65536
    buffer_load_dwordx4 v[64:67], v4, s[20:23], s48 offen
    s_add_u32 s48, s48, 65536
    buffer_load_dwordx4 v[68:71], v4, s[20:23], s48 offen
    s_add_u32 s48, s48, 65536
    buffer_load_dwordx4 v[72:75], v4, s[20:23], s48 offen
    s_add_u32 s48, s48, 65536
    buffer_load_dwordx4 v[76:79], v4, s[20:23], s48 offen
    s_add_u32 s48, s48, 65536
    buffer_load_dwordx4 v[80:83], v4, s[20:23], s48 offen
    s_add_u32 s48, s48, 65536
    buffer_load_dwordx4 v[84:87], v4, s[20:23], s48 offen
    s_add_u32 s48, s48, 65536
    buffer_load_dwordx4 v[88:91], v4, s[20:23], s48 offen
    s_add_u32 s48, s48, 65536
    buffer_load_dwordx4 v[92:95], v4, s[20:23], s48 offen
    s_add_u32 s48, s48, 65536
    buffer_load_dwordx4 v[96:99], v4, s[20:23], s48 offen
    s_add_u32 s48, s48, 65536
    buffer_load_dwordx4 v[100:103], v4, s[20:23], s48 offen
    s_add_u32 s48, s48, 65536
    buffer_load_dwordx4 v[104:107], v4, s[20:23], s48 offen
    s_add_u32 s48, s48, 65536
    buffer_load_dwordx4 v[108:111], v4, s[20:23], s48 offen
    s_add_u32 s48, s48, 65536
    buffer_load_dwordx4 v[112:115], v4, s[20:23], s48 offen
    s_add_u32 s48, s48, 65536
    s_waitcnt vmcnt(20)
    ds_write_b128 v6, v[20:23] offset:0
    ds_write_b128 v6, v[24:27] offset:4608
    ds_write_b128 v6, v[28:31] offset:9216
    ds_write_b128 v6, v[32:35] offset:13824
    buffer_load_dwordx4 v[20:23], v4, s[20:23], s48 offen
    s_add_u32 s48, s48, 65536
    buffer_load_dwordx4 v[24:27], v4, s[20:23], s48 offen
    s_add_u32 s48, s48, 65536
    buffer_load_dwordx4 v[28:31], v4, s[20:23], s48 offen
    s_add_u32 s48, s48, 65536
    buffer_load_dwordx4 v[32:35], v4, s[20:23], s48 offen
    s_add_u32 s48, s48, 65536
    s_waitcnt lgkmcnt(0)
    s_barrier
    ds_read_b64_tr_b16 a[0:1], v8 offset:0
    ds_read_b64_tr_b16 a[2:3], v8 offset:2304
    ds_read_b64_tr_b16 a[160:161], v8 offset:64
    ds_read_b64_tr_b16 a[162:163], v8 offset:2368
    ds_read_b64_tr_b16 a[4:5], v8 offset:9216
    ds_read_b64_tr_b16 a[6:7], v8 offset:11520
    ds_read_b64_tr_b16 a[164:165], v8 offset:9280
    ds_read_b64_tr_b16 a[166:167], v8 offset:11584
    s_waitcnt vmcnt(20)
    ds_write_b128 v6, v[36:39] offset:18432
    ds_write_b128 v6, v[40:43] offset:23040
    ds_write_b128 v6, v[44:47] offset:27648
    ds_write_b128 v6, v[48:51] offset:32256
    buffer_load_dwordx4 v[36:39], v4, s[20:23], s48 offen
    s_add_u32 s48, s48, 65536
    buffer_load_dwordx4 v[40:43], v4, s[20:23], s48 offen
    s_add_u32 s48, s48, 65536
    buffer_load_dwordx4 v[44:47], v4, s[20:23], s48 offen
    s_add_u32 s48, s48, 65536
    buffer_load_dwordx4 v[48:51], v4, s[20:23], s48 offen
    s_add_u32 s48, s48, 65536
    s_waitcnt lgkmcnt(0)
    s_barrier
    ds_read_b64_tr_b16 a[8:9], v8 offset:18432
    ds_read_b64_tr_b16 a[10:11], v8 offset:20736
    ds_read_b64_tr_b16 a[168:169], v8 offset:18496
    ds_read_b64_tr_b16 a[170:171], v8 offset:20800
    ds_read_b64_tr_b16 a[12:13], v8 offset:27648
    ds_read_b64_tr_b16 a[14:15], v8 offset:29952
    ds_read_b64_tr_b16 a[172:173], v8 offset:27712
    ds_read_b64_tr_b16 a[174:175], v8 offset:30016
    s_waitcnt vmcnt(20)
    ds_write_b128 v6, v[52:55] offset:0
    ds_write_b128 v6, v[56:59] offset:4608
    ds_write_b128 v6, v[60:63] offset:9216
    ds_write_b128 v6, v[64:67] offset:13824
    buffer_load_dwordx4 v[52:55], v4, s[20:23], s48 offen
    s_add_u32 s48, s48, 65536
    buffer_load_dwordx4 v[56:59], v4, s[20:23], s48 offen
    s_add_u32 s48, s48, 65536
    buffer_load_dwordx4 v[60:63], v4, s[20:23], s48 offen
    s_add_u32 s48, s48, 65536
    buffer_load_dwordx4 v[64:67], v4, s[20:23], s48 offen
    s_add_u32 s48, s48, 65536
    s_waitcnt lgkmcnt(0)
    s_barrier
    ds_read_b64_tr_b16 a[16:17], v8 offset:0
    ds_read_b64_tr_b16 a[18:19], v8 offset:2304
    ds_read_b64_tr_b16 a[176:177], v8 offset:64
    ds_read_b64_tr_b16 a[178:179], v8 offset:2368
    ds_read_b64_tr_b16 a[20:21], v8 offset:9216
    ds_read_b64_tr_b16 a[22:23], v8 offset:11520
    ds_read_b64_tr_b16 a[180:181], v8 offset:9280
    ds_read_b64_tr_b16 a[182:183], v8 offset:11584
    s_waitcnt vmcnt(20)
    ds_write_b128 v6, v[68:71] offset:18432
    ds_write_b128 v6, v[72:75] offset:23040
    ds_write_b128 v6, v[76:79] offset:27648
    ds_write_b128 v6, v[80:83] offset:32256
    buffer_load_dwordx4 v[68:71], v4, s[20:23], s48 offen
    s_add_u32 s48, s48, 65536
    buffer_load_dwordx4 v[72:75], v4, s[20:23], s48 offen
    s_add_u32 s48, s48, 65536
    buffer_load_dwordx4 v[76:79], v4, s[20:23], s48 offen
    s_add_u32 s48, s48, 65536
    buffer_load_dwordx4 v[80:83], v4, s[20:23], s48 offen
    s_add_u32 s48, s48, 65536
    s_waitcnt lgkmcnt(0)
    s_barrier
    ds_read_b64_tr_b16 a[24:25], v8 offset:18432
    ds_read_b64_tr_b16 a[26:27], v8 offset:20736
    ds_read_b64_tr_b16 a[184:185], v8 offset:18496
    ds_read_b64_tr_b16 a[186:187], v8 offset:20800
    ds_read_b64_tr_b16 a[28:29], v8 offset:27648
    ds_read_b64_tr_b16 a[30:31], v8 offset:29952
    ds_read_b64_tr_b16 a[188:189], v8 offset:27712
    ds_read_b64_tr_b16 a[190:191], v8 offset:30016
    s_waitcnt vmcnt(20)
    ds_write_b128 v6, v[84:87] offset:0
    ds_write_b128 v6, v[88:91] offset:4608
    ds_write_b128 v6, v[92:95] offset:9216
    ds_write_b128 v6, v[96:99] offset:13824
    buffer_load_dwordx4 v[84:87], v4, s[20:23], s48 offen
    s_add_u32 s48, s48, 65536
    buffer_load_dwordx4 v[88:91], v4, s[20:23], s48 offen
    s_add_u32 s48, s48, 65536
    buffer_load_dwordx4 v[92:95], v4, s[20:23], s48 offen
    s_add_u32 s48, s48, 65536
    buffer_load_dwordx4 v[96:99], v4, s[20:23], s48 offen
    s_add_u32 s48, s48, 65536
    s_waitcnt lgkmcnt(0)
    s_barrier
    ds_read_b64_tr_b16 a[32:33], v8 offset:0
    ds_read_b64_tr_b16 a[34:35], v8 offset:2304
    ds_read_b64_tr_b16 a[192:193], v8 offset:64
    ds_read_b64_tr_b16 a[194:195], v8 offset:2368
    ds_read_b64_tr_b16 a[36:37], v8 offset:9216
    ds_read_b64_tr_b16 a[38:39], v8 offset:11520
    ds_read_b64_tr_b16 a[196:197], v8 offset:9280
    ds_read_b64_tr_b16 a[198:199], v8 offset:11584
    s_waitcnt vmcnt(20)
    ds_write_b128 v6, v[100:103] offset:18432
    ds_write_b128 v6, v[104:107] offset:23040
    ds_write_b128 v6, v[108:111] offset:27648
    ds_write_b128 v6, v[112:115] offset:32256
    buffer_load_dwordx4 v[100:103], v4, s[20:23], s48 offen
    s_add_u32 s48, s48, 65536
    buffer_load_dwordx4 v[104:107], v4, s[20:23], s48 offen
    s_add_u32 s48, s48, 65536
    buffer_load_dwordx4 v[108:111], v4, s[20:23], s48 offen
    s_add_u32 s48, s48, 65536
    buffer_load_dwordx4 v[112:115], v4, s[20:23], s48 offen
    s_add_u32 s48, s48, 65536
    s_waitcnt lgkmcnt(0)
    s_barrier
    ds_read_b64_tr_b16 a[40:41], v8 offset:18432
    ds_read_b64_tr_b16 a[42:43], v8 offset:20736
    ds_read_b64_tr_b16 a[200:201], v8 offset:18496
    ds_read_b64_tr_b16 a[202:203], v8 offset:20800
    ds_read_b64_tr_b16 a[44:45], v8 offset:27648
    ds_read_b64_tr_b16 a[46:47], v8 offset:29952
    ds_read_b64_tr_b16 a[204:205], v8 offset:27712
    ds_read_b64_tr_b16 a[206:207], v8 offset:30016
    s_waitcnt vmcnt(20)
    ds_write_b128 v6, v[20:23] offset:0
    ds_write_b128 v6, v[24:27] offset:4608
    ds_write_b128 v6, v[28:31] offset:9216
    ds_write_b128 v6, v[32:35] offset:13824
    buffer_load_dwordx4 v[20:23], v4, s[20:23], s48 offen
    s_add_u32 s48, s48, 65536
    buffer_load_dwordx4 v[24:27], v4, s[20:23], s48 offen
    s_add_u32 s48, s48, 65536
    buffer_load_dwordx4 v[28:31], v4, s[20:23], s48 offen
    s_add_u32 s48, s48, 65536
    buffer_load_dwordx4 v[32:35], v4, s[20:23], s48 offen
    s_add_u32 s48, s48, 65536
    s_waitcnt lgkmcnt(0)
    s_barrier
    ds_read_b64_tr_b16 a[48:49], v8 offset:0
    ds_read_b64_tr_b16 a[50:51], v8 offset:2304
    ds_read_b64_tr_b16 a[208:209], v8 offset:64
    ds_read_b64_tr_b16 a[210:211], v8 offset:2368
    ds_read_b64_tr_b16 a[52:53], v8 offset:9216
    ds_read_b64_tr_b16 a[54:55], v8 offset:11520
    ds_read_b64_tr_b16 a[212:213], v8 offset:9280
    ds_read_b64_tr_b16 a[214:215], v8 offset:11584
    s_waitcnt vmcnt(20)
    ds_write_b128 v6, v[36:39] offset:18432
    ds_write_b128 v6, v[40:43] offset:23040
    ds_write_b128 v6, v[44:47] offset:27648
    ds_write_b128 v6, v[48:51] offset:32256
    buffer_load_dwordx4 v[36:39], v4, s[20:23], s48 offen
    s_add_u32 s48, s48, 65536
    buffer_load_dwordx4 v[40:43], v4, s[20:23], s48 offen
    s_add_u32 s48, s48, 65536
    buffer_load_dwordx4 v[44:47], v4, s[20:23], s48 offen
    s_add_u32 s48, s48, 65536
    buffer_load_dwordx4 v[48:51], v4, s[20:23], s48 offen
    s_add_u32 s48, s48, 65536
    s_waitcnt lgkmcnt(0)
    s_barrier
    ds_read_b64_tr_b16 a[56:57], v8 offset:18432
    ds_read_b64_tr_b16 a[58:59], v8 offset:20736
    ds_read_b64_tr_b16 a[216:217], v8 offset:18496
    ds_read_b64_tr_b16 a[218:219], v8 offset:20800
    ds_read_b64_tr_b16 a[60:61], v8 offset:27648
    ds_read_b64_tr_b16 a[62:63], v8 offset:29952
    ds_read_b64_tr_b16 a[220:221], v8 offset:27712
    ds_read_b64_tr_b16 a[222:223], v8 offset:30016
    s_waitcnt vmcnt(20)
    ds_write_b128 v6, v[52:55] offset:0
    ds_write_b128 v6, v[56:59] offset:4608
    ds_write_b128 v6, v[60:63] offset:9216
    ds_write_b128 v6, v[64:67] offset:13824
    buffer_load_dwordx4 v[52:55], v4, s[20:23], s48 offen
    s_add_u32 s48, s48, 65536
    buffer_load_dwordx4 v[56:59], v4, s[20:23], s48 offen
    s_add_u32 s48, s48, 65536
    buffer_load_dwordx4 v[60:63], v4, s[20:23], s48 offen
    s_add_u32 s48, s48, 65536
    buffer_load_dwordx4 v[64:67], v4, s[20:23], s48 offen
    s_add_u32 s48, s48, 65536
    s_waitcnt lgkmcnt(0)
    s_barrier
    ds_read_b64_tr_b16 a[64:65], v8 offset:0
    ds_read_b64_tr_b16 a[66:67], v8 offset:2304
    ds_read_b64_tr_b16 a[224:225], v8 offset:64
    ds_read_b64_tr_b16 a[226:227], v8 offset:2368
    ds_read_b64_tr_b16 a[68:69], v8 offset:9216
    ds_read_b64_tr_b16 a[70:71], v8 offset:11520
    ds_read_b64_tr_b16 a[228:229], v8 offset:9280
    ds_read_b64_tr_b16 a[230:231], v8 offset:11584
    s_waitcnt vmcnt(20)
    ds_write_b128 v6, v[68:71] offset:18432
    ds_write_b128 v6, v[72:75] offset:23040
    ds_write_b128 v6, v[76:79] offset:27648
    ds_write_b128 v6, v[80:83] offset:32256
    buffer_load_dwordx4 v[68:71], v4, s[20:23], s48 offen
    s_add_u32 s48, s48, 65536
    buffer_load_dwordx4 v[72:75], v4, s[20:23], s48 offen
    s_add_u32 s48, s48, 65536
    buffer_load_dwordx4 v[76:79], v4, s[20:23], s48 offen
    s_add_u32 s48, s48, 65536
    buffer_load_dwordx4 v[80:83], v4, s[20:23], s48 offen
    s_add_u32 s48, s48, 65536
    s_waitcnt lgkmcnt(0)
    s_barrier
    ds_read_b64_tr_b16 a[72:73], v8 offset:18432
    ds_read_b64_tr_b16 a[74:75], v8 offset:20736
    ds_read_b64_tr_b16 a[232:233], v8 offset:18496
    ds_read_b64_tr_b16 a[234:235], v8 offset:20800
    ds_read_b64_tr_b16 a[76:77], v8 offset:27648
    ds_read_b64_tr_b16 a[78:79], v8 offset:29952
    ds_read_b64_tr_b16 a[236:237], v8 offset:27712
    ds_read_b64_tr_b16 a[238:239], v8 offset:30016
    s_waitcnt vmcnt(20)
    ds_write_b128 v6, v[84:87] offset:0
    ds_write_b128 v6, v[88:91] offset:4608
    ds_write_b128 v6, v[92:95] offset:9216
    ds_write_b128 v6, v[96:99] offset:13824
    buffer_load_dwordx4 v[84:87], v4, s[20:23], s48 offen
    s_add_u32 s48, s48, 65536
    buffer_load_dwordx4 v[88:91], v4, s[20:23], s48 offen
    s_add_u32 s48, s48, 65536
    buffer_load_dwordx4 v[92:95], v4, s[20:23], s48 offen
    s_add_u32 s48, s48, 65536
    buffer_load_dwordx4 v[96:99], v4, s[20:23], s48 offen
    s_add_u32 s48, s48, 65536
    s_waitcnt lgkmcnt(0)
    s_barrier
    ds_read_b64_tr_b16 a[80:81], v8 offset:0
    ds_read_b64_tr_b16 a[82:83], v8 offset:2304
    ds_read_b64_tr_b16 a[240:241], v8 offset:64
    ds_read_b64_tr_b16 a[242:243], v8 offset:2368
    ds_read_b64_tr_b16 a[84:85], v8 offset:9216
    ds_read_b64_tr_b16 a[86:87], v8 offset:11520
    ds_read_b64_tr_b16 a[244:245], v8 offset:9280
    ds_read_b64_tr_b16 a[246:247], v8 offset:11584
    s_waitcnt vmcnt(20)
    ds_write_b128 v6, v[100:103] offset:18432
    ds_write_b128 v6, v[104:107] offset:23040
    ds_write_b128 v6, v[108:111] offset:27648
    ds_write_b128 v6, v[112:115] offset:32256
    buffer_load_dwordx4 v[100:103], v4, s[20:23], s48 offen
    s_add_u32 s48, s48, 65536
    buffer_load_dwordx4 v[104:107], v4, s[20:23], s48 offen
    s_add_u32 s48, s48, 65536
    buffer_load_dwordx4 v[108:111], v4, s[20:23], s48 offen
    s_add_u32 s48, s48, 65536
    buffer_load_dwordx4 v[112:115], v4, s[20:23], s48 offen
    s_add_u32 s48, s48, 65536
    s_waitcnt lgkmcnt(0)
    s_barrier
    ds_read_b64_tr_b16 a[88:89], v8 offset:18432
    ds_read_b64_tr_b16 a[90:91], v8 offset:20736
    ds_read_b64_tr_b16 a[248:249], v8 offset:18496
    ds_read_b64_tr_b16 a[250:251], v8 offset:20800
    ds_read_b64_tr_b16 a[92:93], v8 offset:27648
    ds_read_b64_tr_b16 a[94:95], v8 offset:29952
    ds_read_b64_tr_b16 a[252:253], v8 offset:27712
    ds_read_b64_tr_b16 a[254:255], v8 offset:30016
    s_waitcnt vmcnt(20)
    ds_write_b128 v6, v[20:23] offset:0
    ds_write_b128 v6, v[24:27] offset:4608
    ds_write_b128 v6, v[28:31] offset:9216
    ds_write_b128 v6, v[32:35] offset:13824
    buffer_load_dwordx4 v[20:23], v4, s[20:23], s48 offen
    s_add_u32 s48, s48, 65536
    buffer_load_dwordx4 v[24:27], v4, s[20:23], s48 offen
    s_add_u32 s48, s48, 65536
    buffer_load_dwordx4 v[28:31], v4, s[20:23], s48 offen
    s_add_u32 s48, s48, 65536
    buffer_load_dwordx4 v[32:35], v4, s[20:23], s48 offen
    s_add_u32 s48, s48, 65536
    s_waitcnt lgkmcnt(0)
    s_barrier
    ds_read_b64_tr_b16 a[96:97], v8 offset:0
    ds_read_b64_tr_b16 a[98:99], v8 offset:2304
    ds_read_b64_tr_b16 v[192:193], v8 offset:64
    ds_read_b64_tr_b16 v[194:195], v8 offset:2368
    ds_read_b64_tr_b16 a[100:101], v8 offset:9216
    ds_read_b64_tr_b16 a[102:103], v8 offset:11520
    ds_read_b64_tr_b16 v[196:197], v8 offset:9280
    ds_read_b64_tr_b16 v[198:199], v8 offset:11584
    s_waitcnt vmcnt(20)
    ds_write_b128 v6, v[36:39] offset:18432
    ds_write_b128 v6, v[40:43] offset:23040
    ds_write_b128 v6, v[44:47] offset:27648
    ds_write_b128 v6, v[48:51] offset:32256
    buffer_load_dwordx4 v[36:39], v4, s[20:23], s48 offen
    s_add_u32 s48, s48, 65536
    buffer_load_dwordx4 v[40:43], v4, s[20:23], s48 offen
    s_add_u32 s48, s48, 65536
    buffer_load_dwordx4 v[44:47], v4, s[20:23], s48 offen
    s_add_u32 s48, s48, 65536
    buffer_load_dwordx4 v[48:51], v4, s[20:23], s48 offen
    s_add_u32 s48, s48, 65536
    s_waitcnt lgkmcnt(0)
    s_barrier
    ds_read_b64_tr_b16 a[104:105], v8 offset:18432
    ds_read_b64_tr_b16 a[106:107], v8 offset:20736
    ds_read_b64_tr_b16 v[200:201], v8 offset:18496
    ds_read_b64_tr_b16 v[202:203], v8 offset:20800
    ds_read_b64_tr_b16 a[108:109], v8 offset:27648
    ds_read_b64_tr_b16 a[110:111], v8 offset:29952
    ds_read_b64_tr_b16 v[204:205], v8 offset:27712
    ds_read_b64_tr_b16 v[206:207], v8 offset:30016
    s_waitcnt vmcnt(20)
    ds_write_b128 v6, v[52:55] offset:0
    ds_write_b128 v6, v[56:59] offset:4608
    ds_write_b128 v6, v[60:63] offset:9216
    ds_write_b128 v6, v[64:67] offset:13824
    s_waitcnt lgkmcnt(0)
    s_barrier
    ds_read_b64_tr_b16 a[112:113], v8 offset:0
    ds_read_b64_tr_b16 a[114:115], v8 offset:2304
    ds_read_b64_tr_b16 v[208:209], v8 offset:64
    ds_read_b64_tr_b16 v[210:211], v8 offset:2368
    ds_read_b64_tr_b16 a[116:117], v8 offset:9216
    ds_read_b64_tr_b16 a[118:119], v8 offset:11520
    ds_read_b64_tr_b16 v[212:213], v8 offset:9280
    ds_read_b64_tr_b16 v[214:215], v8 offset:11584
    s_waitcnt vmcnt(16)
    ds_write_b128 v6, v[68:71] offset:18432
    ds_write_b128 v6, v[72:75] offset:23040
    ds_write_b128 v6, v[76:79] offset:27648
    ds_write_b128 v6, v[80:83] offset:32256
    s_waitcnt lgkmcnt(0)
    s_barrier
    ds_read_b64_tr_b16 a[120:121], v8 offset:18432
    ds_read_b64_tr_b16 a[122:123], v8 offset:20736
    ds_read_b64_tr_b16 v[216:217], v8 offset:18496
    ds_read_b64_tr_b16 v[218:219], v8 offset:20800
    ds_read_b64_tr_b16 a[124:125], v8 offset:27648
    ds_read_b64_tr_b16 a[126:127], v8 offset:29952
    ds_read_b64_tr_b16 v[220:221], v8 offset:27712
    ds_read_b64_tr_b16 v[222:223], v8 offset:30016
    s_waitcnt vmcnt(12)
    ds_write_b128 v6, v[84:87] offset:0
    ds_write_b128 v6, v[88:91] offset:4608
    ds_write_b128 v6, v[92:95] offset:9216
    ds_write_b128 v6, v[96:99] offset:13824
    s_waitcnt lgkmcnt(0)
    s_barrier
    ds_read_b64_tr_b16 a[128:129], v8 offset:0
    ds_read_b64_tr_b16 a[130:131], v8 offset:2304
    ds_read_b64_tr_b16 v[224:225], v8 offset:64
    ds_read_b64_tr_b16 v[226:227], v8 offset:2368
    ds_read_b64_tr_b16 a[132:133], v8 offset:9216
    ds_read_b64_tr_b16 a[134:135], v8 offset:11520
    ds_read_b64_tr_b16 v[228:229], v8 offset:9280
    ds_read_b64_tr_b16 v[230:231], v8 offset:11584
    s_waitcnt vmcnt(8)
    ds_write_b128 v6, v[100:103] offset:18432
    ds_write_b128 v6, v[104:107] offset:23040
    ds_write_b128 v6, v[108:111] offset:27648
    ds_write_b128 v6, v[112:115] offset:32256
    s_waitcnt lgkmcnt(0)
    s_barrier
    ds_read_b64_tr_b16 a[136:137], v8 offset:18432
    ds_read_b64_tr_b16 a[138:139], v8 offset:20736
    ds_read_b64_tr_b16 v[232:233], v8 offset:18496
    ds_read_b64_tr_b16 v[234:235], v8 offset:20800
    ds_read_b64_tr_b16 a[140:141], v8 offset:27648
    ds_read_b64_tr_b16 a[142:143], v8 offset:29952
    ds_read_b64_tr_b16 v[236:237], v8 offset:27712
    ds_read_b64_tr_b16 v[238:239], v8 offset:30016
    s_waitcnt vmcnt(4)
    ds_write_b128 v6, v[20:23] offset:0
    ds_write_b128 v6, v[24:27] offset:4608
    ds_write_b128 v6, v[28:31] offset:9216
    ds_write_b128 v6, v[32:35] offset:13824
    s_waitcnt lgkmcnt(0)
    s_barrier
    ds_read_b64_tr_b16 a[144:145], v8 offset:0
    ds_read_b64_tr_b16 a[146:147], v8 offset:2304
    ds_read_b64_tr_b16 v[240:241], v8 offset:64
    ds_read_b64_tr_b16 v[242:243], v8 offset:2368
    ds_read_b64_tr_b16 a[148:149], v8 offset:9216
    ds_read_b64_tr_b16 a[150:151], v8 offset:11520
    ds_read_b64_tr_b16 v[244:245], v8 offset:9280
    ds_read_b64_tr_b16 v[246:247], v8 offset:11584
    s_waitcnt vmcnt(0)
    ds_write_b128 v6, v[36:39] offset:18432
    ds_write_b128 v6, v[40:43] offset:23040
    ds_write_b128 v6, v[44:47] offset:27648
    ds_write_b128 v6, v[48:51] offset:32256
    s_waitcnt lgkmcnt(0)
    s_barrier
    ds_read_b64_tr_b16 a[152:153], v8 offset:18432
    ds_read_b64_tr_b16 a[154:155], v8 offset:20736
    ds_read_b64_tr_b16 v[248:249], v8 offset:18496
    ds_read_b64_tr_b16 v[250:251], v8 offset:20800
    ds_read_b64_tr_b16 a[156:157], v8 offset:27648
    ds_read_b64_tr_b16 a[158:159], v8 offset:29952
    ds_read_b64_tr_b16 v[252:253], v8 offset:27712
    ds_read_b64_tr_b16 v[254:255], v8 offset:30016
    s_waitcnt lgkmcnt(0)
    s_barrier
    s_mov_b32 s49, 4194304
    s_cmp_eq_u32 s40, 1
    s_cselect_b32 s49, 20971520, s49
    s_cmp_eq_u32 s40, 2
    s_cselect_b32 s49, 37748736, s49
    s_lshr_b32 s50, s3, 1
    s_lshl_b32 s51, s46, 1
    s_add_u32 s50, s50, s51
    s_lshl_b32 s50, s50, 13
    s_add_u32 s49, s49, s50
    s_and_b32 s50, s3, 1
    s_lshl_b32 s50, s50, 12
    s_add_u32 s49, s49, s50
    s_mul_i32 s52, s18, 64
    s_add_u32 s53, s52, 64
    v_lshlrev_b32 v10, 4, v1
    v_bfe_u32 v11, v1, 4, 1
    v_lshlrev_b32 v11, 10, v11
    v_lshrrev_b32 v12, 5, v1
    v_lshlrev_b32 v12, 8, v12
    v_add_u32 v11, v11, v12
    v_and_b32 v12, 15, v1
    v_lshlrev_b32 v12, 4, v12
    v_add_u32 v11, v11, v12
    s_mul_i32 s54, s3, 10240
    s_mov_b32 s57, 0
    v_mov_b32 v14, 44
    s_mov_b32 s61, 0
L_pl_rdy2_38:
    global_load_dword v15, v14, s[4:5] sc1
    s_add_u32 s61, s61, 1
    s_waitcnt vmcnt(0)
    v_readfirstlane_b32 s60, v15
    s_cmp_ge_u32 s61, 200000
    s_cbranch_scc1 L_pl_rdy2_38_done
    s_cmp_lt_u32 s60, 55
    s_cbranch_scc1 L_pl_rdy2_38
L_pl_rdy2_38_done:
    s_cmp_lg_u32 s63, 0
    s_cbranch_scc1 L_wt_39
    s_mov_b32 s62, 69427200
    v_mov_b32 v14, s62
    s_lshl_b32 s62, s52, 7
    s_add_u32 s62, s62, 69419008
    v_mov_b32 v16, s62
    s_mov_b32 s61, 0
L_wt_39_p:
    global_load_dword v15, v14, s[6:7] sc1
    global_load_dword v17, v16, s[6:7] sc1
    s_add_u32 s61, s61, 1
    s_waitcnt vmcnt(0)
    v_readfirstlane_b32 s62, v15
    s_nop 0
    s_cmp_ge_u32 s62, 64
    s_cselect_b32 s63, 1, 0
    v_readfirstlane_b32 s62, v17
    s_cmp_ge_u32 s61, 200000
    s_cbranch_scc1 L_wt_39
    s_cmp_lt_u32 s62, 1
    s_cbranch_scc1 L_wt_39_p
L_wt_39:
    s_mul_i32 s55, s52, 40960
    s_add_u32 s55, s55, s54
    s_add_u32 s55, s55, 0
    s_add_u32 s56, s57, s54
    s_add_u32 m0, s56, 0
    s_nop 0
    buffer_load_dwordx4 v10, s[8:11], s55 offen offset:0 sc1 lds
    buffer_load_dwordx4 v10, s[8:11], s55 offen offset:1024 sc1 lds
    buffer_load_dwordx4 v10, s[8:11], s55 offen offset:2048 sc1 lds
    buffer_load_dwordx4 v10, s[8:11], s55 offen offset:3072 sc1 lds
    s_add_u32 m0, s56, 4096
    s_add_u32 s55, s55, 4096
    buffer_load_dwordx4 v10, s[8:11], s55 offen offset:0 sc1 lds
    buffer_load_dwordx4 v10, s[8:11], s55 offen offset:1024 sc1 lds
    buffer_load_dwordx4 v10, s[8:11], s55 offen offset:2048 sc1 lds
    buffer_load_dwordx4 v10, s[8:11], s55 offen offset:3072 sc1 lds
    s_add_u32 m0, s56, 8192
    s_add_u32 s55, s55, 4096
    buffer_load_dwordx4 v10, s[8:11], s55 offen offset:0 sc1 lds
    buffer_load_dwordx4 v10, s[8:11], s55 offen offset:1024 sc1 lds
    s_waitcnt vmcnt(0)
    s_cmp_eq_u32 s40, 1
    s_cbranch_scc1 L_wq_loop_v
L_wq_loop_kq:
    s_mul_i32 s61, s18, 64
    s_add_u32 s61, s61, 1
    s_cmp_lg_u32 s52, s61
    s_cbranch_scc1 L_wq_early_kq
    s_waitcnt vmcnt(0)
    s_barrier
    s_cmp_lg_u32 s3, 0
    s_cbranch_scc1 L_sig_40
    s_cmp_lt_u32 s52, 1
    s_cbranch_scc1 L_sig_40
    s_sub_u32 s61, s52, 1
    s_lshl_b32 s61, s61, 9
    s_mov_b32 s62, 69206016
    s_cmp_eq_u32 s40, 2
    s_cselect_b32 s62, 69238784, s62
    s_add_u32 s61, s61, s62
    s_add_u32 s60, s61, 0
    v_mov_b32 v14, s60
    v_mov_b32 v15, 1
    s_mov_b64 exec, 1
    global_atomic_add v14, v15, s[6:7]
    s_mov_b64 exec, -1
L_sig_40:
    s_branch L_wq_early_kq_go
L_wq_early_kq:
    s_waitcnt vmcnt(4)
    s_barrier
    s_cmp_lg_u32 s3, 0
    s_cbranch_scc1 L_sig_41
    s_cmp_lt_u32 s52, 3
    s_cbranch_scc1 L_sig_41
    s_sub_u32 s61, s52, 2
    s_lshl_b32 s61, s61, 9
    s_mov_b32 s62, 69206016
    s_cmp_eq_u32 s40, 2
    s_cselect_b32 s62, 69238784, s62
    s_add_u32 s61, s61, s62
    s_add_u32 s60, s61, 0
    v_mov_b32 v14, s60
    v_mov_b32 v15, 1
    s_mov_b64 exec, 1
    global_atomic_add v14, v15, s[6:7]
    s_mov_b64 exec, -1
L_sig_41:
L_wq_early_kq_go:
    s_add_u32 s58, s52, 1
    s_xor_b32 s59, s57, 40960
    s_cmp_lt_u32 s58, s53
    s_cbranch_scc0 L_wq_nodma_kq
    s_cmp_lg_u32 s63, 0
    s_cbranch_scc1 L_wt_42
    s_mov_b32 s62, 69427200
    v_mov_b32 v14, s62
    s_lshl_b32 s62, s58, 7
    s_add_u32 s62, s62, 69419008
    v_mov_b32 v16, s62
    s_mov_b32 s61, 0
L_wt_42_p:
    global_load_dword v15, v14, s[6:7] sc1
    global_load_dword v17, v16, s[6:7] sc1
    s_add_u32 s61, s61, 1
    s_waitcnt vmcnt(0)
    v_readfirstlane_b32 s62, v15
    s_nop 0
    s_cmp_ge_u32 s62, 64
    s_cselect_b32 s63, 1, 0
    v_readfirstlane_b32 s62, v17
    s_cmp_ge_u32 s61, 200000
    s_cbranch_scc1 L_wt_42
    s_cmp_lt_u32 s62, 1
    s_cbranch_scc1 L_wt_42_p
L_wt_42:
    s_mul_i32 s55, s58, 40960
    s_add_u32 s55, s55, s54
    s_add_u32 s55, s55, 0
    s_add_u32 s56, s59, s54
    s_add_u32 m0, s56, 0
    s_nop 0
    buffer_load_dwordx4 v10, s[8:11], s55 offen offset:0 sc1 lds
    buffer_load_dwordx4 v10, s[8:11], s55 offen offset:1024 sc1 lds
    buffer_load_dwordx4 v10, s[8:11], s55 offen offset:2048 sc1 lds
    buffer_load_dwordx4 v10, s[8:11], s55 offen offset:3072 sc1 lds
    s_add_u32 m0, s56, 4096
    s_add_u32 s55, s55, 4096
    buffer_load_dwordx4 v10, s[8:11], s55 offen offset:0 sc1 lds
    buffer_load_dwordx4 v10, s[8:11], s55 offen offset:1024 sc1 lds
    buffer_load_dwordx4 v10, s[8:11], s55 offen offset:2048 sc1 lds
    buffer_load_dwordx4 v10, s[8:11], s55 offen offset:3072 sc1 lds
    s_add_u32 m0, s56, 8192
    s_add_u32 s55, s55, 4096
    buffer_load_dwordx4 v10, s[8:11], s55 offen offset:0 sc1 lds
    buffer_load_dwordx4 v10, s[8:11], s55 offen offset:1024 sc1 lds
L_wq_nodma_kq:
    v_add_u32 v13, s57, v10
    ds_read_b128 v[160:163], v13 offset:0
    ds_read_b128 v[164:167], v13 offset:1024
    ds_read_b128 v[168:171], v13 offset:2048
    ds_read_b128 v[172:175], v13 offset:3072
    s_waitcnt lgkmcnt(3)
    v_mfma_f32_32x32x16_bf16 v[128:143], a[0:3], v[160:163], 0
    v_mfma_f32_32x32x16_bf16 v[144:159], a[160:163], v[160:163], 0
    ds_read_b128 v[160:163], v13 offset:4096
    s_waitcnt lgkmcnt(3)
    v_mfma_f32_32x32x16_bf16 v[128:143], a[4:7], v[164:167], v[128:143]
    v_mfma_f32_32x32x16_bf16 v[144:159], a[164:167], v[164:167], v[144:159]
    ds_read_b128 v[164:167], v13 offset:5120
    s_waitcnt lgkmcnt(3)
    v_mfma_f32_32x32x16_bf16 v[128:143], a[8:11], v[168:171], v[128:143]
    v_mfma_f32_32x32x16_bf16 v[144:159], a[168:171], v[168:171], v[144:159]
    ds_read_b128 v[168:171], v13 offset:6144
    s_waitcnt lgkmcnt(3)
    v_mfma_f32_32x32x16_bf16 v[128:143], a[12:15], v[172:175], v[128:143]
    v_mfma_f32_32x32x16_bf16 v[144:159], a[172:175], v[172:175], v[144:159]
    ds_read_b128 v[172:175], v13 offset:7168
    s_waitcnt lgkmcnt(3)
    v_mfma_f32_32x32x16_bf16 v[128:143], a[16:19], v[160:163], v[128:143]
    v_mfma_f32_32x32x16_bf16 v[144:159], a[176:179], v[160:163], v[144:159]
    ds_read_b128 v[160:163], v13 offset:8192
    s_waitcnt lgkmcnt(3)
    v_mfma_f32_32x32x16_bf16 v[128:143], a[20:23], v[164:167], v[128:143]
    v_mfma_f32_32x32x16_bf16 v[144:159], a[180:183], v[164:167], v[144:159]
    ds_read_b128 v[164:167], v13 offset:9216
    s_waitcnt lgkmcnt(3)
    v_mfma_f32_32x32x16_bf16 v[128:143], a[24:27], v[168:171], v[128:143]
    v_mfma_f32_32x32x16_bf16 v[144:159], a[184:187], v[168:171], v[144:159]
    ds_read_b128 v[168:171], v13 offset:10240
    s_waitcnt lgkmcnt(3)
    v_mfma_f32_32x32x16_bf16 v[128:143], a[28:31], v[172:175], v[128:143]
    v_mfma_f32_32x32x16_bf16 v[144:159], a[188:191], v[172:175], v[144:159]
    ds_read_b128 v[172:175], v13 offset:11264
    s_waitcnt lgkmcnt(3)
    v_mfma_f32_32x32x16_bf16 v[128:143], a[32:35], v[160:163], v[128:143]
    v_mfma_f32_32x32x16_bf16 v[144:159], a[192:195], v[160:163], v[144:159]
    ds_read_b128 v[160:163], v13 offset:12288
    s_waitcnt lgkmcnt(3)
    v_mfma_f32_32x32x16_bf16 v[128:143], a[36:39], v[164:167], v[128:143]
    v_mfma_f32_32x32x16_bf16 v[144:159], a[196:199], v[164:167], v[144:159]
    ds_read_b128 v[164:167], v13 offset:13312
    s_waitcnt lgkmcnt(3)
    v_mfma_f32_32x32x16_bf16 v[128:143], a[40:43], v[168:171], v[128:143]
    v_mfma_f32_32x32x16_bf16 v[144:159], a[200:203], v[168:171], v[144:159]
    ds_read_b128 v[168:171], v13 offset:14336
    s_waitcnt lgkmcnt(3)
    v_mfma_f32_32x32x16_bf16 v[128:143], a[44:47], v[172:175], v[128:143]
    v_mfma_f32_32x32x16_bf16 v[144:159], a[204:207], v[172:175], v[144:159]
    ds_read_b128 v[172:175], v13 offset:15360
    s_waitcnt lgkmcnt(3)
    v_mfma_f32_32x32x16_bf16 v[128:143], a[48:51], v[160:163], v[128:143]
    v_mfma_f32_32x32x16_bf16 v[144:159], a[208:211], v[160:163], v[144:159]
    ds_read_b128 v[160:163], v13 offset:16384
    s_waitcnt lgkmcnt(3)
    v_mfma_f32_32x32x16_bf16 v[128:143], a[52:55], v[164:167], v[128:143]
    v_mfma_f32_32x32x16_bf16 v[144:159], a[212:215], v[164:167], v[144:159]
    ds_read_b128 v[164:167], v13 offset:17408
    s_waitcnt lgkmcnt(3)
    v_mfma_f32_32x32x16_bf16 v[128:143], a[56:59], v[168:171], v[128:143]
    v_mfma_f32_32x32x16_bf16 v[144:159], a[216:219], v[168:171], v[144:159]
    ds_read_b128 v[168:171], v13 offset:18432
    s_waitcnt lgkmcnt(3)
    v_mfma_f32_32x32x16_bf16 v[128:143], a[60:63], v[172:175], v[128:143]
    v_mfma_f32_32x32x16_bf16 v[144:159], a[220:223], v[172:175], v[144:159]
    ds_read_b128 v[172:175], v13 offset:19456
    s_waitcnt lgkmcnt(3)
    v_mfma_f32_32x32x16_bf16 v[128:143], a[64:67], v[160:163], v[128:143]
    v_mfma_f32_32x32x16_bf16 v[144:159], a[224:227], v[160:163], v[144:159]
    ds_read_b128 v[160:163], v13 offset:20480
    s_waitcnt lgkmcnt(3)
    v_mfma_f32_32x32x16_bf16 v[128:143], a[68:71], v[164:167], v[128:143]
    v_mfma_f32_32x32x16_bf16 v[144:159], a[228:231], v[164:167], v[144:159]
    ds_read_b128 v[164:167], v13 offset:21504
    s_waitcnt lgkmcnt(3)
    v_mfma_f32_32x32x16_bf16 v[128:143], a[72:75], v[168:171], v[128:143]
    v_mfma_f32_32x32x16_bf16 v[144:159], a[232:235], v[168:171], v[144:159]
    ds_read_b128 v[168:171], v13 offset:22528
    s_waitcnt lgkmcnt(3)
    v_mfma_f32_32x32x16_bf16 v[128:143], a[76:79], v[172:175], v[128:143]
    v_mfma_f32_32x32x16_bf16 v[144:159], a[236:239], v[172:175], v[144:159]
    ds_read_b128 v[172:175], v13 offset:23552
    s_waitcnt lgkmcnt(3)
    v_mfma_f32_32x32x16_bf16 v[128:143], a[80:83], v[160:163], v[128:143]
    v_mfma_f32_32x32x16_bf16 v[144:159], a[240:243], v[160:163], v[144:159]
    ds_read_b128 v[160:163], v13 offset:24576
    s_waitcnt lgkmcnt(3)
    v_mfma_f32_32x32x16_bf16 v[128:143], a[84:87], v[164:167], v[128:143]
    v_mfma_f32_32x32x16_bf16 v[144:159], a[244:247], v[164:167], v[144:159]
    ds_read_b128 v[164:167], v13 offset:25600
    s_waitcnt lgkmcnt(3)
    v_mfma_f32_32x32x16_bf16 v[128:143], a[88:91], v[168:171], v[128:143]
    v_mfma_f32_32x32x16_bf16 v[144:159], a[248:251], v[168:171], v[144:159]
    ds_read_b128 v[168:171], v13 offset:26624
    s_waitcnt lgkmcnt(3)
    v_mfma_f32_32x32x16_bf16 v[128:143], a[92:95], v[172:175], v[128:143]
    v_mfma_f32_32x32x16_bf16 v[144:159], a[252:255], v[172:175], v[144:159]
    ds_read_b128 v[172:175], v13 offset:27648
    s_waitcnt lgkmcnt(3)
    v_mfma_f32_32x32x16_bf16 v[128:143], a[96:99], v[160:163], v[128:143]
    v_mfma_f32_32x32x16_bf16 v[144:159], v[192:195], v[160:163], v[144:159]
    ds_read_b128 v[160:163], v13 offset:28672
    s_waitcnt lgkmcnt(3)
    v_mfma_f32_32x32x16_bf16 v[128:143], a[100:103], v[164:167], v[128:143]
    v_mfma_f32_32x32x16_bf16 v[144:159], v[196:199], v[164:167], v[144:159]
    ds_read_b128 v[164:167], v13 offset:29696
    s_waitcnt lgkmcnt(3)
    v_mfma_f32_32x32x16_bf16 v[128:143], a[104:107], v[168:171], v[128:143]
    v_mfma_f32_32x32x16_bf16 v[144:159], v[200:203], v[168:171], v[144:159]
    ds_read_b128 v[168:171], v13 offset:30720
    s_waitcnt lgkmcnt(3)
    v_mfma_f32_32x32x16_bf16 v[128:143], a[108:111], v[172:175], v[128:143]
    v_mfma_f32_32x32x16_bf16 v[144:159], v[204:207], v[172:175], v[144:159]
    ds_read_b128 v[172:175], v13 offset:31744
    s_waitcnt lgkmcnt(3)
    v_mfma_f32_32x32x16_bf16 v[128:143], a[112:115], v[160:163], v[128:143]
    v_mfma_f32_32x32x16_bf16 v[144:159], v[208:211], v[160:163], v[144:159]
    ds_read_b128 v[160:163], v13 offset:32768
    s_waitcnt lgkmcnt(3)
    v_mfma_f32_32x32x16_bf16 v[128:143], a[116:119], v[164:167], v[128:143]
    v_mfma_f32_32x32x16_bf16 v[144:159], v[212:215], v[164:167], v[144:159]
    ds_read_b128 v[164:167], v13 offset:33792
    s_waitcnt lgkmcnt(3)
    v_mfma_f32_32x32x16_bf16 v[128:143], a[120:123], v[168:171], v[128:143]
    v_mfma_f32_32x32x16_bf16 v[144:159], v[216:219], v[168:171], v[144:159]
    ds_read_b128 v[168:171], v13 offset:34816
    s_waitcnt lgkmcnt(3)
    v_mfma_f32_32x32x16_bf16 v[128:143], a[124:127], v[172:175], v[128:143]
    v_mfma_f32_32x32x16_bf16 v[144:159], v[220:223], v[172:175], v[144:159]
    ds_read_b128 v[172:175], v13 offset:35840
    s_waitcnt lgkmcnt(3)
    v_mfma_f32_32x32x16_bf16 v[128:143], a[128:131], v[160:163], v[128:143]
    v_mfma_f32_32x32x16_bf16 v[144:159], v[224:227], v[160:163], v[144:159]
    ds_read_b128 v[160:163], v13 offset:36864
    s_waitcnt lgkmcnt(3)
    v_mfma_f32_32x32x16_bf16 v[128:143], a[132:135], v[164:167], v[128:143]
    v_mfma_f32_32x32x16_bf16 v[144:159], v[228:231], v[164:167], v[144:159]
    ds_read_b128 v[164:167], v13 offset:37888
    s_waitcnt lgkmcnt(3)
    v_mfma_f32_32x32x16_bf16 v[128:143], a[136:139], v[168:171], v[128:143]
    v_mfma_f32_32x32x16_bf16 v[144:159], v[232:235], v[168:171], v[144:159]
    ds_read_b128 v[168:171], v13 offset:38912
    s_waitcnt lgkmcnt(3)
    v_mfma_f32_32x32x16_bf16 v[128:143], a[140:143], v[172:175], v[128:143]
    v_mfma_f32_32x32x16_bf16 v[144:159], v[236:239], v[172:175], v[144:159]
    ds_read_b128 v[172:175], v13 offset:39936
    s_waitcnt lgkmcnt(3)
    v_mfma_f32_32x32x16_bf16 v[128:143], a[144:147], v[160:163], v[128:143]
    v_mfma_f32_32x32x16_bf16 v[144:159], v[240:243], v[160:163], v[144:159]
    s_waitcnt lgkmcnt(2)
    v_mfma_f32_32x32x16_bf16 v[128:143], a[148:151], v[164:167], v[128:143]
    v_mfma_f32_32x32x16_bf16 v[144:159], v[244:247], v[164:167], v[144:159]
    s_waitcnt lgkmcnt(1)
    v_mfma_f32_32x32x16_bf16 v[128:143], a[152:155], v[168:171], v[128:143]
    v_mfma_f32_32x32x16_bf16 v[144:159], v[248:251], v[168:171], v[144:159]
    s_waitcnt lgkmcnt(0)
    v_mfma_f32_32x32x16_bf16 v[128:143], a[156:159], v[172:175], v[128:143]
    v_mfma_f32_32x32x16_bf16 v[144:159], v[252:255], v[172:175], v[144:159]
    s_lshl_b32 s60, s52, 18
    s_add_u32 s60, s60, s49
    s_nop 1
    v_cvt_pk_bf16_f32 v176, v128, v136
    v_cvt_pk_bf16_f32 v177, v129, v137
    v_cvt_pk_bf16_f32 v178, v130, v138
    v_cvt_pk_bf16_f32 v179, v131, v139
    buffer_store_dwordx4 v[176:179], v11, s[8:11], s60 offen offset:0 sc1
    v_cvt_pk_bf16_f32 v180, v132, v140
    v_cvt_pk_bf16_f32 v181, v133, v141
    v_cvt_pk_bf16_f32 v182, v134, v142
    v_cvt_pk_bf16_f32 v183, v135, v143
    buffer_store_dwordx4 v[180:183], v11, s[8:11], s60 offen offset:512 sc1
    v_cvt_pk_bf16_f32 v184, v144, v152
    v_cvt_pk_bf16_f32 v185, v145, v153
    v_cvt_pk_bf16_f32 v186, v146, v154
    v_cvt_pk_bf16_f32 v187, v147, v155
    buffer_store_dwordx4 v[184:187], v11, s[8:11], s60 offen offset:2048 sc1
    v_cvt_pk_bf16_f32 v188, v148, v156
    v_cvt_pk_bf16_f32 v189, v149, v157
    v_cvt_pk_bf16_f32 v190, v150, v158
    v_cvt_pk_bf16_f32 v191, v151, v159
    buffer_store_dwordx4 v[188:191], v11, s[8:11], s60 offen offset:2560 sc1
    s_mov_b32 s52, s58
    s_mov_b32 s57, s59
    s_cmp_lt_u32 s52, s53
    s_cbranch_scc1 L_wq_loop_kq
    s_branch L_wq_done
L_wq_loop_v:
    s_mul_i32 s61, s18, 64
    s_add_u32 s61, s61, 1
    s_cmp_lg_u32 s52, s61
    s_cbranch_scc1 L_wq_early_v
    s_waitcnt vmcnt(0)
    s_barrier
    s_cmp_lg_u32 s3, 0
    s_cbranch_scc1 L_sig_43
    s_cmp_lt_u32 s52, 1
    s_cbranch_scc1 L_sig_43
    s_sub_u32 s61, s52, 1
    s_lshl_b32 s61, s61, 9
    s_mov_b32 s62, 69206016
    s_cmp_eq_u32 s40, 2
    s_cselect_b32 s62, 69238784, s62
    s_add_u32 s61, s61, s62
    s_add_u32 s60, s61, 0
    v_mov_b32 v14, s60
    v_mov_b32 v15, 1
    s_mov_b64 exec, 1
    global_atomic_add v14, v15, s[6:7]
    s_mov_b64 exec, -1
L_sig_43:
    s_branch L_wq_early_v_go
L_wq_early_v:
    s_waitcnt vmcnt(4)
    s_barrier
    s_cmp_lg_u32 s3, 0
    s_cbranch_scc1 L_sig_44
    s_cmp_lt_u32 s52, 3
    s_cbranch_scc1 L_sig_44
    s_sub_u32 s61, s52, 2
    s_lshl_b32 s61, s61, 9
    s_mov_b32 s62, 69206016
    s_cmp_eq_u32 s40, 2
    s_cselect_b32 s62, 69238784, s62
    s_add_u32 s61, s61, s62
    s_add_u32 s60, s61, 0
    v_mov_b32 v14, s60
    v_mov_b32 v15, 1
    s_mov_b64 exec, 1
    global_atomic_add v14, v15, s[6:7]
    s_mov_b64 exec, -1
L_sig_44:
L_wq_early_v_go:
    s_add_u32 s58, s52, 1
    s_xor_b32 s59, s57, 40960
    s_cmp_lt_u32 s58, s53
    s_cbranch_scc0 L_wq_nodma_v
    s_cmp_lg_u32 s63, 0
    s_cbranch_scc1 L_wt_45
    s_mov_b32 s62, 69427200
    v_mov_b32 v14, s62
    s_lshl_b32 s62, s58, 7
    s_add_u32 s62, s62, 69419008
    v_mov_b32 v16, s62
    s_mov_b32 s61, 0
L_wt_45_p:
    global_load_dword v15, v14, s[6:7] sc1
    global_load_dword v17, v16, s[6:7] sc1
    s_add_u32 s61, s61, 1
    s_waitcnt vmcnt(0)
    v_readfirstlane_b32 s62, v15
    s_nop 0
    s_cmp_ge_u32 s62, 64
    s_cselect_b32 s63, 1, 0
    v_readfirstlane_b32 s62, v17
    s_cmp_ge_u32 s61, 200000
    s_cbranch_scc1 L_wt_45
    s_cmp_lt_u32 s62, 1
    s_cbranch_scc1 L_wt_45_p
L_wt_45:
    s_mul_i32 s55, s58, 40960
    s_add_u32 s55, s55, s54
    s_add_u32 s55, s55, 0
    s_add_u32 s56, s59, s54
    s_add_u32 m0, s56, 0
    s_nop 0
    buffer_load_dwordx4 v10, s[8:11], s55 offen offset:0 sc1 lds
    buffer_load_dwordx4 v10, s[8:11], s55 offen offset:1024 sc1 lds
    buffer_load_dwordx4 v10, s[8:11], s55 offen offset:2048 sc1 lds
    buffer_load_dwordx4 v10, s[8:11], s55 offen offset:3072 sc1 lds
    s_add_u32 m0, s56, 4096
    s_add_u32 s55, s55, 4096
    buffer_load_dwordx4 v10, s[8:11], s55 offen offset:0 sc1 lds
    buffer_load_dwordx4 v10, s[8:11], s55 offen offset:1024 sc1 lds
    buffer_load_dwordx4 v10, s[8:11], s55 offen offset:2048 sc1 lds
    buffer_load_dwordx4 v10, s[8:11], s55 offen offset:3072 sc1 lds
    s_add_u32 m0, s56, 8192
    s_add_u32 s55, s55, 4096
    buffer_load_dwordx4 v10, s[8:11], s55 offen offset:0 sc1 lds
    buffer_load_dwordx4 v10, s[8:11], s55 offen offset:1024 sc1 lds
L_wq_nodma_v:
    v_add_u32 v13, s57, v10
    ds_read_b128 v[160:163], v13 offset:0
    ds_read_b128 v[164:167], v13 offset:1024
    ds_read_b128 v[168:171], v13 offset:2048
    ds_read_b128 v[172:175], v13 offset:3072
    s_waitcnt lgkmcnt(3)
    v_mfma_f32_32x32x16_bf16 v[128:143], v[160:163], a[0:3], 0
    v_mfma_f32_32x32x16_bf16 v[144:159], v[160:163], a[160:163], 0
    ds_read_b128 v[160:163], v13 offset:4096
    s_waitcnt lgkmcnt(3)
    v_mfma_f32_32x32x16_bf16 v[128:143], v[164:167], a[4:7], v[128:143]
    v_mfma_f32_32x32x16_bf16 v[144:159], v[164:167], a[164:167], v[144:159]
    ds_read_b128 v[164:167], v13 offset:5120
    s_waitcnt lgkmcnt(3)
    v_mfma_f32_32x32x16_bf16 v[128:143], v[168:171], a[8:11], v[128:143]
    v_mfma_f32_32x32x16_bf16 v[144:159], v[168:171], a[168:171], v[144:159]
    ds_read_b128 v[168:171], v13 offset:6144
    s_waitcnt lgkmcnt(3)
    v_mfma_f32_32x32x16_bf16 v[128:143], v[172:175], a[12:15], v[128:143]
    v_mfma_f32_32x32x16_bf16 v[144:159], v[172:175], a[172:175], v[144:159]
    ds_read_b128 v[172:175], v13 offset:7168
    s_waitcnt lgkmcnt(3)
    v_mfma_f32_32x32x16_bf16 v[128:143], v[160:163], a[16:19], v[128:143]
    v_mfma_f32_32x32x16_bf16 v[144:159], v[160:163], a[176:179], v[144:159]
    ds_read_b128 v[160:163], v13 offset:8192
    s_waitcnt lgkmcnt(3)
    v_mfma_f32_32x32x16_bf16 v[128:143], v[164:167], a[20:23], v[128:143]
    v_mfma_f32_32x32x16_bf16 v[144:159], v[164:167], a[180:183], v[144:159]
    ds_read_b128 v[164:167], v13 offset:9216
    s_waitcnt lgkmcnt(3)
    v_mfma_f32_32x32x16_bf16 v[128:143], v[168:171], a[24:27], v[128:143]
    v_mfma_f32_32x32x16_bf16 v[144:159], v[168:171], a[184:187], v[144:159]
    ds_read_b128 v[168:171], v13 offset:10240
    s_waitcnt lgkmcnt(3)
    v_mfma_f32_32x32x16_bf16 v[128:143], v[172:175], a[28:31], v[128:143]
    v_mfma_f32_32x32x16_bf16 v[144:159], v[172:175], a[188:191], v[144:159]
    ds_read_b128 v[172:175], v13 offset:11264
    s_waitcnt lgkmcnt(3)
    v_mfma_f32_32x32x16_bf16 v[128:143], v[160:163], a[32:35], v[128:143]
    v_mfma_f32_32x32x16_bf16 v[144:159], v[160:163], a[192:195], v[144:159]
    ds_read_b128 v[160:163], v13 offset:12288
    s_waitcnt lgkmcnt(3)
    v_mfma_f32_32x32x16_bf16 v[128:143], v[164:167], a[36:39], v[128:143]
    v_mfma_f32_32x32x16_bf16 v[144:159], v[164:167], a[196:199], v[144:159]
    ds_read_b128 v[164:167], v13 offset:13312
    s_waitcnt lgkmcnt(3)
    v_mfma_f32_32x32x16_bf16 v[128:143], v[168:171], a[40:43], v[128:143]
    v_mfma_f32_32x32x16_bf16 v[144:159], v[168:171], a[200:203], v[144:159]
    ds_read_b128 v[168:171], v13 offset:14336
    s_waitcnt lgkmcnt(3)
    v_mfma_f32_32x32x16_bf16 v[128:143], v[172:175], a[44:47], v[128:143]
    v_mfma_f32_32x32x16_bf16 v[144:159], v[172:175], a[204:207], v[144:159]
    ds_read_b128 v[172:175], v13 offset:15360
    s_waitcnt lgkmcnt(3)
    v_mfma_f32_32x32x16_bf16 v[128:143], v[160:163], a[48:51], v[128:143]
    v_mfma_f32_32x32x16_bf16 v[144:159], v[160:163], a[208:211], v[144:159]
    ds_read_b128 v[160:163], v13 offset:16384
    s_waitcnt lgkmcnt(3)
    v_mfma_f32_32x32x16_bf16 v[128:143], v[164:167], a[52:55], v[128:143]
    v_mfma_f32_32x32x16_bf16 v[144:159], v[164:167], a[212:215], v[144:159]
    ds_read_b128 v[164:167], v13 offset:17408
    s_waitcnt lgkmcnt(3)
    v_mfma_f32_32x32x16_bf16 v[128:143], v[168:171], a[56:59], v[128:143]
    v_mfma_f32_32x32x16_bf16 v[144:159], v[168:171], a[216:219], v[144:159]
    ds_read_b128 v[168:171], v13 offset:18432
    s_waitcnt lgkmcnt(3)
    v_mfma_f32_32x32x16_bf16 v[128:143], v[172:175], a[60:63], v[128:143]
    v_mfma_f32_32x32x16_bf16 v[144:159], v[172:175], a[220:223], v[144:159]
    ds_read_b128 v[172:175], v13 offset:19456
    s_waitcnt lgkmcnt(3)
    v_mfma_f32_32x32x16_bf16 v[128:143], v[160:163], a[64:67], v[128:143]
    v_mfma_f32_32x32x16_bf16 v[144:159], v[160:163], a[224:227], v[144:159]
    ds_read_b128 v[160:163], v13 offset:20480
    s_waitcnt lgkmcnt(3)
    v_mfma_f32_32x32x16_bf16 v[128:143], v[164:167], a[68:71], v[128:143]
    v_mfma_f32_32x32x16_bf16 v[144:159], v[164:167], a[228:231], v[144:159]
    ds_read_b128 v[164:167], v13 offset:21504
    s_waitcnt lgkmcnt(3)
    v_mfma_f32_32x32x16_bf16 v[128:143], v[168:171], a[72:75], v[128:143]
    v_mfma_f32_32x32x16_bf16 v[144:159], v[168:171], a[232:235], v[144:159]
    ds_read_b128 v[168:171], v13 offset:22528
    s_waitcnt lgkmcnt(3)
    v_mfma_f32_32x32x16_bf16 v[128:143], v[172:175], a[76:79], v[128:143]
    v_mfma_f32_32x32x16_bf16 v[144:159], v[172:175], a[236:239], v[144:159]
    ds_read_b128 v[172:175], v13 offset:23552
    s_waitcnt lgkmcnt(3)
    v_mfma_f32_32x32x16_bf16 v[128:143], v[160:163], a[80:83], v[128:143]
    v_mfma_f32_32x32x16_bf16 v[144:159], v[160:163], a[240:243], v[144:159]
    ds_read_b128 v[160:163], v13 offset:24576
    s_waitcnt lgkmcnt(3)
    v_mfma_f32_32x32x16_bf16 v[128:143], v[164:167], a[84:87], v[128:143]
    v_mfma_f32_32x32x16_bf16 v[144:159], v[164:167], a[244:247], v[144:159]
    ds_read_b128 v[164:167], v13 offset:25600
    s_waitcnt lgkmcnt(3)
    v_mfma_f32_32x32x16_bf16 v[128:143], v[168:171], a[88:91], v[128:143]
    v_mfma_f32_32x32x16_bf16 v[144:159], v[168:171], a[248:251], v[144:159]
    ds_read_b128 v[168:171], v13 offset:26624
    s_waitcnt lgkmcnt(3)
    v_mfma_f32_32x32x16_bf16 v[128:143], v[172:175], a[92:95], v[128:143]
    v_mfma_f32_32x32x16_bf16 v[144:159], v[172:175], a[252:255], v[144:159]
    ds_read_b128 v[172:175], v13 offset:27648
    s_waitcnt lgkmcnt(3)
    v_mfma_f32_32x32x16_bf16 v[128:143], v[160:163], a[96:99], v[128:143]
    v_mfma_f32_32x32x16_bf16 v[144:159], v[160:163], v[192:195], v[144:159]
    ds_read_b128 v[160:163], v13 offset:28672
    s_waitcnt lgkmcnt(3)
    v_mfma_f32_32x32x16_bf16 v[128:143], v[164:167], a[100:103], v[128:143]
    v_mfma_f32_32x32x16_bf16 v[144:159], v[164:167], v[196:199], v[144:159]
    ds_read_b128 v[164:167], v13 offset:29696
    s_waitcnt lgkmcnt(3)
    v_mfma_f32_32x32x16_bf16 v[128:143], v[168:171], a[104:107], v[128:143]
    v_mfma_f32_32x32x16_bf16 v[144:159], v[168:171], v[200:203], v[144:159]
    ds_read_b128 v[168:171], v13 offset:30720
    s_waitcnt lgkmcnt(3)
    v_mfma_f32_32x32x16_bf16 v[128:143], v[172:175], a[108:111], v[128:143]
    v_mfma_f32_32x32x16_bf16 v[144:159], v[172:175], v[204:207], v[144:159]
    ds_read_b128 v[172:175], v13 offset:31744
    s_waitcnt lgkmcnt(3)
    v_mfma_f32_32x32x16_bf16 v[128:143], v[160:163], a[112:115], v[128:143]
    v_mfma_f32_32x32x16_bf16 v[144:159], v[160:163], v[208:211], v[144:159]
    ds_read_b128 v[160:163], v13 offset:32768
    s_waitcnt lgkmcnt(3)
    v_mfma_f32_32x32x16_bf16 v[128:143], v[164:167], a[116:119], v[128:143]
    v_mfma_f32_32x32x16_bf16 v[144:159], v[164:167], v[212:215], v[144:159]
    ds_read_b128 v[164:167], v13 offset:33792
    s_waitcnt lgkmcnt(3)
    v_mfma_f32_32x32x16_bf16 v[128:143], v[168:171], a[120:123], v[128:143]
    v_mfma_f32_32x32x16_bf16 v[144:159], v[168:171], v[216:219], v[144:159]
    ds_read_b128 v[168:171], v13 offset:34816
    s_waitcnt lgkmcnt(3)
    v_mfma_f32_32x32x16_bf16 v[128:143], v[172:175], a[124:127], v[128:143]
    v_mfma_f32_32x32x16_bf16 v[144:159], v[172:175], v[220:223], v[144:159]
    ds_read_b128 v[172:175], v13 offset:35840
    s_waitcnt lgkmcnt(3)
    v_mfma_f32_32x32x16_bf16 v[128:143], v[160:163], a[128:131], v[128:143]
    v_mfma_f32_32x32x16_bf16 v[144:159], v[160:163], v[224:227], v[144:159]
    ds_read_b128 v[160:163], v13 offset:36864
    s_waitcnt lgkmcnt(3)
    v_mfma_f32_32x32x16_bf16 v[128:143], v[164:167], a[132:135], v[128:143]
    v_mfma_f32_32x32x16_bf16 v[144:159], v[164:167], v[228:231], v[144:159]
    ds_read_b128 v[164:167], v13 offset:37888
    s_waitcnt lgkmcnt(3)
    v_mfma_f32_32x32x16_bf16 v[128:143], v[168:171], a[136:139], v[128:143]
    v_mfma_f32_32x32x16_bf16 v[144:159], v[168:171], v[232:235], v[144:159]
    ds_read_b128 v[168:171], v13 offset:38912
    s_waitcnt lgkmcnt(3)
    v_mfma_f32_32x32x16_bf16 v[128:143], v[172:175], a[140:143], v[128:143]
    v_mfma_f32_32x32x16_bf16 v[144:159], v[172:175], v[236:239], v[144:159]
    ds_read_b128 v[172:175], v13 offset:39936
    s_waitcnt lgkmcnt(3)
    v_mfma_f32_32x32x16_bf16 v[128:143], v[160:163], a[144:147], v[128:143]
    v_mfma_f32_32x32x16_bf16 v[144:159], v[160:163], v[240:243], v[144:159]
    s_waitcnt lgkmcnt(2)
    v_mfma_f32_32x32x16_bf16 v[128:143], v[164:167], a[148:151], v[128:143]
    v_mfma_f32_32x32x16_bf16 v[144:159], v[164:167], v[244:247], v[144:159]
    s_waitcnt lgkmcnt(1)
    v_mfma_f32_32x32x16_bf16 v[128:143], v[168:171], a[152:155], v[128:143]
    v_mfma_f32_32x32x16_bf16 v[144:159], v[168:171], v[248:251], v[144:159]
    s_waitcnt lgkmcnt(0)
    v_mfma_f32_32x32x16_bf16 v[128:143], v[172:175], a[156:159], v[128:143]
    v_mfma_f32_32x32x16_bf16 v[144:159], v[172:175], v[252:255], v[144:159]
    s_lshl_b32 s60, s52, 18
    s_add_u32 s60, s60, s49
    s_nop 1
    v_cvt_pk_bf16_f32 v176, v128, v129
    v_cvt_pk_bf16_f32 v177, v130, v131
    v_cvt_pk_bf16_f32 v178, v136, v137
    v_cvt_pk_bf16_f32 v179, v138, v139
    buffer_store_dwordx4 v[176:179], v11, s[8:11], s60 offen offset:0 sc1
    v_cvt_pk_bf16_f32 v180, v132, v133
    v_cvt_pk_bf16_f32 v181, v134, v135
    v_cvt_pk_bf16_f32 v182, v140, v141
    v_cvt_pk_bf16_f32 v183, v142, v143
    buffer_store_dwordx4 v[180:183], v11, s[8:11], s60 offen offset:512 sc1
    v_cvt_pk_bf16_f32 v184, v144, v145
    v_cvt_pk_bf16_f32 v185, v146, v147
    v_cvt_pk_bf16_f32 v186, v152, v153
    v_cvt_pk_bf16_f32 v187, v154, v155
    buffer_store_dwordx4 v[184:187], v11, s[8:11], s60 offen offset:2048 sc1
    v_cvt_pk_bf16_f32 v188, v148, v149
    v_cvt_pk_bf16_f32 v189, v150, v151
    v_cvt_pk_bf16_f32 v190, v156, v157
    v_cvt_pk_bf16_f32 v191, v158, v159
    buffer_store_dwordx4 v[188:191], v11, s[8:11], s60 offen offset:2560 sc1
    s_mov_b32 s52, s58
    s_mov_b32 s57, s59
    s_cmp_lt_u32 s52, s53
    s_cbranch_scc1 L_wq_loop_v
    s_branch L_wq_done
L_wq_done:
    s_waitcnt vmcnt(0)
    s_barrier
    s_add_u32 s52, s53, 0
    s_cmp_lg_u32 s3, 0
    s_cbranch_scc1 L_sig_46
    s_cmp_lt_u32 s52, 3
    s_cbranch_scc1 L_sig_46
    s_sub_u32 s61, s52, 2
    s_lshl_b32 s61, s61, 9
    s_mov_b32 s62, 69206016
    s_cmp_eq_u32 s40, 2
    s_cselect_b32 s62, 69238784, s62
    s_add_u32 s61, s61, s62
    s_add_u32 s60, s61, 0
    v_mov_b32 v14, s60
    v_mov_b32 v15, 1
    s_mov_b64 exec, 1
    global_atomic_add v14, v15, s[6:7]
    s_mov_b64 exec, -1
L_sig_46:
    s_cmp_lg_u32 s3, 0
    s_cbranch_scc1 L_sig_47
    s_cmp_lt_u32 s52, 1
    s_cbranch_scc1 L_sig_47
    s_sub_u32 s61, s52, 1
    s_lshl_b32 s61, s61, 9
    s_mov_b32 s62, 69206016
    s_cmp_eq_u32 s40, 2
    s_cselect_b32 s62, 69238784, s62
    s_add_u32 s61, s61, s62
    s_add_u32 s60, s61, 0
    v_mov_b32 v14, s60
    v_mov_b32 v15, 1
    s_mov_b64 exec, 1
    global_atomic_add v14, v15, s[6:7]
    s_mov_b64 exec, -1
L_sig_47:
    s_branch L_w_end
L_w_post:
    s_sub_u32 s20, s18, 64
    s_cmp_ge_u32 s20, 55
    s_cbranch_scc1 L_w_nozero
    v_lshlrev_b32 v2, 4, v0
    v_mov_b32 v4, 0
    v_mov_b32 v5, 0
    v_mov_b32 v6, 0
    v_mov_b32 v7, 0
    s_lshl_b32 s20, s20, 12
    s_add_u32 s20, s20, 69206016
    buffer_store_dwordx4 v[4:7], v2, s[8:11], s20 offen sc1
    s_waitcnt vmcnt(0)
    s_barrier
    s_cmp_lg_u32 s3, 0
    s_cbranch_scc1 L_w_nozero
    v_mov_b32 v2, 44
    v_mov_b32 v3, 1
    s_mov_b64 exec, 1
    global_atomic_add v2, v3, s[4:5]
    s_mov_b64 exec, -1
L_w_nozero:
    s_cmp_ge_u32 s18, 64
    s_cbranch_scc1 L_w_noln
    s_load_dwordx2 s[20:21], s[0:1], 0
    s_waitcnt lgkmcnt(0)
    s_mov_b32 s12, s20
    s_mov_b32 s13, s21
    s_mov_b32 s14, 0x280000
    s_mov_b32 s15, 0x20000
    v_and_b32 v1, 63, v0
    v_and_b32 v2, 31, v1
    v_lshrrev_b32 v3, 5, v1
    v_mul_u32_u24 v4, 1280, v2
    v_lshlrev_b32 v5, 4, v3
    v_add_u32 v4, v4, v5
    s_mul_i32 s40, s3, 320
    v_add_u32 v4, s40, v4
    s_mul_i32 s41, s18, 40960
    buffer_load_dwordx4 v[10:13], v4, s[12:15], s41 offen offset:0
    buffer_load_dwordx4 v[14:17], v4, s[12:15], s41 offen offset:32
    buffer_load_dwordx4 v[18:21], v4, s[12:15], s41 offen offset:64
    buffer_load_dwordx4 v[22:25], v4, s[12:15], s41 offen offset:96
    buffer_load_dwordx4 v[26:29], v4, s[12:15], s41 offen offset:128
    buffer_load_dwordx4 v[30:33], v4, s[12:15], s41 offen offset:160
    buffer_load_dwordx4 v[34:37], v4, s[12:15], s41 offen offset:192
    buffer_load_dwordx4 v[38:41], v4, s[12:15], s41 offen offset:224
    buffer_load_dwordx4 v[42:45], v4, s[12:15], s41 offen offset:256
    buffer_load_dwordx4 v[46:49], v4, s[12:15], s41 offen offset:288
    v_lshlrev_b32 v6, 2, v2
    s_lshl_b32 s42, s3, 7
    v_add_u32 v7, s42, v6
    s_waitcnt vmcnt(9)
    v_lshlrev_b32 v60, 16, v10
    v_and_b32 v61, 0xffff0000, v10
    v_lshlrev_b32 v62, 16, v11
    v_and_b32 v63, 0xffff0000, v11
    v_lshlrev_b32 v64, 16, v12
    v_and_b32 v65, 0xffff0000, v12
    v_lshlrev_b32 v66, 16, v13
    v_and_b32 v67, 0xffff0000, v13
    s_waitcnt vmcnt(8)
    v_lshlrev_b32 v68, 16, v14
    v_and_b32 v69, 0xffff0000, v14
    v_lshlrev_b32 v70, 16, v15
    v_and_b32 v71, 0xffff0000, v15
    v_lshlrev_b32 v72, 16, v16
    v_and_b32 v73, 0xffff0000, v16
    v_lshlrev_b32 v74, 16, v17
    v_and_b32 v75, 0xffff0000, v17
    s_waitcnt vmcnt(7)
    v_lshlrev_b32 v76, 16, v18
    v_and_b32 v77, 0xffff0000, v18
    v_lshlrev_b32 v78, 16, v19
    v_and_b32 v79, 0xffff0000, v19
    v_lshlrev_b32 v80, 16, v20
    v_and_b32 v81, 0xffff0000, v20
    v_lshlrev_b32 v82, 16, v21
    v_and_b32 v83, 0xffff0000, v21
    s_waitcnt vmcnt(6)
    v_lshlrev_b32 v84, 16, v22
    v_and_b32 v85, 0xffff0000, v22
    v_lshlrev_b32 v86, 16, v23
    v_and_b32 v87, 0xffff0000, v23
    v_lshlrev_b32 v88, 16, v24
    v_and_b32 v89, 0xffff0000, v24
    v_lshlrev_b32 v90, 16, v25
    v_and_b32 v91, 0xffff0000, v25
    s_waitcnt vmcnt(5)
    v_lshlrev_b32 v92, 16, v26
    v_and_b32 v93, 0xffff0000, v26
    v_lshlrev_b32 v94, 16, v27
    v_and_b32 v95, 0xffff0000, v27
    v_lshlrev_b32 v96, 16, v28
    v_and_b32 v97, 0xffff0000, v28
    v_lshlrev_b32 v98, 16, v29
    v_and_b32 v99, 0xffff0000, v29
    s_waitcnt vmcnt(4)
    v_lshlrev_b32 v100, 16, v30
    v_and_b32 v101, 0xffff0000, v30
    v_lshlrev_b32 v102, 16, v31
    v_and_b32 v103, 0xffff0000, v31
    v_lshlrev_b32 v104, 16, v32
    v_and_b32 v105, 0xffff0000, v32
    v_lshlrev_b32 v106, 16, v33
    v_and_b32 v107, 0xffff0000, v33
    s_waitcnt vmcnt(3)
    v_lshlrev_b32 v108, 16, v34
    v_and_b32 v109, 0xffff0000, v34
    v_lshlrev_b32 v110, 16, v35
    v_and_b32 v111, 0xffff0000, v35
    v_lshlrev_b32 v112, 16, v36
    v_and_b32 v113, 0xffff0000, v36
    v_lshlrev_b32 v114, 16, v37
    v_and_b32 v115, 0xffff0000, v37
    s_waitcnt vmcnt(2)
    v_lshlrev_b32 v116, 16, v38
    v_and_b32 v117, 0xffff0000, v38
    v_lshlrev_b32 v118, 16, v39
    v_and_b32 v119, 0xffff0000, v39
    v_lshlrev_b32 v120, 16, v40
    v_and_b32 v121, 0xffff0000, v40
    v_lshlrev_b32 v122, 16, v41
    v_and_b32 v123, 0xffff0000, v41
    s_waitcnt vmcnt(1)
    v_lshlrev_b32 v124, 16, v42
    v_and_b32 v125, 0xffff0000, v42
    v_lshlrev_b32 v126, 16, v43
    v_and_b32 v127, 0xffff0000, v43
    v_lshlrev_b32 v128, 16, v44
    v_and_b32 v129, 0xffff0000, v44
    v_lshlrev_b32 v130, 16, v45
    v_and_b32 v131, 0xffff0000, v45
    s_waitcnt vmcnt(0)
    v_lshlrev_b32 v132, 16, v46
    v_and_b32 v133, 0xffff0000, v46
    v_lshlrev_b32 v134, 16, v47
    v_and_b32 v135, 0xffff0000, v47
    v_lshlrev_b32 v136, 16, v48
    v_and_b32 v137, 0xffff0000, v48
    v_lshlrev_b32 v138, 16, v49
    v_and_b32 v139, 0xffff0000, v49
    v_add_f32 v8, v60, v61
    v_add_f32 v9, v62, v63
    v_add_f32 v8, v8, v64
    v_add_f32 v9, v9, v65
    v_add_f32 v8, v8, v66
    v_add_f32 v9, v9, v67
    v_add_f32 v8, v8, v68
    v_add_f32 v9, v9, v69
    v_add_f32 v8, v8, v70
    v_add_f32 v9, v9, v71
    v_add_f32 v8, v8, v72
    v_add_f32 v9, v9, v73
    v_add_f32 v8, v8, v74
    v_add_f32 v9, v9, v75
    v_add_f32 v8, v8, v76
    v_add_f32 v9, v9, v77
    v_add_f32 v8, v8, v78
    v_add_f32 v9, v9, v79
    v_add_f32 v8, v8, v80
    v_add_f32 v9, v9, v81
    v_add_f32 v8, v8, v82
    v_add_f32 v9, v9, v83
    v_add_f32 v8, v8, v84
    v_add_f32 v9, v9, v85
    v_add_f32 v8, v8, v86
    v_add_f32 v9, v9, v87
    v_add_f32 v8, v8, v88
    v_add_f32 v9, v9, v89
    v_add_f32 v8, v8, v90
    v_add_f32 v9, v9, v91
    v_add_f32 v8, v8, v92
    v_add_f32 v9, v9, v93
    v_add_f32 v8, v8, v94
    v_add_f32 v9, v9, v95
    v_add_f32 v8, v8, v96
    v_add_f32 v9, v9, v97
    v_add_f32 v8, v8, v98
    v_add_f32 v9, v9, v99
    v_add_f32 v8, v8, v100
    v_add_f32 v9, v9, v101
    v_add_f32 v8, v8, v102
    v_add_f32 v9, v9, v103
    v_add_f32 v8, v8, v104
    v_add_f32 v9, v9, v105
    v_add_f32 v8, v8, v106
    v_add_f32 v9, v9, v107
    v_add_f32 v8, v8, v108
    v_add_f32 v9, v9, v109
    v_add_f32 v8, v8, v110
    v_add_f32 v9, v9, v111
    v_add_f32 v8, v8, v112
    v_add_f32 v9, v9, v113
    v_add_f32 v8, v8, v114
    v_add_f32 v9, v9, v115
    v_add_f32 v8, v8, v116
    v_add_f32 v9, v9, v117
    v_add_f32 v8, v8, v118
    v_add_f32 v9, v9, v119
    v_add_f32 v8, v8, v120
    v_add_f32 v9, v9, v121
    v_add_f32 v8, v8, v122
    v_add_f32 v9, v9, v123
    v_add_f32 v8, v8, v124
    v_add_f32 v9, v9, v125
    v_add_f32 v8, v8, v126
    v_add_f32 v9, v9, v127
    v_add_f32 v8, v8, v128
    v_add_f32 v9, v9, v129
    v_add_f32 v8, v8, v130
    v_add_f32 v9, v9, v131
    v_add_f32 v8, v8, v132
    v_add_f32 v9, v9, v133
    v_add_f32 v8, v8, v134
    v_add_f32 v9, v9, v135
    v_add_f32 v8, v8, v136
    v_add_f32 v9, v9, v137
    v_add_f32 v8, v8, v138
    v_add_f32 v9, v9, v139
    v_add_f32 v8, v8, v9
    v_mov_b32 v9, v8
    s_nop 1
    v_permlane32_swap_b32 v9, v8
    v_add_f32 v8, v8, v9
    ds_write_b32 v7, v8 offset:0
    s_waitcnt lgkmcnt(0)
    s_barrier
    ds_read_b32 v50, v6 offset:0
    ds_read_b32 v51, v6 offset:128
    ds_read_b32 v52, v6 offset:256
    ds_read_b32 v53, v6 offset:384
    s_waitcnt lgkmcnt(0)
    v_add_f32 v50, v50, v51
    v_add_f32 v52, v52, v53
    v_add_f32 v8, v50, v52
    s_mov_b32 s43, 0x3acccccd
    v_mul_f32 v8, s43, v8
    v_sub_f32 v60, v60, v8
    v_sub_f32 v61, v61, v8
    v_sub_f32 v62, v62, v8
    v_sub_f32 v63, v63, v8
    v_sub_f32 v64, v64, v8
    v_sub_f32 v65, v65, v8
    v_sub_f32 v66, v66, v8
    v_sub_f32 v67, v67, v8
    v_sub_f32 v68, v68, v8
    v_sub_f32 v69, v69, v8
    v_sub_f32 v70, v70, v8
    v_sub_f32 v71, v71, v8
    v_sub_f32 v72, v72, v8
    v_sub_f32 v73, v73, v8
    v_sub_f32 v74, v74, v8
    v_sub_f32 v75, v75, v8
    v_sub_f32 v76, v76, v8
    v_sub_f32 v77, v77, v8
    v_sub_f32 v78, v78, v8
    v_sub_f32 v79, v79, v8
    v_sub_f32 v80, v80, v8
    v_sub_f32 v81, v81, v8
    v_sub_f32 v82, v82, v8
    v_sub_f32 v83, v83, v8
    v_sub_f32 v84, v84, v8
    v_sub_f32 v85, v85, v8
    v_sub_f32 v86, v86, v8
    v_sub_f32 v87, v87, v8
    v_sub_f32 v88, v88, v8
    v_sub_f32 v89, v89, v8
    v_sub_f32 v90, v90, v8
    v_sub_f32 v91, v91, v8
    v_sub_f32 v92, v92, v8
    v_sub_f32 v93, v93, v8
    v_sub_f32 v94, v94, v8
    v_sub_f32 v95, v95, v8
    v_sub_f32 v96, v96, v8
    v_sub_f32 v97, v97, v8
    v_sub_f32 v98, v98, v8
    v_sub_f32 v99, v99, v8
    v_sub_f32 v100, v100, v8
    v_sub_f32 v101, v101, v8
    v_sub_f32 v102, v102, v8
    v_sub_f32 v103, v103, v8
    v_sub_f32 v104, v104, v8
    v_sub_f32 v105, v105, v8
    v_sub_f32 v106, v106, v8
    v_sub_f32 v107, v107, v8
    v_sub_f32 v108, v108, v8
    v_sub_f32 v109, v109, v8
    v_sub_f32 v110, v110, v8
    v_sub_f32 v111, v111, v8
    v_sub_f32 v112, v112, v8
    v_sub_f32 v113, v113, v8
    v_sub_f32 v114, v114, v8
    v_sub_f32 v115, v115, v8
    v_sub_f32 v116, v116, v8
    v_sub_f32 v117, v117, v8
    v_sub_f32 v118, v118, v8
    v_sub_f32 v119, v119, v8
    v_sub_f32 v120, v120, v8
    v_sub_f32 v121, v121, v8
    v_sub_f32 v122, v122, v8
    v_sub_f32 v123, v123, v8
    v_sub_f32 v124, v124, v8
    v_sub_f32 v125, v125, v8
    v_sub_f32 v126, v126, v8
    v_sub_f32 v127, v127, v8
    v_sub_f32 v128, v128, v8
    v_sub_f32 v129, v129, v8
    v_sub_f32 v130, v130, v8
    v_sub_f32 v131, v131, v8
    v_sub_f32 v132, v132, v8
    v_sub_f32 v133, v133, v8
    v_sub_f32 v134, v134, v8
    v_sub_f32 v135, v135, v8
    v_sub_f32 v136, v136, v8
    v_sub_f32 v137, v137, v8
    v_sub_f32 v138, v138, v8
    v_sub_f32 v139, v139, v8
    v_mul_f32 v8, v60, v60
    v_mul_f32 v9, v61, v61
    v_fmac_f32 v8, v62, v62
    v_fmac_f32 v9, v63, v63
    v_fmac_f32 v8, v64, v64
    v_fmac_f32 v9, v65, v65
    v_fmac_f32 v8, v66, v66
    v_fmac_f32 v9, v67, v67
    v_fmac_f32 v8, v68, v68
    v_fmac_f32 v9, v69, v69
    v_fmac_f32 v8, v70, v70
    v_fmac_f32 v9, v71, v71
    v_fmac_f32 v8, v72, v72
    v_fmac_f32 v9, v73, v73
    v_fmac_f32 v8, v74, v74
    v_fmac_f32 v9, v75, v75
    v_fmac_f32 v8, v76, v76
    v_fmac_f32 v9, v77, v77
    v_fmac_f32 v8, v78, v78
    v_fmac_f32 v9, v79, v79
    v_fmac_f32 v8, v80, v80
    v_fmac_f32 v9, v81, v81
    v_fmac_f32 v8, v82, v82
    v_fmac_f32 v9, v83, v83
    v_fmac_f32 v8, v84, v84
    v_fmac_f32 v9, v85, v85
    v_fmac_f32 v8, v86, v86
    v_fmac_f32 v9, v87, v87
    v_fmac_f32 v8, v88, v88
    v_fmac_f32 v9, v89, v89
    v_fmac_f32 v8, v90, v90
    v_fmac_f32 v9, v91, v91
    v_fmac_f32 v8, v92, v92
    v_fmac_f32 v9, v93, v93
    v_fmac_f32 v8, v94, v94
    v_fmac_f32 v9, v95, v95
    v_fmac_f32 v8, v96, v96
    v_fmac_f32 v9, v97, v97
    v_fmac_f32 v8, v98, v98
    v_fmac_f32 v9, v99, v99
    v_fmac_f32 v8, v100, v100
    v_fmac_f32 v9, v101, v101
    v_fmac_f32 v8, v102, v102
    v_fmac_f32 v9, v103, v103
    v_fmac_f32 v8, v104, v104
    v_fmac_f32 v9, v105, v105
    v_fmac_f32 v8, v106, v106
    v_fmac_f32 v9, v107, v107
    v_fmac_f32 v8, v108, v108
    v_fmac_f32 v9, v109, v109
    v_fmac_f32 v8, v110, v110
    v_fmac_f32 v9, v111, v111
    v_fmac_f32 v8, v112, v112
    v_fmac_f32 v9, v113, v113
    v_fmac_f32 v8, v114, v114
    v_fmac_f32 v9, v115, v115
    v_fmac_f32 v8, v116, v116
    v_fmac_f32 v9, v117, v117
    v_fmac_f32 v8, v118, v118
    v_fmac_f32 v9, v119, v119
    v_fmac_f32 v8, v120, v120
    v_fmac_f32 v9, v121, v121
    v_fmac_f32 v8, v122, v122
    v_fmac_f32 v9, v123, v123
    v_fmac_f32 v8, v124, v124
    v_fmac_f32 v9, v125, v125
    v_fmac_f32 v8, v126, v126
    v_fmac_f32 v9, v127, v127
    v_fmac_f32 v8, v128, v128
    v_fmac_f32 v9, v129, v129
    v_fmac_f32 v8, v130, v130
    v_fmac_f32 v9, v131, v131
    v_fmac_f32 v8, v132, v132
    v_fmac_f32 v9, v133, v133
    v_fmac_f32 v8, v134, v134
    v_fmac_f32 v9, v135, v135
    v_fmac_f32 v8, v136, v136
    v_fmac_f32 v9, v137, v137
    v_fmac_f32 v8, v138, v138
    v_fmac_f32 v9, v139, v139
    v_add_f32 v8, v8, v9
    v_mov_b32 v9, v8
    s_nop 1
    v_permlane32_swap_b32 v9, v8
    v_add_f32 v8, v8, v9
    ds_write_b32 v7, v8 offset:512
    s_waitcnt lgkmcnt(0)
    s_barrier
    ds_read_b32 v50, v6 offset:512
    ds_read_b32 v51, v6 offset:640
    ds_read_b32 v52, v6 offset:768
    ds_read_b32 v53, v6 offset:896
    s_waitcnt lgkmcnt(0)
    v_add_f32 v50, v50, v51
    v_add_f32 v52, v52, v53
    v_add_f32 v8, v50, v52
    v_mov_b32 v9, 0x3727c5ac
    v_fmac_f32 v9, s43, v8
    v_rsq_f32 v9, v9
    v_lshlrev_b32 v4, 4, v1
    s_mul_i32 s44, s3, 10240
    s_add_u32 s44, s44, s41
    s_add_u32 s44, s44, 0
    v_mul_f32 v60, v60, v9
    v_mul_f32 v61, v61, v9
    v_cvt_pk_bf16_f32 v10, v60, v61
    v_mul_f32 v62, v62, v9
    v_mul_f32 v63, v63, v9
    v_cvt_pk_bf16_f32 v11, v62, v63
    v_mul_f32 v64, v64, v9
    v_mul_f32 v65, v65, v9
    v_cvt_pk_bf16_f32 v12, v64, v65
    v_mul_f32 v66, v66, v9
    v_mul_f32 v67, v67, v9
    v_cvt_pk_bf16_f32 v13, v66, v67
    buffer_store_dwordx4 v[10:13], v4, s[8:11], s44 offen sc1
    s_add_u32 s44, s44, 1024
    v_mul_f32 v68, v68, v9
    v_mul_f32 v69, v69, v9
    v_cvt_pk_bf16_f32 v14, v68, v69
    v_mul_f32 v70, v70, v9
    v_mul_f32 v71, v71, v9
    v_cvt_pk_bf16_f32 v15, v70, v71
    v_mul_f32 v72, v72, v9
    v_mul_f32 v73, v73, v9
    v_cvt_pk_bf16_f32 v16, v72, v73
    v_mul_f32 v74, v74, v9
    v_mul_f32 v75, v75, v9
    v_cvt_pk_bf16_f32 v17, v74, v75
    buffer_store_dwordx4 v[14:17], v4, s[8:11], s44 offen sc1
    s_add_u32 s44, s44, 1024
    v_mul_f32 v76, v76, v9
    v_mul_f32 v77, v77, v9
    v_cvt_pk_bf16_f32 v18, v76, v77
    v_mul_f32 v78, v78, v9
    v_mul_f32 v79, v79, v9
    v_cvt_pk_bf16_f32 v19, v78, v79
    v_mul_f32 v80, v80, v9
    v_mul_f32 v81, v81, v9
    v_cvt_pk_bf16_f32 v20, v80, v81
    v_mul_f32 v82, v82, v9
    v_mul_f32 v83, v83, v9
    v_cvt_pk_bf16_f32 v21, v82, v83
    buffer_store_dwordx4 v[18:21], v4, s[8:11], s44 offen sc1
    s_add_u32 s44, s44, 1024
    v_mul_f32 v84, v84, v9
    v_mul_f32 v85, v85, v9
    v_cvt_pk_bf16_f32 v22, v84, v85
    v_mul_f32 v86, v86, v9
    v_mul_f32 v87, v87, v9
    v_cvt_pk_bf16_f32 v23, v86, v87
    v_mul_f32 v88, v88, v9
    v_mul_f32 v89, v89, v9
    v_cvt_pk_bf16_f32 v24, v88, v89
    v_mul_f32 v90, v90, v9
    v_mul_f32 v91, v91, v9
    v_cvt_pk_bf16_f32 v25, v90, v91
    buffer_store_dwordx4 v[22:25], v4, s[8:11], s44 offen sc1
    s_add_u32 s44, s44, 1024
    v_mul_f32 v92, v92, v9
    v_mul_f32 v93, v93, v9
    v_cvt_pk_bf16_f32 v26, v92, v93
    v_mul_f32 v94, v94, v9
    v_mul_f32 v95, v95, v9
    v_cvt_pk_bf16_f32 v27, v94, v95
    v_mul_f32 v96, v96, v9
    v_mul_f32 v97, v97, v9
    v_cvt_pk_bf16_f32 v28, v96, v97
    v_mul_f32 v98, v98, v9
    v_mul_f32 v99, v99, v9
    v_cvt_pk_bf16_f32 v29, v98, v99
    buffer_store_dwordx4 v[26:29], v4, s[8:11], s44 offen sc1
    s_add_u32 s44, s44, 1024
    v_mul_f32 v100, v100, v9
    v_mul_f32 v101, v101, v9
    v_cvt_pk_bf16_f32 v30, v100, v101
    v_mul_f32 v102, v102, v9
    v_mul_f32 v103, v103, v9
    v_cvt_pk_bf16_f32 v31, v102, v103
    v_mul_f32 v104, v104, v9
    v_mul_f32 v105, v105, v9
    v_cvt_pk_bf16_f32 v32, v104, v105
    v_mul_f32 v106, v106, v9
    v_mul_f32 v107, v107, v9
    v_cvt_pk_bf16_f32 v33, v106, v107
    buffer_store_dwordx4 v[30:33], v4, s[8:11], s44 offen sc1
    s_add_u32 s44, s44, 1024
    v_mul_f32 v108, v108, v9
    v_mul_f32 v109, v109, v9
    v_cvt_pk_bf16_f32 v34, v108, v109
    v_mul_f32 v110, v110, v9
    v_mul_f32 v111, v111, v9
    v_cvt_pk_bf16_f32 v35, v110, v111
    v_mul_f32 v112, v112, v9
    v_mul_f32 v113, v113, v9
    v_cvt_pk_bf16_f32 v36, v112, v113
    v_mul_f32 v114, v114, v9
    v_mul_f32 v115, v115, v9
    v_cvt_pk_bf16_f32 v37, v114, v115
    buffer_store_dwordx4 v[34:37], v4, s[8:11], s44 offen sc1
    s_add_u32 s44, s44, 1024
    v_mul_f32 v116, v116, v9
    v_mul_f32 v117, v117, v9
    v_cvt_pk_bf16_f32 v38, v116, v117
    v_mul_f32 v118, v118, v9
    v_mul_f32 v119, v119, v9
    v_cvt_pk_bf16_f32 v39, v118, v119
    v_mul_f32 v120, v120, v9
    v_mul_f32 v121, v121, v9
    v_cvt_pk_bf16_f32 v40, v120, v121
    v_mul_f32 v122, v122, v9
    v_mul_f32 v123, v123, v9
    v_cvt_pk_bf16_f32 v41, v122, v123
    buffer_store_dwordx4 v[38:41], v4, s[8:11], s44 offen sc1
    s_add_u32 s44, s44, 1024
    v_mul_f32 v124, v124, v9
    v_mul_f32 v125, v125, v9
    v_cvt_pk_bf16_f32 v42, v124, v125
    v_mul_f32 v126, v126, v9
    v_mul_f32 v127, v127, v9
    v_cvt_pk_bf16_f32 v43, v126, v127
    v_mul_f32 v128, v128, v9
    v_mul_f32 v129, v129, v9
    v_cvt_pk_bf16_f32 v44, v128, v129
    v_mul_f32 v130, v130, v9
    v_mul_f32 v131, v131, v9
    v_cvt_pk_bf16_f32 v45, v130, v131
    buffer_store_dwordx4 v[42:45], v4, s[8:11], s44 offen sc1
    s_add_u32 s44, s44, 1024
    v_mul_f32 v132, v132, v9
    v_mul_f32 v133, v133, v9
    v_cvt_pk_bf16_f32 v46, v132, v133
    v_mul_f32 v134, v134, v9
    v_mul_f32 v135, v135, v9
    v_cvt_pk_bf16_f32 v47, v134, v135
    v_mul_f32 v136, v136, v9
    v_mul_f32 v137, v137, v9
    v_cvt_pk_bf16_f32 v48, v136, v137
    v_mul_f32 v138, v138, v9
    v_mul_f32 v139, v139, v9
    v_cvt_pk_bf16_f32 v49, v138, v139
    buffer_store_dwordx4 v[46:49], v4, s[8:11], s44 offen sc1
    s_waitcnt vmcnt(0)
    s_barrier
    s_cmp_lg_u32 s3, 0
    s_cbranch_scc1 L_w_noln
    v_mov_b32 v2, 44
    s_mov_b32 s61, 0
L_pl_rdy_48:
    global_load_dword v3, v2, s[4:5] sc1
    s_add_u32 s61, s61, 1
    s_waitcnt vmcnt(0)
    v_readfirstlane_b32 s60, v3
    s_cmp_ge_u32 s61, 200000
    s_cbranch_scc1 L_pl_rdy_48_done
    s_cmp_lt_u32 s60, 55
    s_cbranch_scc1 L_pl_rdy_48
L_pl_rdy_48_done:
    s_lshl_b32 s20, s18, 7
    s_add_u32 s20, s20, 69419008
    s_add_u32 s60, s20, 0
    v_mov_b32 v2, s60
    v_mov_b32 v3, 1
    s_mov_b64 exec, 1
    global_atomic_add v2, v3, s[6:7]
    s_mov_b64 exec, -1
    s_mov_b32 s20, 69427200
    s_add_u32 s60, s20, 0
    v_mov_b32 v2, s60
    v_mov_b32 v3, 1
    s_mov_b64 exec, 1
    global_atomic_add v2, v3, s[6:7]
    s_mov_b64 exec, -1
L_w_noln:
    s_barrier
    v_mov_b32 v2, 44
    s_mov_b32 s61, 0
L_pl_rdy3_49:
    global_load_dword v3, v2, s[4:5] sc1
    s_add_u32 s61, s61, 1
    s_waitcnt vmcnt(0)
    v_readfirstlane_b32 s60, v3
    s_cmp_ge_u32 s61, 200000
    s_cbranch_scc1 L_pl_rdy3_49_done
    s_cmp_lt_u32 s60, 55
    s_cbranch_scc1 L_pl_rdy3_49
L_pl_rdy3_49_done:
    s_waitcnt vmcnt(0) lgkmcnt(0)
    s_barrier
    s_mov_b32 s63, 0
    s_cmp_eq_u32 s17, 4
    s_cbranch_scc1 L_role_op
    s_cmp_eq_u32 s17, 5
    s_cbranch_scc1 L_role_f1
    s_cmp_eq_u32 s17, 6
    s_cbranch_scc1 L_role_f2
    v_and_b32 v1, 63, v0
    v_lshlrev_b32 v2, 4, v1
    v_lshlrev_b32 v3, 3, v1
    s_lshr_b32 s20, s16, 3
    s_and_b32 s21, s16, 7
    s_lshl_b32 s21, s21, 2
    s_add_u32 s21, s21, s3
    v_and_b32 v4, 15, v1
    v_lshrrev_b32 v5, 4, v1
    v_lshlrev_b32 v5, 2, v5
    v_sub_u32 v4, v4, v5
    v_mov_b32 v6, 0xff800000
    s_mov_b32 s48, 0x3e0293ee
    s_mov_b32 s22, 0
L_att_loop:
    s_cmp_lt_u32 s20, s22
    s_cbranch_scc1 L_att_proj_ok
    s_add_u32 s23, s20, 6
    s_min_u32 s23, s23, 63
    s_cmp_lg_u32 s3, 0
    s_cbranch_scc1 L_w_attq_50_d
    s_lshl_b32 s60, s23, 9
    s_add_u32 s60, s60, 69238784
    v_and_b32 v232, 3, v0
    v_lshlrev_b32 v232, 7, v232
    v_add_u32 v232, s60, v232
    s_mov_b32 s61, 0
L_w_attq_50:
    global_load_dword v233, v232, s[6:7] sc1
    s_add_u32 s61, s61, 1
    s_waitcnt vmcnt(0)
    v_readlane_b32 s60, v233, 0
    v_readlane_b32 s62, v233, 1
    s_nop 0
    s_add_u32 s60, s60, s62
    v_readlane_b32 s62, v233, 2
    s_nop 0
    s_add_u32 s60, s60, s62
    v_readlane_b32 s62, v233, 3
    s_nop 0
    s_add_u32 s60, s60, s62
    s_cmp_ge_u32 s61, 100000
    s_cselect_b32 s63, 1, s63
    s_cmp_lg_u32 s63, 0
    s_cbranch_scc1 L_w_attq_50_d
    s_cmp_ge_u32 s60, 16
    s_cbranch_scc1 L_w_attq_50_d
    s_branch L_w_attq_50
L_w_attq_50_d:
    s_cmp_lg_u32 s3, 0
    s_cbranch_scc1 L_w_attk_51_d
    s_lshl_b32 s60, s23, 9
    s_add_u32 s60, s60, 69206016
    v_and_b32 v232, 3, v0
    v_lshlrev_b32 v232, 7, v232
    v_add_u32 v232, s60, v232
    s_mov_b32 s61, 0
L_w_attk_51:
    global_load_dword v233, v232, s[6:7] sc1
    s_add_u32 s61, s61, 1
    s_waitcnt vmcnt(0)
    v_readlane_b32 s60, v233, 0
    v_readlane_b32 s62, v233, 1
    s_nop 0
    s_add_u32 s60, s60, s62
    v_readlane_b32 s62, v233, 2
    s_nop 0
    s_add_u32 s60, s60, s62
    v_readlane_b32 s62, v233, 3
    s_nop 0
    s_add_u32 s60, s60, s62
    s_cmp_ge_u32 s61, 100000
    s_cselect_b32 s63, 1, s63
    s_cmp_lg_u32 s63, 0
    s_cbranch_scc1 L_w_attk_51_d
    s_cmp_ge_u32 s60, 32
    s_cbranch_scc1 L_w_attk_51_d
    s_branch L_w_attk_51
L_w_attk_51_d:
    s_barrier
    s_add_u32 s22, s23, 1
L_att_proj_ok:
    s_lshl_b32 s40, s20, 5
    s_add_u32 s40, s40, s21
    s_lshl_b32 s41, s40, 13
    s_add_u32 s42, s41, 37748736
    s_add_u32 s43, s41, 4194304
    s_add_u32 s44, s41, 20971520
    s_lshl_b32 s45, s40, 12
    s_add_u32 s45, s45, 54525952
    s_lshl_b32 s46, s40, 11
    s_add_u32 s46, s46, 62914560
    buffer_load_dwordx4 v[8:11], v2, s[8:11], s42 offen offset:0 sc1
    buffer_load_dwordx4 v[12:15], v2, s[8:11], s42 offen offset:1024 sc1
    buffer_load_dwordx4 v[40:43], v2, s[8:11], s43 offen offset:0 sc1
    buffer_load_dwordx4 v[44:47], v2, s[8:11], s43 offen offset:1024 sc1
    buffer_load_dwordx4 v[16:19], v2, s[8:11], s42 offen offset:2048 sc1
    buffer_load_dwordx4 v[20:23], v2, s[8:11], s42 offen offset:3072 sc1
    buffer_load_dwordx4 v[48:51], v2, s[8:11], s43 offen offset:2048 sc1
    buffer_load_dwordx4 v[52:55], v2, s[8:11], s43 offen offset:3072 sc1
    s_add_u32 s47, s42, 4096
    buffer_load_dwordx4 v[24:27], v2, s[8:11], s47 offen offset:0 sc1
    s_add_u32 s47, s42, 4096
    buffer_load_dwordx4 v[28:31], v2, s[8:11], s47 offen offset:1024 sc1
    s_add_u32 s47, s43, 4096
    buffer_load_dwordx4 v[56:59], v2, s[8:11], s47 offen offset:0 sc1
    s_add_u32 s47, s43, 4096
    buffer_load_dwordx4 v[60:63], v2, s[8:11], s47 offen offset:1024 sc1
    s_add_u32 s47, s42, 4096
    buffer_load_dwordx4 v[32:35], v2, s[8:11], s47 offen offset:2048 sc1
    s_add_u32 s47, s42, 4096
    buffer_load_dwordx4 v[36:39], v2, s[8:11], s47 offen offset:3072 sc1
    s_add_u32 s47, s43, 4096
    buffer_load_dwordx4 v[64:67], v2, s[8:11], s47 offen offset:2048 sc1
    s_add_u32 s47, s43, 4096
    buffer_load_dwordx4 v[68:71], v2, s[8:11], s47 offen offset:3072 sc1
    buffer_load_dwordx4 v[88:91], v2, s[8:11], s44 offen offset:0 sc1
    buffer_load_dwordx4 v[92:95], v2, s[8:11], s44 offen offset:1024 sc1
    buffer_load_dwordx4 v[96:99], v2, s[8:11], s44 offen offset:2048 sc1
    buffer_load_dwordx4 v[100:103], v2, s[8:11], s44 offen offset:3072 sc1
    s_add_u32 s47, s44, 4096
    buffer_load_dwordx4 v[104:107], v2, s[8:11], s47 offen offset:0 sc1
    s_add_u32 s47, s44, 4096
    buffer_load_dwordx4 v[108:111], v2, s[8:11], s47 offen offset:1024 sc1
    s_add_u32 s47, s44, 4096
    buffer_load_dwordx4 v[112:115], v2, s[8:11], s47 offen offset:2048 sc1
    s_add_u32 s47, s44, 4096
    buffer_load_dwordx4 v[116:119], v2, s[8:11], s47 offen offset:3072 sc1
    s_waitcnt vmcnt(20)
    v_mfma_f32_16x16x32_bf16 v[140:143], v[40:43], v[8:11], 0
    v_mfma_f32_16x16x32_bf16 v[148:151], v[40:43], v[12:15], 0
    v_mfma_f32_16x16x32_bf16 v[152:155], v[44:47], v[12:15], 0
    s_waitcnt vmcnt(16)
    v_mfma_f32_16x16x32_bf16 v[140:143], v[48:51], v[16:19], v[140:143]
    v_mfma_f32_16x16x32_bf16 v[148:151], v[48:51], v[20:23], v[148:151]
    v_mfma_f32_16x16x32_bf16 v[152:155], v[52:55], v[20:23], v[152:155]
    s_waitcnt vmcnt(12)
    v_mfma_f32_16x16x32_bf16 v[140:143], v[56:59], v[24:27], v[140:143]
    v_mfma_f32_16x16x32_bf16 v[148:151], v[56:59], v[28:31], v[148:151]
    v_mfma_f32_16x16x32_bf16 v[152:155], v[60:63], v[28:31], v[152:155]
    s_waitcnt vmcnt(8)
    v_mfma_f32_16x16x32_bf16 v[140:143], v[64:67], v[32:35], v[140:143]
    v_mfma_f32_16x16x32_bf16 v[148:151], v[64:67], v[36:39], v[148:151]
    v_mfma_f32_16x16x32_bf16 v[152:155], v[68:71], v[36:39], v[152:155]
    v_cmp_gt_i32 vcc, 0, v4
    s_nop 1
    v_cndmask_b32 v140, v140, v6, vcc
    v_cmp_gt_i32 vcc, 1, v4
    s_nop 1
    v_cndmask_b32 v141, v141, v6, vcc
    v_cmp_gt_i32 vcc, 2, v4
    s_nop 1
    v_cndmask_b32 v142, v142, v6, vcc
    v_cmp_gt_i32 vcc, 3, v4
    s_nop 1
    v_cndmask_b32 v143, v143, v6, vcc
    v_cmp_gt_i32 vcc, 0, v4
    s_nop 1
    v_cndmask_b32 v152, v152, v6, vcc
    v_cmp_gt_i32 vcc, 1, v4
    s_nop 1
    v_cndmask_b32 v153, v153, v6, vcc
    v_cmp_gt_i32 vcc, 2, v4
    s_nop 1
    v_cndmask_b32 v154, v154, v6, vcc
    v_cmp_gt_i32 vcc, 3, v4
    s_nop 1
    v_cndmask_b32 v155, v155, v6, vcc
    s_waitcnt vmcnt(0)
    s_cmp_lg_u32 s3, 0
    s_cbranch_scc1 L_w_attm_52_d
    s_lshl_b32 s60, s20, 9
    s_add_u32 s60, s60, 69271552
    v_and_b32 v232, 3, v0
    v_lshlrev_b32 v232, 7, v232
    v_add_u32 v232, s60, v232
    s_mov_b32 s61, 0
L_w_attm_52:
    global_load_dword v233, v232, s[6:7] sc1
    s_add_u32 s61, s61, 1
    s_waitcnt vmcnt(0)
    v_readlane_b32 s60, v233, 0
    v_readlane_b32 s62, v233, 1
    s_nop 0
    s_add_u32 s60, s60, s62
    v_readlane_b32 s62, v233, 2
    s_nop 0
    s_add_u32 s60, s60, s62
    v_readlane_b32 s62, v233, 3
    s_nop 0
    s_add_u32 s60, s60, s62
    s_cmp_ge_u32 s61, 100000
    s_cselect_b32 s63, 1, s63
    s_cmp_lg_u32 s63, 0
    s_cbranch_scc1 L_w_attm_52_d
    s_cmp_ge_u32 s60, 1118464
    s_cbranch_scc1 L_w_attm_52_d
    s_branch L_w_attm_52
L_w_attm_52_d:
    s_barrier
    buffer_load_dwordx4 v[72:75], v2, s[8:11], s45 offen offset:0 sc1
    buffer_load_dwordx4 v[76:79], v2, s[8:11], s45 offen offset:1024 sc1
    buffer_load_dwordx4 v[80:83], v2, s[8:11], s45 offen offset:2048 sc1
    buffer_load_dwordx4 v[84:87], v2, s[8:11], s45 offen offset:3072 sc1
    buffer_load_dwordx2 v[120:121], v3, s[8:11], s46 offen offset:0 sc1
    buffer_load_dwordx2 v[124:125], v3, s[8:11], s46 offen offset:512 sc1
    buffer_load_dwordx2 v[128:129], v3, s[8:11], s46 offen offset:1024 sc1
    buffer_load_dwordx2 v[132:133], v3, s[8:11], s46 offen offset:1536 sc1
    s_waitcnt vmcnt(7)
    v_mfma_f32_16x16x32_bf16 v[136:139], v[72:75], v[8:11], 0
    v_mfma_f32_16x16x32_bf16 v[144:147], v[72:75], v[12:15], 0
    s_waitcnt vmcnt(6)
    v_mfma_f32_16x16x32_bf16 v[136:139], v[76:79], v[16:19], v[136:139]
    v_mfma_f32_16x16x32_bf16 v[144:147], v[76:79], v[20:23], v[144:147]
    s_waitcnt vmcnt(5)
    v_mfma_f32_16x16x32_bf16 v[136:139], v[80:83], v[24:27], v[136:139]
    v_mfma_f32_16x16x32_bf16 v[144:147], v[80:83], v[28:31], v[144:147]
    s_waitcnt vmcnt(4)
    v_mfma_f32_16x16x32_bf16 v[136:139], v[84:87], v[32:35], v[136:139]
    v_mfma_f32_16x16x32_bf16 v[144:147], v[84:87], v[36:39], v[144:147]
    s_nop 3
    v_max3_f32 v224, v136, v137, v140
    v_max3_f32 v224, v224, v141, v142
    v_max_f32 v224, v224, v143
    v_mov_b32 v228, v224
    s_nop 1
    v_permlane32_swap_b32 v228, v224
    v_max_f32 v224, v224, v228
    v_mov_b32 v228, v224
    s_nop 1
    v_permlane16_swap_b32 v228, v224
    v_max_f32 v224, v224, v228
    v_mul_f32 v224, s48, v224
    v_fma_f32 v136, v136, s48, -v224
    v_fma_f32 v137, v137, s48, -v224
    v_fma_f32 v140, v140, s48, -v224
    v_fma_f32 v141, v141, s48, -v224
    v_fma_f32 v142, v142, s48, -v224
    v_fma_f32 v143, v143, s48, -v224
    v_exp_f32 v136, v136
    v_exp_f32 v137, v137
    v_exp_f32 v140, v140
    v_exp_f32 v141, v141
    v_exp_f32 v142, v142
    v_exp_f32 v143, v143
    v_add_f32 v226, v136, v137
    v_add_f32 v226, v226, v140
    v_add_f32 v226, v226, v141
    v_add_f32 v226, v226, v142
    v_add_f32 v226, v226, v143
    v_mov_b32 v228, v226
    s_nop 1
    v_permlane32_swap_b32 v228, v226
    v_add_f32 v226, v226, v228
    v_mov_b32 v228, v226
    s_nop 1
    v_permlane16_swap_b32 v228, v226
    v_add_f32 v226, v226, v228
    v_rcp_f32 v226, v226
    v_max3_f32 v225, v144, v145, v148
    v_max3_f32 v225, v225, v149, v150
    v_max3_f32 v225, v225, v151, v152
    v_max3_f32 v225, v225, v153, v154
    v_max_f32 v225, v225, v155
    v_mov_b32 v228, v225
    s_nop 1
    v_permlane32_swap_b32 v228, v225
    v_max_f32 v225, v225, v228
    v_mov_b32 v228, v225
    s_nop 1
    v_permlane16_swap_b32 v228, v225
    v_max_f32 v225, v225, v228
    v_mul_f32 v225, s48, v225
    v_fma_f32 v144, v144, s48, -v225
    v_fma_f32 v145, v145, s48, -v225
    v_fma_f32 v148, v148, s48, -v225
    v_fma_f32 v149, v149, s48, -v225
    v_fma_f32 v150, v150, s48, -v225
    v_fma_f32 v151, v151, s48, -v225
    v_fma_f32 v152, v152, s48, -v225
    v_fma_f32 v153, v153, s48, -v225
    v_fma_f32 v154, v154, s48, -v225
    v_fma_f32 v155, v155, s48, -v225
    v_exp_f32 v144, v144
    v_exp_f32 v145, v145
    v_exp_f32 v148, v148
    v_exp_f32 v149, v149
    v_exp_f32 v150, v150
    v_exp_f32 v151, v151
    v_exp_f32 v152, v152
    v_exp_f32 v153, v153
    v_exp_f32 v154, v154
    v_exp_f32 v155, v155
    v_add_f32 v227, v144, v145
    v_add_f32 v227, v227, v148
    v_add_f32 v227, v227, v149
    v_add_f32 v227, v227, v150
    v_add_f32 v227, v227, v151
    v_add_f32 v227, v227, v152
    v_add_f32 v227, v227, v153
    v_add_f32 v227, v227, v154
    v_add_f32 v227, v227, v155
    v_mov_b32 v228, v227
    s_nop 1
    v_permlane32_swap_b32 v228, v227
    v_add_f32 v227, v227, v228
    v_mov_b32 v228, v227
    s_nop 1
    v_permlane16_swap_b32 v228, v227
    v_add_f32 v227, v227, v228
    v_rcp_f32 v227, v227
    v_cvt_pk_bf16_f32 v40, v140, v141
    v_cvt_pk_bf16_f32 v41, v142, v143
    v_mov_b32 v42, 0
    v_mov_b32 v43, 0
    v_cvt_pk_bf16_f32 v44, v148, v149
    v_cvt_pk_bf16_f32 v45, v150, v151
    v_cvt_pk_bf16_f32 v46, v152, v153
    v_cvt_pk_bf16_f32 v47, v154, v155
    v_cvt_pk_bf16_f32 v48, v136, v137
    v_mov_b32 v49, 0
    v_cvt_pk_bf16_f32 v50, v144, v145
    v_mov_b32 v51, 0
    s_waitcnt vmcnt(0)
    v_mov_b32 v122, v121
    v_mov_b32 v123, v120
    v_mov_b32 v126, v125
    v_mov_b32 v127, v124
    v_mov_b32 v130, v129
    v_mov_b32 v131, v128
    v_mov_b32 v134, v133
    v_mov_b32 v135, v132
    s_lshl_b32 s49, s20, 18
    s_lshl_b32 s50, s21, 12
    s_add_u32 s49, s49, s50
    s_add_u32 s49, s49, 73400320
    s_add_u32 s50, s49, 131072
    v_mfma_f32_16x16x32_bf16 v[160:163], v[88:91], v[40:43], 0
    v_mfma_f32_16x16x32_bf16 v[164:167], v[88:91], v[44:47], 0
    v_mfma_f32_16x16x32_bf16 v[168:171], v[92:95], v[40:43], 0
    v_mfma_f32_16x16x32_bf16 v[172:175], v[92:95], v[44:47], 0
    v_mfma_f32_16x16x16_bf16 v[160:163], v[120:121], v[48:49], v[160:163]
    v_mfma_f32_16x16x16_bf16 v[164:167], v[120:121], v[50:51], v[164:167]
    v_mfma_f32_16x16x16_bf16 v[168:171], v[122:123], v[48:49], v[168:171]
    v_mfma_f32_16x16x16_bf16 v[172:175], v[122:123], v[50:51], v[172:175]
    v_mfma_f32_16x16x32_bf16 v[176:179], v[96:99], v[40:43], 0
    v_mfma_f32_16x16x32_bf16 v[180:183], v[96:99], v[44:47], 0
    v_mfma_f32_16x16x32_bf16 v[184:187], v[100:103], v[40:43], 0
    v_mfma_f32_16x16x32_bf16 v[188:191], v[100:103], v[44:47], 0
    v_mfma_f32_16x16x16_bf16 v[176:179], v[124:125], v[48:49], v[176:179]
    v_mfma_f32_16x16x16_bf16 v[180:183], v[124:125], v[50:51], v[180:183]
    v_mfma_f32_16x16x16_bf16 v[184:187], v[126:127], v[48:49], v[184:187]
    v_mfma_f32_16x16x16_bf16 v[188:191], v[126:127], v[50:51], v[188:191]
    v_mfma_f32_16x16x32_bf16 v[192:195], v[104:107], v[40:43], 0
    v_mfma_f32_16x16x32_bf16 v[196:199], v[104:107], v[44:47], 0
    v_mfma_f32_16x16x32_bf16 v[200:203], v[108:111], v[40:43], 0
    v_mfma_f32_16x16x32_bf16 v[204:207], v[108:111], v[44:47], 0
    v_mfma_f32_16x16x16_bf16 v[192:195], v[128:129], v[48:49], v[192:195]
    v_mfma_f32_16x16x16_bf16 v[196:199], v[128:129], v[50:51], v[196:199]
    v_mfma_f32_16x16x16_bf16 v[200:203], v[130:131], v[48:49], v[200:203]
    v_mfma_f32_16x16x16_bf16 v[204:207], v[130:131], v[50:51], v[204:207]
    v_mfma_f32_16x16x32_bf16 v[208:211], v[112:115], v[40:43], 0
    v_mfma_f32_16x16x32_bf16 v[212:215], v[112:115], v[44:47], 0
    v_mfma_f32_16x16x32_bf16 v[216:219], v[116:119], v[40:43], 0
    v_mfma_f32_16x16x32_bf16 v[220:223], v[116:119], v[44:47], 0
    v_mfma_f32_16x16x16_bf16 v[208:211], v[132:133], v[48:49], v[208:211]
    v_mfma_f32_16x16x16_bf16 v[212:215], v[132:133], v[50:51], v[212:215]
    v_mfma_f32_16x16x16_bf16 v[216:219], v[134:135], v[48:49], v[216:219]
    v_mfma_f32_16x16x16_bf16 v[220:223], v[134:135], v[50:51], v[220:223]
    v_mul_f32 v160, v160, v226
    v_mul_f32 v161, v161, v226
    v_mul_f32 v162, v162, v226
    v_mul_f32 v163, v163, v226
    v_cvt_pk_bf16_f32 v8, v160, v161
    v_cvt_pk_bf16_f32 v9, v162, v163
    v_mul_f32 v168, v168, v226
    v_mul_f32 v169, v169, v226
    v_mul_f32 v170, v170, v226
    v_mul_f32 v171, v171, v226
    v_cvt_pk_bf16_f32 v10, v168, v169
    v_cvt_pk_bf16_f32 v11, v170, v171
    buffer_store_dwordx4 v[8:11], v2, s[8:11], s49 offen offset:0 sc1
    v_mul_f32 v164, v164, v227
    v_mul_f32 v165, v165, v227
    v_mul_f32 v166, v166, v227
    v_mul_f32 v167, v167, v227
    v_cvt_pk_bf16_f32 v24, v164, v165
    v_cvt_pk_bf16_f32 v25, v166, v167
    v_mul_f32 v172, v172, v227
    v_mul_f32 v173, v173, v227
    v_mul_f32 v174, v174, v227
    v_mul_f32 v175, v175, v227
    v_cvt_pk_bf16_f32 v26, v172, v173
    v_cvt_pk_bf16_f32 v27, v174, v175
    buffer_store_dwordx4 v[24:27], v2, s[8:11], s50 offen offset:0 sc1
    v_mul_f32 v176, v176, v226
    v_mul_f32 v177, v177, v226
    v_mul_f32 v178, v178, v226
    v_mul_f32 v179, v179, v226
    v_cvt_pk_bf16_f32 v12, v176, v177
    v_cvt_pk_bf16_f32 v13, v178, v179
    v_mul_f32 v184, v184, v226
    v_mul_f32 v185, v185, v226
    v_mul_f32 v186, v186, v226
    v_mul_f32 v187, v187, v226
    v_cvt_pk_bf16_f32 v14, v184, v185
    v_cvt_pk_bf16_f32 v15, v186, v187
    buffer_store_dwordx4 v[12:15], v2, s[8:11], s49 offen offset:1024 sc1
    v_mul_f32 v180, v180, v227
    v_mul_f32 v181, v181, v227
    v_mul_f32 v182, v182, v227
    v_mul_f32 v183, v183, v227
    v_cvt_pk_bf16_f32 v28, v180, v181
    v_cvt_pk_bf16_f32 v29, v182, v183
    v_mul_f32 v188, v188, v227
    v_mul_f32 v189, v189, v227
    v_mul_f32 v190, v190, v227
    v_mul_f32 v191, v191, v227
    v_cvt_pk_bf16_f32 v30, v188, v189
    v_cvt_pk_bf16_f32 v31, v190, v191
    buffer_store_dwordx4 v[28:31], v2, s[8:11], s50 offen offset:1024 sc1
    v_mul_f32 v192, v192, v226
    v_mul_f32 v193, v193, v226
    v_mul_f32 v194, v194, v226
    v_mul_f32 v195, v195, v226
    v_cvt_pk_bf16_f32 v16, v192, v193
    v_cvt_pk_bf16_f32 v17, v194, v195
    v_mul_f32 v200, v200, v226
    v_mul_f32 v201, v201, v226
    v_mul_f32 v202, v202, v226
    v_mul_f32 v203, v203, v226
    v_cvt_pk_bf16_f32 v18, v200, v201
    v_cvt_pk_bf16_f32 v19, v202, v203
    buffer_store_dwordx4 v[16:19], v2, s[8:11], s49 offen offset:2048 sc1
    v_mul_f32 v196, v196, v227
    v_mul_f32 v197, v197, v227
    v_mul_f32 v198, v198, v227
    v_mul_f32 v199, v199, v227
    v_cvt_pk_bf16_f32 v32, v196, v197
    v_cvt_pk_bf16_f32 v33, v198, v199
    v_mul_f32 v204, v204, v227
    v_mul_f32 v205, v205, v227
    v_mul_f32 v206, v206, v227
    v_mul_f32 v207, v207, v227
    v_cvt_pk_bf16_f32 v34, v204, v205
    v_cvt_pk_bf16_f32 v35, v206, v207
    buffer_store_dwordx4 v[32:35], v2, s[8:11], s50 offen offset:2048 sc1
    v_mul_f32 v208, v208, v226
    v_mul_f32 v209, v209, v226
    v_mul_f32 v210, v210, v226
    v_mul_f32 v211, v211, v226
    v_cvt_pk_bf16_f32 v20, v208, v209
    v_cvt_pk_bf16_f32 v21, v210, v211
    v_mul_f32 v216, v216, v226
    v_mul_f32 v217, v217, v226
    v_mul_f32 v218, v218, v226
    v_mul_f32 v219, v219, v226
    v_cvt_pk_bf16_f32 v22, v216, v217
    v_cvt_pk_bf16_f32 v23, v218, v219
    buffer_store_dwordx4 v[20:23], v2, s[8:11], s49 offen offset:3072 sc1
    v_mul_f32 v212, v212, v227
    v_mul_f32 v213, v213, v227
    v_mul_f32 v214, v214, v227
    v_mul_f32 v215, v215, v227
    v_cvt_pk_bf16_f32 v36, v212, v213
    v_cvt_pk_bf16_f32 v37, v214, v215
    v_mul_f32 v220, v220, v227
    v_mul_f32 v221, v221, v227
    v_mul_f32 v222, v222, v227
    v_mul_f32 v223, v223, v227
    v_cvt_pk_bf16_f32 v38, v220, v221
    v_cvt_pk_bf16_f32 v39, v222, v223
    buffer_store_dwordx4 v[36:39], v2, s[8:11], s50 offen offset:3072 sc1
    s_waitcnt vmcnt(0)
    s_barrier
    s_cmp_lg_u32 s3, 0
    s_cbranch_scc1 L_sg_53
    s_lshl_b32 s60, s20, 9
    s_add_u32 s60, s60, 69304320
    v_mov_b32 v232, s60
    v_mov_b32 v233, 1
    s_mov_b64 exec, 1
    global_atomic_add v232, v233, s[6:7]
    s_mov_b64 exec, -1
L_sg_53:
    s_add_u32 s20, s20, 3
    s_cmp_lt_u32 s20, 64
    s_cbranch_scc1 L_att_loop
    s_branch L_post_end
L_role_op:
    s_cmp_ge_u32 s16, 20
    s_cselect_b32 s28, 1, 0
    s_mul_i32 s29, s28, 20
    s_sub_u32 s29, s16, s29
    s_load_dwordx2 s[24:25], s[0:1], 40
    s_load_dwordx2 s[26:27], s[0:1], 0
    s_lshl_b32 s21, s29, 6
    s_mov_b32 s20, s28
    s_lshl_b32 s22, s3, 5
    s_lshl_b32 s23, s22, 5
    s_waitcnt lgkmcnt(0)
    s_mov_b32 s12, s24
    s_mov_b32 s13, s25
    s_mov_b32 s14, 0x500000
    s_mov_b32 s15, 0x20000
    s_mov_b32 s16, s26
    s_mov_b32 s17, s27
    s_mov_b32 s18, 0x280000
    s_mov_b32 s19, 0x20000
    v_and_b32 v1, 63, v0
    v_lshrrev_b32 v4, 2, v1
    v_and_b32 v5, 3, v1
    s_mov_b32 s40, 1280
    v_mul_lo_u32 v6, s40, v4
    v_lshlrev_b32 v7, 4, v5
    v_add3_u32 v6, v6, v7, s21
    v_mul_u32_u24 v4, 96, v4
    v_add_u32 v4, v4, v7
    s_mul_i32 s41, s3, 6144
    s_add_u32 s41, s41, 16384
    v_add_u32 v4, s41, v4
    v_and_b32 v5, 15, v1
    v_lshrrev_b32 v7, 4, v1
    v_lshlrev_b32 v7, 2, v7
    v_lshrrev_b32 v8, 2, v5
    v_add_u32 v7, v7, v8
    v_mul_u32_u24 v7, 96, v7
    v_and_b32 v5, 3, v5
    v_lshlrev_b32 v5, 3, v5
    v_add3_u32 v7, v7, v5, s41
    s_mul_i32 s42, s23, 1280
    buffer_load_dwordx4 v[10:13], v6, s[12:15], s42 offen
    s_add_u32 s42, s42, 20480
    buffer_load_dwordx4 v[14:17], v6, s[12:15], s42 offen
    s_add_u32 s42, s42, 20480
    buffer_load_dwordx4 v[18:21], v6, s[12:15], s42 offen
    s_add_u32 s42, s42, 20480
    buffer_load_dwordx4 v[22:25], v6, s[12:15], s42 offen
    s_add_u32 s42, s42, 20480
    buffer_load_dwordx4 v[26:29], v6, s[12:15], s42 offen
    s_add_u32 s42, s42, 20480
    buffer_load_dwordx4 v[30:33], v6, s[12:15], s42 offen
    s_add_u32 s42, s42, 20480
    buffer_load_dwordx4 v[34:37], v6, s[12:15], s42 offen
    s_add_u32 s42, s42, 20480
    buffer_load_dwordx4 v[38:41], v6, s[12:15], s42 offen
    s_add_u32 s42, s42, 20480
    buffer_load_dwordx4 v[42:45], v6, s[12:15], s42 offen
    s_add_u32 s42, s42, 20480
    buffer_load_dwordx4 v[46:49], v6, s[12:15], s42 offen
    s_add_u32 s42, s42, 20480
    buffer_load_dwordx4 v[50:53], v6, s[12:15], s42 offen
    s_add_u32 s42, s42, 20480
    buffer_load_dwordx4 v[54:57], v6, s[12:15], s42 offen
    s_add_u32 s42, s42, 20480
    buffer_load_dwordx4 v[58:61], v6, s[12:15], s42 offen
    s_add_u32 s42, s42, 20480
    buffer_load_dwordx4 v[62:65], v6, s[12:15], s42 offen
    s_add_u32 s42, s42, 20480
    buffer_load_dwordx4 v[66:69], v6, s[12:15], s42 offen
    s_add_u32 s42, s42, 20480
    buffer_load_dwordx4 v[70:73], v6, s[12:15], s42 offen
    s_add_u32 s42, s42, 20480
    s_waitcnt vmcnt(14)
    ds_write_b128 v4, v[10:13] offset:0
    ds_write_b128 v4, v[14:17] offset:1536
    buffer_load_dwordx4 v[10:13], v6, s[12:15], s42 offen
    s_add_u32 s42, s42, 20480
    buffer_load_dwordx4 v[14:17], v6, s[12:15], s42 offen
    s_add_u32 s42, s42, 20480
    ds_read_b64_tr_b16 a[0:1], v7 offset:0
    ds_read_b64_tr_b16 a[2:3], v7 offset:1536
    ds_read_b64_tr_b16 a[4:5], v7 offset:32
    ds_read_b64_tr_b16 a[6:7], v7 offset:1568
    s_waitcnt vmcnt(14)
    ds_write_b128 v4, v[18:21] offset:3072
    ds_write_b128 v4, v[22:25] offset:4608
    buffer_load_dwordx4 v[18:21], v6, s[12:15], s42 offen
    s_add_u32 s42, s42, 20480
    buffer_load_dwordx4 v[22:25], v6, s[12:15], s42 offen
    s_add_u32 s42, s42, 20480
    ds_read_b64_tr_b16 a[8:9], v7 offset:3072
    ds_read_b64_tr_b16 a[10:11], v7 offset:4608
    ds_read_b64_tr_b16 a[12:13], v7 offset:3104
    ds_read_b64_tr_b16 a[14:15], v7 offset:4640
    s_waitcnt lgkmcnt(0)
    s_waitcnt vmcnt(14)
    ds_write_b128 v4, v[26:29] offset:0
    ds_write_b128 v4, v[30:33] offset:1536
    buffer_load_dwordx4 v[26:29], v6, s[12:15], s42 offen
    s_add_u32 s42, s42, 20480
    buffer_load_dwordx4 v[30:33], v6, s[12:15], s42 offen
    s_add_u32 s42, s42, 20480
    ds_read_b64_tr_b16 a[16:17], v7 offset:0
    ds_read_b64_tr_b16 a[18:19], v7 offset:1536
    ds_read_b64_tr_b16 a[20:21], v7 offset:32
    ds_read_b64_tr_b16 a[22:23], v7 offset:1568
    s_waitcnt vmcnt(14)
    ds_write_b128 v4, v[34:37] offset:3072
    ds_write_b128 v4, v[38:41] offset:4608
    buffer_load_dwordx4 v[34:37], v6, s[12:15], s42 offen
    s_add_u32 s42, s42, 20480
    buffer_load_dwordx4 v[38:41], v6, s[12:15], s42 offen
    s_add_u32 s42, s42, 20480
    ds_read_b64_tr_b16 a[24:25], v7 offset:3072
    ds_read_b64_tr_b16 a[26:27], v7 offset:4608
    ds_read_b64_tr_b16 a[28:29], v7 offset:3104
    ds_read_b64_tr_b16 a[30:31], v7 offset:4640
    s_waitcnt lgkmcnt(0)
    s_waitcnt vmcnt(14)
    ds_write_b128 v4, v[42:45] offset:0
    ds_write_b128 v4, v[46:49] offset:1536
    buffer_load_dwordx4 v[42:45], v6, s[12:15], s42 offen
    s_add_u32 s42, s42, 20480
    buffer_load_dwordx4 v[46:49], v6, s[12:15], s42 offen
    s_add_u32 s42, s42, 20480
    ds_read_b64_tr_b16 a[32:33], v7 offset:0
    ds_read_b64_tr_b16 a[34:35], v7 offset:1536
    ds_read_b64_tr_b16 a[36:37], v7 offset:32
    ds_read_b64_tr_b16 a[38:39], v7 offset:1568
    s_waitcnt vmcnt(14)
    ds_write_b128 v4, v[50:53] offset:3072
    ds_write_b128 v4, v[54:57] offset:4608
    buffer_load_dwordx4 v[50:53], v6, s[12:15], s42 offen
    s_add_u32 s42, s42, 20480
    buffer_load_dwordx4 v[54:57], v6, s[12:15], s42 offen
    s_add_u32 s42, s42, 20480
    ds_read_b64_tr_b16 a[40:41], v7 offset:3072
    ds_read_b64_tr_b16 a[42:43], v7 offset:4608
    ds_read_b64_tr_b16 a[44:45], v7 offset:3104
    ds_read_b64_tr_b16 a[46:47], v7 offset:4640
    s_waitcnt lgkmcnt(0)
    s_waitcnt vmcnt(14)
    ds_write_b128 v4, v[58:61] offset:0
    ds_write_b128 v4, v[62:65] offset:1536
    buffer_load_dwordx4 v[58:61], v6, s[12:15], s42 offen
    s_add_u32 s42, s42, 20480
    buffer_load_dwordx4 v[62:65], v6, s[12:15], s42 offen
    s_add_u32 s42, s42, 20480
    ds_read_b64_tr_b16 a[48:49], v7 offset:0
    ds_read_b64_tr_b16 a[50:51], v7 offset:1536
    ds_read_b64_tr_b16 a[52:53], v7 offset:32
    ds_read_b64_tr_b16 a[54:55], v7 offset:1568
    s_waitcnt vmcnt(14)
    ds_write_b128 v4, v[66:69] offset:3072
    ds_write_b128 v4, v[70:73] offset:4608
    buffer_load_dwordx4 v[66:69], v6, s[12:15], s42 offen
    s_add_u32 s42, s42, 20480
    buffer_load_dwordx4 v[70:73], v6, s[12:15], s42 offen
    s_add_u32 s42, s42, 20480
    ds_read_b64_tr_b16 a[56:57], v7 offset:3072
    ds_read_b64_tr_b16 a[58:59], v7 offset:4608
    ds_read_b64_tr_b16 a[60:61], v7 offset:3104
    ds_read_b64_tr_b16 a[62:63], v7 offset:4640
    s_waitcnt lgkmcnt(0)
    s_waitcnt vmcnt(14)
    ds_write_b128 v4, v[10:13] offset:0
    ds_write_b128 v4, v[14:17] offset:1536
    buffer_load_dwordx4 v[10:13], v6, s[12:15], s42 offen
    s_add_u32 s42, s42, 20480
    buffer_load_dwordx4 v[14:17], v6, s[12:15], s42 offen
    s_add_u32 s42, s42, 20480
    ds_read_b64_tr_b16 a[64:65], v7 offset:0
    ds_read_b64_tr_b16 a[66:67], v7 offset:1536
    ds_read_b64_tr_b16 a[68:69], v7 offset:32
    ds_read_b64_tr_b16 a[70:71], v7 offset:1568
    s_waitcnt vmcnt(14)
    ds_write_b128 v4, v[18:21] offset:3072
    ds_write_b128 v4, v[22:25] offset:4608
    buffer_load_dwordx4 v[18:21], v6, s[12:15], s42 offen
    s_add_u32 s42, s42, 20480
    buffer_load_dwordx4 v[22:25], v6, s[12:15], s42 offen
    s_add_u32 s42, s42, 20480
    ds_read_b64_tr_b16 a[72:73], v7 offset:3072
    ds_read_b64_tr_b16 a[74:75], v7 offset:4608
    ds_read_b64_tr_b16 a[76:77], v7 offset:3104
    ds_read_b64_tr_b16 a[78:79], v7 offset:4640
    s_waitcnt lgkmcnt(0)
    s_waitcnt vmcnt(14)
    ds_write_b128 v4, v[26:29] offset:0
    ds_write_b128 v4, v[30:33] offset:1536
    buffer_load_dwordx4 v[26:29], v6, s[12:15], s42 offen
    s_add_u32 s42, s42, 20480
    buffer_load_dwordx4 v[30:33], v6, s[12:15], s42 offen
    s_add_u32 s42, s42, 20480
    ds_read_b64_tr_b16 a[80:81], v7 offset:0
    ds_read_b64_tr_b16 a[82:83], v7 offset:1536
    ds_read_b64_tr_b16 a[84:85], v7 offset:32
    ds_read_b64_tr_b16 a[86:87], v7 offset:1568
    s_waitcnt vmcnt(14)
    ds_write_b128 v4, v[34:37] offset:3072
    ds_write_b128 v4, v[38:41] offset:4608
    buffer_load_dwordx4 v[34:37], v6, s[12:15], s42 offen
    s_add_u32 s42, s42, 20480
    buffer_load_dwordx4 v[38:41], v6, s[12:15], s42 offen
    s_add_u32 s42, s42, 20480
    ds_read_b64_tr_b16 a[88:89], v7 offset:3072
    ds_read_b64_tr_b16 a[90:91], v7 offset:4608
    ds_read_b64_tr_b16 a[92:93], v7 offset:3104
    ds_read_b64_tr_b16 a[94:95], v7 offset:4640
    s_waitcnt lgkmcnt(0)
    s_waitcnt vmcnt(14)
    ds_write_b128 v4, v[42:45] offset:0
    ds_write_b128 v4, v[46:49] offset:1536
    buffer_load_dwordx4 v[42:45], v6, s[12:15], s42 offen
    s_add_u32 s42, s42, 20480
    buffer_load_dwordx4 v[46:49], v6, s[12:15], s42 offen
    s_add_u32 s42, s42, 20480
    ds_read_b64_tr_b16 a[96:97], v7 offset:0
    ds_read_b64_tr_b16 a[98:99], v7 offset:1536
    ds_read_b64_tr_b16 a[100:101], v7 offset:32
    ds_read_b64_tr_b16 a[102:103], v7 offset:1568
    s_waitcnt vmcnt(14)
    ds_write_b128 v4, v[50:53] offset:3072
    ds_write_b128 v4, v[54:57] offset:4608
    buffer_load_dwordx4 v[50:53], v6, s[12:15], s42 offen
    s_add_u32 s42, s42, 20480
    buffer_load_dwordx4 v[54:57], v6, s[12:15], s42 offen
    s_add_u32 s42, s42, 20480
    ds_read_b64_tr_b16 a[104:105], v7 offset:3072
    ds_read_b64_tr_b16 a[106:107], v7 offset:4608
    ds_read_b64_tr_b16 a[108:109], v7 offset:3104
    ds_read_b64_tr_b16 a[110:111], v7 offset:4640
    s_waitcnt lgkmcnt(0)
    s_waitcnt vmcnt(14)
    ds_write_b128 v4, v[58:61] offset:0
    ds_write_b128 v4, v[62:65] offset:1536
    buffer_load_dwordx4 v[58:61], v6, s[12:15], s42 offen
    s_add_u32 s42, s42, 20480
    buffer_load_dwordx4 v[62:65], v6, s[12:15], s42 offen
    s_add_u32 s42, s42, 20480
    ds_read_b64_tr_b16 a[112:113], v7 offset:0
    ds_read_b64_tr_b16 a[114:115], v7 offset:1536
    ds_read_b64_tr_b16 a[116:117], v7 offset:32
    ds_read_b64_tr_b16 a[118:119], v7 offset:1568
    s_waitcnt vmcnt(14)
    ds_write_b128 v4, v[66:69] offset:3072
    ds_write_b128 v4, v[70:73] offset:4608
    buffer_load_dwordx4 v[66:69], v6, s[12:15], s42 offen
    s_add_u32 s42, s42, 20480
    buffer_load_dwordx4 v[70:73], v6, s[12:15], s42 offen
    s_add_u32 s42, s42, 20480
    ds_read_b64_tr_b16 a[120:121], v7 offset:3072
    ds_read_b64_tr_b16 a[122:123], v7 offset:4608
    ds_read_b64_tr_b16 a[124:125], v7 offset:3104
    ds_read_b64_tr_b16 a[126:127], v7 offset:4640
    s_waitcnt lgkmcnt(0)
    s_waitcnt vmcnt(14)
    ds_write_b128 v4, v[10:13] offset:0
    ds_write_b128 v4, v[14:17] offset:1536
    buffer_load_dwordx4 v[10:13], v6, s[12:15], s42 offen
    s_add_u32 s42, s42, 20480
    buffer_load_dwordx4 v[14:17], v6, s[12:15], s42 offen
    s_add_u32 s42, s42, 20480
    ds_read_b64_tr_b16 a[128:129], v7 offset:0
    ds_read_b64_tr_b16 a[130:131], v7 offset:1536
    ds_read_b64_tr_b16 a[132:133], v7 offset:32
    ds_read_b64_tr_b16 a[134:135], v7 offset:1568
    s_waitcnt vmcnt(14)
    ds_write_b128 v4, v[18:21] offset:3072
    ds_write_b128 v4, v[22:25] offset:4608
    buffer_load_dwordx4 v[18:21], v6, s[12:15], s42 offen
    s_add_u32 s42, s42, 20480
    buffer_load_dwordx4 v[22:25], v6, s[12:15], s42 offen
    s_add_u32 s42, s42, 20480
    ds_read_b64_tr_b16 a[136:137], v7 offset:3072
    ds_read_b64_tr_b16 a[138:139], v7 offset:4608
    ds_read_b64_tr_b16 a[140:141], v7 offset:3104
    ds_read_b64_tr_b16 a[142:143], v7 offset:4640
    s_waitcnt lgkmcnt(0)
    s_waitcnt vmcnt(14)
    ds_write_b128 v4, v[26:29] offset:0
    ds_write_b128 v4, v[30:33] offset:1536
    buffer_load_dwordx4 v[26:29], v6, s[12:15], s42 offen
    s_add_u32 s42, s42, 20480
    buffer_load_dwordx4 v[30:33], v6, s[12:15], s42 offen
    s_add_u32 s42, s42, 20480
    ds_read_b64_tr_b16 a[144:145], v7 offset:0
    ds_read_b64_tr_b16 a[146:147], v7 offset:1536
    ds_read_b64_tr_b16 a[148:149], v7 offset:32
    ds_read_b64_tr_b16 a[150:151], v7 offset:1568
    s_waitcnt vmcnt(14)
    ds_write_b128 v4, v[34:37] offset:3072
    ds_write_b128 v4, v[38:41] offset:4608
    buffer_load_dwordx4 v[34:37], v6, s[12:15], s42 offen
    s_add_u32 s42, s42, 20480
    buffer_load_dwordx4 v[38:41], v6, s[12:15], s42 offen
    s_add_u32 s42, s42, 20480
    ds_read_b64_tr_b16 a[152:153], v7 offset:3072
    ds_read_b64_tr_b16 a[154:155], v7 offset:4608
    ds_read_b64_tr_b16 a[156:157], v7 offset:3104
    ds_read_b64_tr_b16 a[158:159], v7 offset:4640
    s_waitcnt lgkmcnt(0)
    s_waitcnt vmcnt(14)
    ds_write_b128 v4, v[42:45] offset:0
    ds_write_b128 v4, v[46:49] offset:1536
    buffer_load_dwordx4 v[42:45], v6, s[12:15], s42 offen
    s_add_u32 s42, s42, 20480
    buffer_load_dwordx4 v[46:49], v6, s[12:15], s42 offen
    s_add_u32 s42, s42, 20480
    ds_read_b64_tr_b16 a[160:161], v7 offset:0
    ds_read_b64_tr_b16 a[162:163], v7 offset:1536
    ds_read_b64_tr_b16 a[164:165], v7 offset:32
    ds_read_b64_tr_b16 a[166:167], v7 offset:1568
    s_waitcnt vmcnt(14)
    ds_write_b128 v4, v[50:53] offset:3072
    ds_write_b128 v4, v[54:57] offset:4608
    buffer_load_dwordx4 v[50:53], v6, s[12:15], s42 offen
    s_add_u32 s42, s42, 20480
    buffer_load_dwordx4 v[54:57], v6, s[12:15], s42 offen
    s_add_u32 s42, s42, 20480
    ds_read_b64_tr_b16 a[168:169], v7 offset:3072
    ds_read_b64_tr_b16 a[170:171], v7 offset:4608
    ds_read_b64_tr_b16 a[172:173], v7 offset:3104
    ds_read_b64_tr_b16 a[174:175], v7 offset:4640
    s_waitcnt lgkmcnt(0)
    s_waitcnt vmcnt(14)
    ds_write_b128 v4, v[58:61] offset:0
    ds_write_b128 v4, v[62:65] offset:1536
    buffer_load_dwordx4 v[58:61], v6, s[12:15], s42 offen
    s_add_u32 s42, s42, 20480
    buffer_load_dwordx4 v[62:65], v6, s[12:15], s42 offen
    s_add_u32 s42, s42, 20480
    ds_read_b64_tr_b16 a[176:177], v7 offset:0
    ds_read_b64_tr_b16 a[178:179], v7 offset:1536
    ds_read_b64_tr_b16 a[180:181], v7 offset:32
    ds_read_b64_tr_b16 a[182:183], v7 offset:1568
    s_waitcnt vmcnt(14)
    ds_write_b128 v4, v[66:69] offset:3072
    ds_write_b128 v4, v[70:73] offset:4608
    buffer_load_dwordx4 v[66:69], v6, s[12:15], s42 offen
    s_add_u32 s42, s42, 20480
    buffer_load_dwordx4 v[70:73], v6, s[12:15], s42 offen
    s_add_u32 s42, s42, 20480
    ds_read_b64_tr_b16 a[184:185], v7 offset:3072
    ds_read_b64_tr_b16 a[186:187], v7 offset:4608
    ds_read_b64_tr_b16 a[188:189], v7 offset:3104
    ds_read_b64_tr_b16 a[190:191], v7 offset:4640
    s_waitcnt lgkmcnt(0)
    s_waitcnt vmcnt(14)
    ds_write_b128 v4, v[10:13] offset:0
    ds_write_b128 v4, v[14:17] offset:1536
    ds_read_b64_tr_b16 a[192:193], v7 offset:0
    ds_read_b64_tr_b16 a[194:195], v7 offset:1536
    ds_read_b64_tr_b16 a[196:197], v7 offset:32
    ds_read_b64_tr_b16 a[198:199], v7 offset:1568
    s_waitcnt vmcnt(12)
    ds_write_b128 v4, v[18:21] offset:3072
    ds_write_b128 v4, v[22:25] offset:4608
    ds_read_b64_tr_b16 a[200:201], v7 offset:3072
    ds_read_b64_tr_b16 a[202:203], v7 offset:4608
    ds_read_b64_tr_b16 a[204:205], v7 offset:3104
    ds_read_b64_tr_b16 a[206:207], v7 offset:4640
    s_waitcnt lgkmcnt(0)
    s_waitcnt vmcnt(10)
    ds_write_b128 v4, v[26:29] offset:0
    ds_write_b128 v4, v[30:33] offset:1536
    ds_read_b64_tr_b16 a[208:209], v7 offset:0
    ds_read_b64_tr_b16 a[210:211], v7 offset:1536
    ds_read_b64_tr_b16 a[212:213], v7 offset:32
    ds_read_b64_tr_b16 a[214:215], v7 offset:1568
    s_waitcnt vmcnt(8)
    ds_write_b128 v4, v[34:37] offset:3072
    ds_write_b128 v4, v[38:41] offset:4608
    ds_read_b64_tr_b16 a[216:217], v7 offset:3072
    ds_read_b64_tr_b16 a[218:219], v7 offset:4608
    ds_read_b64_tr_b16 a[220:221], v7 offset:3104
    ds_read_b64_tr_b16 a[222:223], v7 offset:4640
    s_waitcnt lgkmcnt(0)
    s_waitcnt vmcnt(6)
    ds_write_b128 v4, v[42:45] offset:0
    ds_write_b128 v4, v[46:49] offset:1536
    ds_read_b64_tr_b16 a[224:225], v7 offset:0
    ds_read_b64_tr_b16 a[226:227], v7 offset:1536
    ds_read_b64_tr_b16 a[228:229], v7 offset:32
    ds_read_b64_tr_b16 a[230:231], v7 offset:1568
    s_waitcnt vmcnt(4)
    ds_write_b128 v4, v[50:53] offset:3072
    ds_write_b128 v4, v[54:57] offset:4608
    ds_read_b64_tr_b16 a[232:233], v7 offset:3072
    ds_read_b64_tr_b16 a[234:235], v7 offset:4608
    ds_read_b64_tr_b16 a[236:237], v7 offset:3104
    ds_read_b64_tr_b16 a[238:239], v7 offset:4640
    s_waitcnt lgkmcnt(0)
    s_waitcnt vmcnt(2)
    ds_write_b128 v4, v[58:61] offset:0
    ds_write_b128 v4, v[62:65] offset:1536
    ds_read_b64_tr_b16 a[240:241], v7 offset:0
    ds_read_b64_tr_b16 a[242:243], v7 offset:1536
    ds_read_b64_tr_b16 a[244:245], v7 offset:32
    ds_read_b64_tr_b16 a[246:247], v7 offset:1568
    s_waitcnt vmcnt(0)
    ds_write_b128 v4, v[66:69] offset:3072
    ds_write_b128 v4, v[70:73] offset:4608
    ds_read_b64_tr_b16 a[248:249], v7 offset:3072
    ds_read_b64_tr_b16 a[250:251], v7 offset:4608
    ds_read_b64_tr_b16 a[252:253], v7 offset:3104
    ds_read_b64_tr_b16 a[254:255], v7 offset:4640
    s_waitcnt lgkmcnt(0)
    s_waitcnt lgkmcnt(0)
    v_and_b32 v1, 63, v0
    v_lshlrev_b32 v2, 4, v1
    s_lshl_b32 s40, s3, 12
    v_add_u32 v3, s40, v2
    s_lshl_b32 s40, s3, 10
    v_add_u32 v4, s40, v2
    v_and_b32 v5, 15, v1
    v_lshrrev_b32 v6, 4, v1
    s_and_b32 s41, s3, 1
    s_lshl_b32 s42, s41, 5
    s_add_u32 s42, s42, s21
    v_mul_u32_u24 v7, 1280, v5
    v_lshlrev_b32 v8, 3, v6
    v_add3_u32 v7, v7, v8, s42
    s_lshl_b32 s42, s41, 3
    v_add_u32 v8, s42, v2
    v_lshlrev_b32 v9, 3, v5
    s_lshr_b32 s31, s20, 1
    s_mov_b32 s35, 64
    s_cmp_lg_u32 s3, 0
    s_cbranch_scc1 L_w_op0_54_d
    s_lshl_b32 s60, s31, 9
    s_add_u32 s60, s60, 69304320
    v_and_b32 v12, 3, v0
    v_lshlrev_b32 v12, 7, v12
    v_add_u32 v12, s60, v12
    s_mov_b32 s61, 0
L_w_op0_54:
    global_load_dword v13, v12, s[6:7] sc1
    s_add_u32 s61, s61, 1
    s_waitcnt vmcnt(0)
    v_readlane_b32 s60, v13, 0
    v_readlane_b32 s62, v13, 1
    s_nop 0
    s_add_u32 s60, s60, s62
    v_readlane_b32 s62, v13, 2
    s_nop 0
    s_add_u32 s60, s60, s62
    v_readlane_b32 s62, v13, 3
    s_nop 0
    s_add_u32 s60, s60, s62
    s_cmp_ge_u32 s61, 100000
    s_cselect_b32 s63, 1, s63
    s_cmp_lg_u32 s63, 0
    s_cbranch_scc1 L_w_op0_54_d
    s_cmp_ge_u32 s60, 8
    s_cbranch_scc1 L_w_op0_54_d
    s_branch L_w_op0_54
L_w_op0_54_d:
    s_barrier
    s_mov_b32 s43, s20
    s_mul_i32 s44, s43, 131072
    s_lshl_b32 s45, s22, 10
    s_add_u32 s44, s44, s45
    s_add_u32 s44, s44, 73400320
    s_add_u32 s45, s44, 131072
    buffer_load_dwordx4 v[16:19], v2, s[8:11], s44 offen offset:0 sc1
    buffer_load_dwordx4 v[20:23], v2, s[8:11], s44 offen offset:1024 sc1
    buffer_load_dwordx4 v[24:27], v2, s[8:11], s44 offen offset:2048 sc1
    buffer_load_dwordx4 v[28:31], v2, s[8:11], s44 offen offset:3072 sc1
    s_add_u32 s49, s44, 4096
    buffer_load_dwordx4 v[32:35], v2, s[8:11], s49 offen sc1
    s_add_u32 s49, s44, 5120
    buffer_load_dwordx4 v[36:39], v2, s[8:11], s49 offen sc1
    s_add_u32 s49, s44, 6144
    buffer_load_dwordx4 v[40:43], v2, s[8:11], s49 offen sc1
    s_add_u32 s49, s44, 7168
    buffer_load_dwordx4 v[44:47], v2, s[8:11], s49 offen sc1
    s_add_u32 s49, s44, 8192
    buffer_load_dwordx4 v[48:51], v2, s[8:11], s49 offen sc1
    s_add_u32 s49, s44, 9216
    buffer_load_dwordx4 v[52:55], v2, s[8:11], s49 offen sc1
    s_add_u32 s49, s44, 10240
    buffer_load_dwordx4 v[56:59], v2, s[8:11], s49 offen sc1
    s_add_u32 s49, s44, 11264
    buffer_load_dwordx4 v[60:63], v2, s[8:11], s49 offen sc1
    s_add_u32 s49, s44, 12288
    buffer_load_dwordx4 v[64:67], v2, s[8:11], s49 offen sc1
    s_add_u32 s49, s44, 13312
    buffer_load_dwordx4 v[68:71], v2, s[8:11], s49 offen sc1
    s_add_u32 s49, s44, 14336
    buffer_load_dwordx4 v[72:75], v2, s[8:11], s49 offen sc1
    s_add_u32 s49, s44, 15360
    buffer_load_dwordx4 v[76:79], v2, s[8:11], s49 offen sc1
    s_add_u32 s49, s44, 16384
    buffer_load_dwordx4 v[80:83], v2, s[8:11], s49 offen sc1
    s_add_u32 s49, s44, 17408
    buffer_load_dwordx4 v[84:87], v2, s[8:11], s49 offen sc1
    s_add_u32 s49, s44, 18432
    buffer_load_dwordx4 v[88:91], v2, s[8:11], s49 offen sc1
    s_add_u32 s49, s44, 19456
    buffer_load_dwordx4 v[92:95], v2, s[8:11], s49 offen sc1
    s_add_u32 s49, s44, 20480
    buffer_load_dwordx4 v[96:99], v2, s[8:11], s49 offen sc1
    s_add_u32 s49, s44, 21504
    buffer_load_dwordx4 v[100:103], v2, s[8:11], s49 offen sc1
    s_add_u32 s49, s44, 22528
    buffer_load_dwordx4 v[104:107], v2, s[8:11], s49 offen sc1
    s_add_u32 s49, s44, 23552
    buffer_load_dwordx4 v[108:111], v2, s[8:11], s49 offen sc1
    s_add_u32 s49, s44, 24576
    buffer_load_dwordx4 v[112:115], v2, s[8:11], s49 offen sc1
    s_add_u32 s49, s44, 25600
    buffer_load_dwordx4 v[116:119], v2, s[8:11], s49 offen sc1
    s_add_u32 s49, s44, 26624
    buffer_load_dwordx4 v[120:123], v2, s[8:11], s49 offen sc1
    s_add_u32 s49, s44, 27648
    buffer_load_dwordx4 v[124:127], v2, s[8:11], s49 offen sc1
    s_add_u32 s49, s44, 28672
    buffer_load_dwordx4 v[128:131], v2, s[8:11], s49 offen sc1
    s_add_u32 s49, s44, 29696
    buffer_load_dwordx4 v[132:135], v2, s[8:11], s49 offen sc1
    s_add_u32 s49, s44, 30720
    buffer_load_dwordx4 v[136:139], v2, s[8:11], s49 offen sc1
    s_add_u32 s49, s44, 31744
    buffer_load_dwordx4 v[140:143], v2, s[8:11], s49 offen sc1
L_op_loop:
    s_mov_b32 s46, s20
    s_mul_i32 s47, s46, 20480
    buffer_load_dwordx2 v[10:11], v7, s[16:19], s47 offen
    s_add_u32 s32, s20, 2
    s_min_u32 s34, s32, 127
    s_lshr_b32 s34, s34, 1
    s_lshl_b32 s60, s34, 9
    s_add_u32 s60, s60, 69304320
    v_and_b32 v12, 3, v0
    v_lshlrev_b32 v12, 7, v12
    v_add_u32 v12, s60, v12
    global_load_dword v13, v12, s[6:7] sc1
    s_waitcnt vmcnt(33)
    v_mfma_f32_16x16x32_bf16 v[240:243], a[0:3], v[16:19], 0
    v_mfma_f32_16x16x32_bf16 v[244:247], a[4:7], v[16:19], 0
    s_waitcnt vmcnt(32)
    v_mfma_f32_16x16x32_bf16 v[240:243], a[8:11], v[20:23], v[240:243]
    v_mfma_f32_16x16x32_bf16 v[244:247], a[12:15], v[20:23], v[244:247]
    s_waitcnt vmcnt(31)
    v_mfma_f32_16x16x32_bf16 v[240:243], a[16:19], v[24:27], v[240:243]
    v_mfma_f32_16x16x32_bf16 v[244:247], a[20:23], v[24:27], v[244:247]
    s_waitcnt vmcnt(30)
    v_mfma_f32_16x16x32_bf16 v[240:243], a[24:27], v[28:31], v[240:243]
    v_mfma_f32_16x16x32_bf16 v[244:247], a[28:31], v[28:31], v[244:247]
    s_waitcnt vmcnt(29)
    v_mfma_f32_16x16x32_bf16 v[240:243], a[32:35], v[32:35], v[240:243]
    v_mfma_f32_16x16x32_bf16 v[244:247], a[36:39], v[32:35], v[244:247]
    s_waitcnt vmcnt(28)
    v_mfma_f32_16x16x32_bf16 v[240:243], a[40:43], v[36:39], v[240:243]
    v_mfma_f32_16x16x32_bf16 v[244:247], a[44:47], v[36:39], v[244:247]
    s_waitcnt vmcnt(27)
    v_mfma_f32_16x16x32_bf16 v[240:243], a[48:51], v[40:43], v[240:243]
    v_mfma_f32_16x16x32_bf16 v[244:247], a[52:55], v[40:43], v[244:247]
    s_waitcnt vmcnt(26)
    v_mfma_f32_16x16x32_bf16 v[240:243], a[56:59], v[44:47], v[240:243]
    v_mfma_f32_16x16x32_bf16 v[244:247], a[60:63], v[44:47], v[244:247]
    s_waitcnt vmcnt(25)
    v_mfma_f32_16x16x32_bf16 v[240:243], a[64:67], v[48:51], v[240:243]
    v_mfma_f32_16x16x32_bf16 v[244:247], a[68:71], v[48:51], v[244:247]
    s_waitcnt vmcnt(24)
    v_mfma_f32_16x16x32_bf16 v[240:243], a[72:75], v[52:55], v[240:243]
    v_mfma_f32_16x16x32_bf16 v[244:247], a[76:79], v[52:55], v[244:247]
    s_waitcnt vmcnt(23)
    v_mfma_f32_16x16x32_bf16 v[240:243], a[80:83], v[56:59], v[240:243]
    v_mfma_f32_16x16x32_bf16 v[244:247], a[84:87], v[56:59], v[244:247]
    s_waitcnt vmcnt(22)
    v_mfma_f32_16x16x32_bf16 v[240:243], a[88:91], v[60:63], v[240:243]
    v_mfma_f32_16x16x32_bf16 v[244:247], a[92:95], v[60:63], v[244:247]
    s_waitcnt vmcnt(21)
    v_mfma_f32_16x16x32_bf16 v[240:243], a[96:99], v[64:67], v[240:243]
    v_mfma_f32_16x16x32_bf16 v[244:247], a[100:103], v[64:67], v[244:247]
    s_waitcnt vmcnt(20)
    v_mfma_f32_16x16x32_bf16 v[240:243], a[104:107], v[68:71], v[240:243]
    v_mfma_f32_16x16x32_bf16 v[244:247], a[108:111], v[68:71], v[244:247]
    s_waitcnt vmcnt(19)
    v_mfma_f32_16x16x32_bf16 v[240:243], a[112:115], v[72:75], v[240:243]
    v_mfma_f32_16x16x32_bf16 v[244:247], a[116:119], v[72:75], v[244:247]
    s_waitcnt vmcnt(18)
    v_mfma_f32_16x16x32_bf16 v[240:243], a[120:123], v[76:79], v[240:243]
    v_mfma_f32_16x16x32_bf16 v[244:247], a[124:127], v[76:79], v[244:247]
    s_waitcnt vmcnt(17)
    v_mfma_f32_16x16x32_bf16 v[240:243], a[128:131], v[80:83], v[240:243]
    v_mfma_f32_16x16x32_bf16 v[244:247], a[132:135], v[80:83], v[244:247]
    s_waitcnt vmcnt(16)
    v_mfma_f32_16x16x32_bf16 v[240:243], a[136:139], v[84:87], v[240:243]
    v_mfma_f32_16x16x32_bf16 v[244:247], a[140:143], v[84:87], v[244:247]
    s_waitcnt vmcnt(15)
    v_mfma_f32_16x16x32_bf16 v[240:243], a[144:147], v[88:91], v[240:243]
    v_mfma_f32_16x16x32_bf16 v[244:247], a[148:151], v[88:91], v[244:247]
    s_waitcnt vmcnt(14)
    v_mfma_f32_16x16x32_bf16 v[240:243], a[152:155], v[92:95], v[240:243]
    v_mfma_f32_16x16x32_bf16 v[244:247], a[156:159], v[92:95], v[244:247]
    s_waitcnt vmcnt(13)
    v_mfma_f32_16x16x32_bf16 v[240:243], a[160:163], v[96:99], v[240:243]
    v_mfma_f32_16x16x32_bf16 v[244:247], a[164:167], v[96:99], v[244:247]
    s_waitcnt vmcnt(12)
    v_mfma_f32_16x16x32_bf16 v[240:243], a[168:171], v[100:103], v[240:243]
    v_mfma_f32_16x16x32_bf16 v[244:247], a[172:175], v[100:103], v[244:247]
    s_waitcnt vmcnt(11)
    v_mfma_f32_16x16x32_bf16 v[240:243], a[176:179], v[104:107], v[240:243]
    v_mfma_f32_16x16x32_bf16 v[244:247], a[180:183], v[104:107], v[244:247]
    s_waitcnt vmcnt(10)
    v_mfma_f32_16x16x32_bf16 v[240:243], a[184:187], v[108:111], v[240:243]
    v_mfma_f32_16x16x32_bf16 v[244:247], a[188:191], v[108:111], v[244:247]
    s_waitcnt vmcnt(9)
    v_mfma_f32_16x16x32_bf16 v[240:243], a[192:195], v[112:115], v[240:243]
    v_mfma_f32_16x16x32_bf16 v[244:247], a[196:199], v[112:115], v[244:247]
    s_waitcnt vmcnt(8)
    v_mfma_f32_16x16x32_bf16 v[240:243], a[200:203], v[116:119], v[240:243]
    v_mfma_f32_16x16x32_bf16 v[244:247], a[204:207], v[116:119], v[244:247]
    s_waitcnt vmcnt(7)
    v_mfma_f32_16x16x32_bf16 v[240:243], a[208:211], v[120:123], v[240:243]
    v_mfma_f32_16x16x32_bf16 v[244:247], a[212:215], v[120:123], v[244:247]
    s_waitcnt vmcnt(6)
    v_mfma_f32_16x16x32_bf16 v[240:243], a[216:219], v[124:127], v[240:243]
    v_mfma_f32_16x16x32_bf16 v[244:247], a[220:223], v[124:127], v[244:247]
    s_waitcnt vmcnt(5)
    v_mfma_f32_16x16x32_bf16 v[240:243], a[224:227], v[128:131], v[240:243]
    v_mfma_f32_16x16x32_bf16 v[244:247], a[228:231], v[128:131], v[244:247]
    s_waitcnt vmcnt(4)
    v_mfma_f32_16x16x32_bf16 v[240:243], a[232:235], v[132:135], v[240:243]
    v_mfma_f32_16x16x32_bf16 v[244:247], a[236:239], v[132:135], v[244:247]
    s_waitcnt vmcnt(3)
    v_mfma_f32_16x16x32_bf16 v[240:243], a[240:243], v[136:139], v[240:243]
    v_mfma_f32_16x16x32_bf16 v[244:247], a[244:247], v[136:139], v[244:247]
    s_waitcnt vmcnt(2)
    v_mfma_f32_16x16x32_bf16 v[240:243], a[248:251], v[140:143], v[240:243]
    v_mfma_f32_16x16x32_bf16 v[244:247], a[252:255], v[140:143], v[244:247]
    s_waitcnt vmcnt(0)
    v_readlane_b32 s60, v13, 0
    v_readlane_b32 s62, v13, 1
    s_nop 0
    s_add_u32 s60, s60, s62
    v_readlane_b32 s62, v13, 2
    s_nop 0
    s_add_u32 s60, s60, s62
    v_readlane_b32 s62, v13, 3
    s_nop 0
    s_add_u32 s60, s60, s62
    s_cmp_ge_u32 s60, 8
    s_cselect_b32 s33, 1, 0
    s_cmp_ge_u32 s32, 128
    s_cselect_b32 s33, 0, s33
    ds_write_b128 v3, v[240:243] offset:0
    ds_write_b128 v3, v[244:247] offset:1024
    v_mov_b32 v14, 53248
    s_cmp_lg_u32 s3, 0
    s_cbranch_scc1 L_op_nofl
    v_mov_b32 v15, s33
    ds_write_b32 v14, v15
L_op_nofl:
    s_waitcnt lgkmcnt(0)
    s_barrier
    ds_read_b32 v15, v14
    s_cmp_ge_u32 s35, 64
    s_cbranch_scc1 L_op_nopend
    s_cmp_lg_u32 s3, 0
    s_cbranch_scc1 L_sr_55
    s_lshl_b32 s60, s35, 9
    s_add_u32 s60, s60, 69337088
    s_and_b32 s61, s29, 3
    s_lshl_b32 s61, s61, 7
    s_add_u32 s60, s60, s61
    v_mov_b32 v12, s60
    v_mov_b32 v13, 1
    s_mov_b64 exec, 1
    global_atomic_add v12, v13, s[6:7]
    s_mov_b64 exec, -1
L_sr_55:
    s_mov_b32 s35, 64
L_op_nopend:
    ds_read_b128 v[240:243], v4 offset:0
    ds_read_b128 v[244:247], v4 offset:4096
    ds_read_b128 v[248:251], v4 offset:8192
    ds_read_b128 v[252:255], v4 offset:12288
    s_waitcnt lgkmcnt(4)
    v_readfirstlane_b32 s33, v15
    s_nop 0
    s_cmp_eq_u32 s33, 0
    s_cbranch_scc1 L_op_nopre
    s_mov_b32 s43, s32
    s_mul_i32 s44, s43, 131072
    s_lshl_b32 s45, s22, 10
    s_add_u32 s44, s44, s45
    s_add_u32 s44, s44, 73400320
    s_add_u32 s45, s44, 131072
    buffer_load_dwordx4 v[16:19], v2, s[8:11], s44 offen offset:0 sc1
    buffer_load_dwordx4 v[20:23], v2, s[8:11], s44 offen offset:1024 sc1
    buffer_load_dwordx4 v[24:27], v2, s[8:11], s44 offen offset:2048 sc1
    buffer_load_dwordx4 v[28:31], v2, s[8:11], s44 offen offset:3072 sc1
    s_add_u32 s49, s44, 4096
    buffer_load_dwordx4 v[32:35], v2, s[8:11], s49 offen sc1
    s_add_u32 s49, s44, 5120
    buffer_load_dwordx4 v[36:39], v2, s[8:11], s49 offen sc1
    s_add_u32 s49, s44, 6144
    buffer_load_dwordx4 v[40:43], v2, s[8:11], s49 offen sc1
    s_add_u32 s49, s44, 7168
    buffer_load_dwordx4 v[44:47], v2, s[8:11], s49 offen sc1
    s_add_u32 s49, s44, 8192
    buffer_load_dwordx4 v[48:51], v2, s[8:11], s49 offen sc1
    s_add_u32 s49, s44, 9216
    buffer_load_dwordx4 v[52:55], v2, s[8:11], s49 offen sc1
    s_add_u32 s49, s44, 10240
    buffer_load_dwordx4 v[56:59], v2, s[8:11], s49 offen sc1
    s_add_u32 s49, s44, 11264
    buffer_load_dwordx4 v[60:63], v2, s[8:11], s49 offen sc1
    s_add_u32 s49, s44, 12288
    buffer_load_dwordx4 v[64:67], v2, s[8:11], s49 offen sc1
    s_add_u32 s49, s44, 13312
    buffer_load_dwordx4 v[68:71], v2, s[8:11], s49 offen sc1
    s_add_u32 s49, s44, 14336
    buffer_load_dwordx4 v[72:75], v2, s[8:11], s49 offen sc1
    s_add_u32 s49, s44, 15360
    buffer_load_dwordx4 v[76:79], v2, s[8:11], s49 offen sc1
    s_add_u32 s49, s44, 16384
    buffer_load_dwordx4 v[80:83], v2, s[8:11], s49 offen sc1
    s_add_u32 s49, s44, 17408
    buffer_load_dwordx4 v[84:87], v2, s[8:11], s49 offen sc1
    s_add_u32 s49, s44, 18432
    buffer_load_dwordx4 v[88:91], v2, s[8:11], s49 offen sc1
    s_add_u32 s49, s44, 19456
    buffer_load_dwordx4 v[92:95], v2, s[8:11], s49 offen sc1
    s_add_u32 s49, s44, 20480
    buffer_load_dwordx4 v[96:99], v2, s[8:11], s49 offen sc1
    s_add_u32 s49, s44, 21504
    buffer_load_dwordx4 v[100:103], v2, s[8:11], s49 offen sc1
    s_add_u32 s49, s44, 22528
    buffer_load_dwordx4 v[104:107], v2, s[8:11], s49 offen sc1
    s_add_u32 s49, s44, 23552
    buffer_load_dwordx4 v[108:111], v2, s[8:11], s49 offen sc1
    s_add_u32 s49, s44, 24576
    buffer_load_dwordx4 v[112:115], v2, s[8:11], s49 offen sc1
    s_add_u32 s49, s44, 25600
    buffer_load_dwordx4 v[116:119], v2, s[8:11], s49 offen sc1
    s_add_u32 s49, s44, 26624
    buffer_load_dwordx4 v[120:123], v2, s[8:11], s49 offen sc1
    s_add_u32 s49, s44, 27648
    buffer_load_dwordx4 v[124:127], v2, s[8:11], s49 offen sc1
    s_add_u32 s49, s44, 28672
    buffer_load_dwordx4 v[128:131], v2, s[8:11], s49 offen sc1
    s_add_u32 s49, s44, 29696
    buffer_load_dwordx4 v[132:135], v2, s[8:11], s49 offen sc1
    s_add_u32 s49, s44, 30720
    buffer_load_dwordx4 v[136:139], v2, s[8:11], s49 offen sc1
    s_add_u32 s49, s44, 31744
    buffer_load_dwordx4 v[140:143], v2, s[8:11], s49 offen sc1
L_op_nopre:
    s_waitcnt lgkmcnt(0)
    s_barrier
    s_cmp_ge_u32 s3, 2
    s_cbranch_scc1 L_op_noepi
    v_add_f32 v240, v240, v244
    v_add_f32 v248, v248, v252
    v_add_f32 v241, v241, v245
    v_add_f32 v249, v249, v253
    v_add_f32 v242, v242, v246
    v_add_f32 v250, v250, v254
    v_add_f32 v243, v243, v247
    v_add_f32 v251, v251, v255
    v_add_f32 v240, v240, v248
    v_add_f32 v241, v241, v249
    v_add_f32 v242, v242, v250
    v_add_f32 v243, v243, v251
    v_lshlrev_b32 v244, 16, v10
    v_and_b32 v245, 0xffff0000, v10
    v_lshlrev_b32 v246, 16, v11
    v_and_b32 v247, 0xffff0000, v11
    v_add_f32 v240, v240, v244
    v_add_f32 v241, v241, v245
    v_add_f32 v242, v242, v246
    v_add_f32 v243, v243, v247
    v_cvt_pk_bf16_f32 v10, v240, v241
    v_cvt_pk_bf16_f32 v11, v242, v243
    s_mul_i32 s47, s46, 20480
    s_lshl_b32 s48, s29, 10
    s_add_u32 s47, s47, s48
    s_add_u32 s47, s47, 96468992
    buffer_store_dwordx2 v[10:11], v8, s[8:11], s47 offen sc1
L_op_noepi:
    s_cmp_eq_u32 s33, 0
    s_cbranch_scc1 L_op_signow
    s_mov_b32 s35, s31
    s_branch L_op_sigdone
L_op_signow:
    s_lshl_b32 s60, s34, 9
    s_add_u32 s60, s60, 69304320
    v_and_b32 v12, 3, v0
    v_lshlrev_b32 v12, 7, v12
    v_add_u32 v12, s60, v12
    global_load_dword v13, v12, s[6:7] sc1
    s_waitcnt vmcnt(0)
    v_readlane_b32 s60, v13, 0
    v_readlane_b32 s62, v13, 1
    s_nop 0
    s_add_u32 s60, s60, s62
    v_readlane_b32 s62, v13, 2
    s_nop 0
    s_add_u32 s60, s60, s62
    v_readlane_b32 s62, v13, 3
    s_nop 0
    s_add_u32 s60, s60, s62
    s_cmp_ge_u32 s60, 8
    s_cselect_b32 s36, 1, 0
    v_mov_b32 v14, 53252
    s_cmp_lg_u32 s3, 0
    s_cbranch_scc1 L_sp_56
    v_mov_b32 v15, s36
    ds_write_b32 v14, v15
    s_waitcnt lgkmcnt(0)
L_sp_56:
    s_barrier
    ds_read_b32 v15, v14
    s_cmp_lg_u32 s3, 0
    s_cbranch_scc1 L_sr_57
    s_lshl_b32 s60, s31, 9
    s_add_u32 s60, s60, 69337088
    s_and_b32 s61, s29, 3
    s_lshl_b32 s61, s61, 7
    s_add_u32 s60, s60, s61
    v_mov_b32 v12, s60
    v_mov_b32 v13, 1
    s_mov_b64 exec, 1
    global_atomic_add v12, v13, s[6:7]
    s_mov_b64 exec, -1
L_sr_57:
    s_waitcnt lgkmcnt(0)
    v_readfirstlane_b32 s36, v15
    s_branch L_op_late
L_op_sigdone:
    s_mov_b32 s36, 0
L_op_late:
    s_mov_b32 s20, s32
    s_cmp_ge_u32 s20, 128
    s_cbranch_scc1 L_op_fin
    s_lshr_b32 s31, s20, 1
    s_cmp_lg_u32 s33, 0
    s_cbranch_scc1 L_op_loop
    s_cmp_lg_u32 s36, 0
    s_cbranch_scc1 L_op_go
    s_cmp_lg_u32 s3, 0
    s_cbranch_scc1 L_w_op1_58_d
    s_lshl_b32 s60, s31, 9
    s_add_u32 s60, s60, 69304320
    v_and_b32 v12, 3, v0
    v_lshlrev_b32 v12, 7, v12
    v_add_u32 v12, s60, v12
    s_mov_b32 s61, 0
L_w_op1_58:
    global_load_dword v13, v12, s[6:7] sc1
    s_add_u32 s61, s61, 1
    s_waitcnt vmcnt(0)
    v_readlane_b32 s60, v13, 0
    v_readlane_b32 s62, v13, 1
    s_nop 0
    s_add_u32 s60, s60, s62
    v_readlane_b32 s62, v13, 2
    s_nop 0
    s_add_u32 s60, s60, s62
    v_readlane_b32 s62, v13, 3
    s_nop 0
    s_add_u32 s60, s60, s62
    s_cmp_ge_u32 s61, 100000
    s_cselect_b32 s63, 1, s63
    s_cmp_lg_u32 s63, 0
    s_cbranch_scc1 L_w_op1_58_d
    s_cmp_ge_u32 s60, 8
    s_cbranch_scc1 L_w_op1_58_d
    s_branch L_w_op1_58
L_w_op1_58_d:
    s_barrier
L_op_go:
    s_mov_b32 s43, s20
    s_mul_i32 s44, s43, 131072
    s_lshl_b32 s45, s22, 10
    s_add_u32 s44, s44, s45
    s_add_u32 s44, s44, 73400320
    s_add_u32 s45, s44, 131072
    buffer_load_dwordx4 v[16:19], v2, s[8:11], s44 offen offset:0 sc1
    buffer_load_dwordx4 v[20:23], v2, s[8:11], s44 offen offset:1024 sc1
    buffer_load_dwordx4 v[24:27], v2, s[8:11], s44 offen offset:2048 sc1
    buffer_load_dwordx4 v[28:31], v2, s[8:11], s44 offen offset:3072 sc1
    s_add_u32 s49, s44, 4096
    buffer_load_dwordx4 v[32:35], v2, s[8:11], s49 offen sc1
    s_add_u32 s49, s44, 5120
    buffer_load_dwordx4 v[36:39], v2, s[8:11], s49 offen sc1
    s_add_u32 s49, s44, 6144
    buffer_load_dwordx4 v[40:43], v2, s[8:11], s49 offen sc1
    s_add_u32 s49, s44, 7168
    buffer_load_dwordx4 v[44:47], v2, s[8:11], s49 offen sc1
    s_add_u32 s49, s44, 8192
    buffer_load_dwordx4 v[48:51], v2, s[8:11], s49 offen sc1
    s_add_u32 s49, s44, 9216
    buffer_load_dwordx4 v[52:55], v2, s[8:11], s49 offen sc1
    s_add_u32 s49, s44, 10240
    buffer_load_dwordx4 v[56:59], v2, s[8:11], s49 offen sc1
    s_add_u32 s49, s44, 11264
    buffer_load_dwordx4 v[60:63], v2, s[8:11], s49 offen sc1
    s_add_u32 s49, s44, 12288
    buffer_load_dwordx4 v[64:67], v2, s[8:11], s49 offen sc1
    s_add_u32 s49, s44, 13312
    buffer_load_dwordx4 v[68:71], v2, s[8:11], s49 offen sc1
    s_add_u32 s49, s44, 14336
    buffer_load_dwordx4 v[72:75], v2, s[8:11], s49 offen sc1
    s_add_u32 s49, s44, 15360
    buffer_load_dwordx4 v[76:79], v2, s[8:11], s49 offen sc1
    s_add_u32 s49, s44, 16384
    buffer_load_dwordx4 v[80:83], v2, s[8:11], s49 offen sc1
    s_add_u32 s49, s44, 17408
    buffer_load_dwordx4 v[84:87], v2, s[8:11], s49 offen sc1
    s_add_u32 s49, s44, 18432
    buffer_load_dwordx4 v[88:91], v2, s[8:11], s49 offen sc1
    s_add_u32 s49, s44, 19456
    buffer_load_dwordx4 v[92:95], v2, s[8:11], s49 offen sc1
    s_add_u32 s49, s44, 20480
    buffer_load_dwordx4 v[96:99], v2, s[8:11], s49 offen sc1
    s_add_u32 s49, s44, 21504
    buffer_load_dwordx4 v[100:103], v2, s[8:11], s49 offen sc1
    s_add_u32 s49, s44, 22528
    buffer_load_dwordx4 v[104:107], v2, s[8:11], s49 offen sc1
    s_add_u32 s49, s44, 23552
    buffer_load_dwordx4 v[108:111], v2, s[8:11], s49 offen sc1
    s_add_u32 s49, s44, 24576
    buffer_load_dwordx4 v[112:115], v2, s[8:11], s49 offen sc1
    s_add_u32 s49, s44, 25600
    buffer_load_dwordx4 v[116:119], v2, s[8:11], s49 offen sc1
    s_add_u32 s49, s44, 26624
    buffer_load_dwordx4 v[120:123], v2, s[8:11], s49 offen sc1
    s_add_u32 s49, s44, 27648
    buffer_load_dwordx4 v[124:127], v2, s[8:11], s49 offen sc1
    s_add_u32 s49, s44, 28672
    buffer_load_dwordx4 v[128:131], v2, s[8:11], s49 offen sc1
    s_add_u32 s49, s44, 29696
    buffer_load_dwordx4 v[132:135], v2, s[8:11], s49 offen sc1
    s_add_u32 s49, s44, 30720
    buffer_load_dwordx4 v[136:139], v2, s[8:11], s49 offen sc1
    s_add_u32 s49, s44, 31744
    buffer_load_dwordx4 v[140:143], v2, s[8:11], s49 offen sc1
    s_branch L_op_loop
L_op_fin:
    s_branch L_post_end
L_role_f1:
    s_mov_b32 s29, s16
    s_load_dwordx2 s[24:25], s[0:1], 64
    s_load_dwordx2 s[26:27], s[0:1], 72
    s_and_b32 s21, s3, 1
    s_lshl_b32 s22, s29, 6
    s_lshl_b32 s23, s21, 5
    s_add_u32 s22, s22, s23
    s_mov_b32 s23, 0
    s_waitcnt lgkmcnt(0)
    s_mov_b32 s12, s24
    s_mov_b32 s13, s25
    s_mov_b32 s14, 0x21c000
    s_mov_b32 s15, 0x20000
    s_mov_b32 s16, s26
    s_mov_b32 s17, s27
    s_mov_b32 s18, 0x21c000
    s_mov_b32 s19, 0x20000
    v_and_b32 v1, 63, v0
    v_lshrrev_b32 v4, 1, v1
    v_and_b32 v5, 1, v1
    s_mov_b32 s40, 3456
    v_mul_lo_u32 v6, s40, v4
    v_lshlrev_b32 v7, 4, v5
    v_add3_u32 v6, v6, v7, s22
    v_lshlrev_b32 v4, 5, v4
    v_add_u32 v4, v4, v7
    s_lshl_b32 s41, s3, 11
    v_add_u32 v4, s41, v4
    v_and_b32 v5, 15, v1
    v_lshrrev_b32 v7, 4, v1
    v_lshlrev_b32 v7, 2, v7
    v_lshrrev_b32 v8, 2, v5
    v_add_u32 v7, v7, v8
    v_lshlrev_b32 v7, 5, v7
    v_and_b32 v5, 3, v5
    v_lshlrev_b32 v5, 3, v5
    v_add3_u32 v7, v7, v5, s41
    s_mov_b32 s42, 0
    buffer_load_dwordx4 v[16:19], v6, s[12:15], s42 offen
    s_add_u32 s42, s42, 110592
    buffer_load_dwordx4 v[20:23], v6, s[12:15], s42 offen
    s_add_u32 s42, s42, 110592
    buffer_load_dwordx4 v[24:27], v6, s[12:15], s42 offen
    s_add_u32 s42, s42, 110592
    buffer_load_dwordx4 v[28:31], v6, s[12:15], s42 offen
    s_add_u32 s42, s42, 110592
    buffer_load_dwordx4 v[32:35], v6, s[12:15], s42 offen
    s_add_u32 s42, s42, 110592
    buffer_load_dwordx4 v[36:39], v6, s[12:15], s42 offen
    s_add_u32 s42, s42, 110592
    buffer_load_dwordx4 v[40:43], v6, s[12:15], s42 offen
    s_add_u32 s42, s42, 110592
    buffer_load_dwordx4 v[44:47], v6, s[12:15], s42 offen
    s_add_u32 s42, s42, 110592
    buffer_load_dwordx4 v[48:51], v6, s[12:15], s42 offen
    s_add_u32 s42, s42, 110592
    buffer_load_dwordx4 v[52:55], v6, s[12:15], s42 offen
    s_add_u32 s42, s42, 110592
    buffer_load_dwordx4 v[56:59], v6, s[12:15], s42 offen
    s_add_u32 s42, s42, 110592
    buffer_load_dwordx4 v[60:63], v6, s[12:15], s42 offen
    s_add_u32 s42, s42, 110592
    buffer_load_dwordx4 v[64:67], v6, s[12:15], s42 offen
    s_add_u32 s42, s42, 110592
    buffer_load_dwordx4 v[68:71], v6, s[12:15], s42 offen
    s_add_u32 s42, s42, 110592
    buffer_load_dwordx4 v[72:75], v6, s[12:15], s42 offen
    s_add_u32 s42, s42, 110592
    buffer_load_dwordx4 v[76:79], v6, s[12:15], s42 offen
    s_add_u32 s42, s42, 110592
    buffer_load_dwordx4 v[80:83], v6, s[12:15], s42 offen
    s_add_u32 s42, s42, 110592
    buffer_load_dwordx4 v[84:87], v6, s[12:15], s42 offen
    s_add_u32 s42, s42, 110592
    buffer_load_dwordx4 v[88:91], v6, s[12:15], s42 offen
    s_add_u32 s42, s42, 110592
    buffer_load_dwordx4 v[92:95], v6, s[12:15], s42 offen
    s_add_u32 s42, s42, 110592
    s_waitcnt vmcnt(19)
    ds_write_b128 v4, v[16:19] offset:0
    ds_read_b64_tr_b16 a[0:1], v7 offset:0
    ds_read_b64_tr_b16 a[2:3], v7 offset:512
    s_waitcnt vmcnt(18)
    ds_write_b128 v4, v[20:23] offset:1024
    ds_read_b64_tr_b16 a[8:9], v7 offset:1024
    ds_read_b64_tr_b16 a[10:11], v7 offset:1536
    s_waitcnt lgkmcnt(0)
    s_waitcnt vmcnt(17)
    ds_write_b128 v4, v[24:27] offset:0
    ds_read_b64_tr_b16 a[16:17], v7 offset:0
    ds_read_b64_tr_b16 a[18:19], v7 offset:512
    s_waitcnt vmcnt(16)
    ds_write_b128 v4, v[28:31] offset:1024
    ds_read_b64_tr_b16 a[24:25], v7 offset:1024
    ds_read_b64_tr_b16 a[26:27], v7 offset:1536
    s_waitcnt lgkmcnt(0)
    s_waitcnt vmcnt(15)
    ds_write_b128 v4, v[32:35] offset:0
    ds_read_b64_tr_b16 a[32:33], v7 offset:0
    ds_read_b64_tr_b16 a[34:35], v7 offset:512
    s_waitcnt vmcnt(14)
    ds_write_b128 v4, v[36:39] offset:1024
    ds_read_b64_tr_b16 a[40:41], v7 offset:1024
    ds_read_b64_tr_b16 a[42:43], v7 offset:1536
    s_waitcnt lgkmcnt(0)
    s_waitcnt vmcnt(13)
    ds_write_b128 v4, v[40:43] offset:0
    ds_read_b64_tr_b16 a[48:49], v7 offset:0
    ds_read_b64_tr_b16 a[50:51], v7 offset:512
    s_waitcnt vmcnt(12)
    ds_write_b128 v4, v[44:47] offset:1024
    ds_read_b64_tr_b16 a[56:57], v7 offset:1024
    ds_read_b64_tr_b16 a[58:59], v7 offset:1536
    s_waitcnt lgkmcnt(0)
    s_waitcnt vmcnt(11)
    ds_write_b128 v4, v[48:51] offset:0
    ds_read_b64_tr_b16 a[64:65], v7 offset:0
    ds_read_b64_tr_b16 a[66:67], v7 offset:512
    s_waitcnt vmcnt(10)
    ds_write_b128 v4, v[52:55] offset:1024
    ds_read_b64_tr_b16 a[72:73], v7 offset:1024
    ds_read_b64_tr_b16 a[74:75], v7 offset:1536
    s_waitcnt lgkmcnt(0)
    s_waitcnt vmcnt(9)
    ds_write_b128 v4, v[56:59] offset:0
    ds_read_b64_tr_b16 a[80:81], v7 offset:0
    ds_read_b64_tr_b16 a[82:83], v7 offset:512
    s_waitcnt vmcnt(8)
    ds_write_b128 v4, v[60:63] offset:1024
    ds_read_b64_tr_b16 a[88:89], v7 offset:1024
    ds_read_b64_tr_b16 a[90:91], v7 offset:1536
    s_waitcnt lgkmcnt(0)
    s_waitcnt vmcnt(7)
    ds_write_b128 v4, v[64:67] offset:0
    ds_read_b64_tr_b16 a[96:97], v7 offset:0
    ds_read_b64_tr_b16 a[98:99], v7 offset:512
    s_waitcnt vmcnt(6)
    ds_write_b128 v4, v[68:71] offset:1024
    ds_read_b64_tr_b16 a[104:105], v7 offset:1024
    ds_read_b64_tr_b16 a[106:107], v7 offset:1536
    s_waitcnt lgkmcnt(0)
    s_waitcnt vmcnt(5)
    ds_write_b128 v4, v[72:75] offset:0
    ds_read_b64_tr_b16 a[112:113], v7 offset:0
    ds_read_b64_tr_b16 a[114:115], v7 offset:512
    s_waitcnt vmcnt(4)
    ds_write_b128 v4, v[76:79] offset:1024
    ds_read_b64_tr_b16 a[120:121], v7 offset:1024
    ds_read_b64_tr_b16 a[122:123], v7 offset:1536
    s_waitcnt lgkmcnt(0)
    s_waitcnt vmcnt(3)
    ds_write_b128 v4, v[80:83] offset:0
    ds_read_b64_tr_b16 a[128:129], v7 offset:0
    ds_read_b64_tr_b16 a[130:131], v7 offset:512
    s_waitcnt vmcnt(2)
    ds_write_b128 v4, v[84:87] offset:1024
    ds_read_b64_tr_b16 a[136:137], v7 offset:1024
    ds_read_b64_tr_b16 a[138:139], v7 offset:1536
    s_waitcnt lgkmcnt(0)
    s_waitcnt vmcnt(1)
    ds_write_b128 v4, v[88:91] offset:0
    ds_read_b64_tr_b16 a[144:145], v7 offset:0
    ds_read_b64_tr_b16 a[146:147], v7 offset:512
    s_waitcnt vmcnt(0)
    ds_write_b128 v4, v[92:95] offset:1024
    ds_read_b64_tr_b16 a[152:153], v7 offset:1024
    ds_read_b64_tr_b16 a[154:155], v7 offset:1536
    s_waitcnt lgkmcnt(0)
    s_waitcnt lgkmcnt(0)
    v_and_b32 v1, 63, v0
    v_lshrrev_b32 v4, 1, v1
    v_and_b32 v5, 1, v1
    s_mov_b32 s40, 3456
    v_mul_lo_u32 v6, s40, v4
    v_lshlrev_b32 v7, 4, v5
    v_add3_u32 v6, v6, v7, s22
    v_lshlrev_b32 v4, 5, v4
    v_add_u32 v4, v4, v7
    s_lshl_b32 s41, s3, 11
    v_add_u32 v4, s41, v4
    v_and_b32 v5, 15, v1
    v_lshrrev_b32 v7, 4, v1
    v_lshlrev_b32 v7, 2, v7
    v_lshrrev_b32 v8, 2, v5
    v_add_u32 v7, v7, v8
    v_lshlrev_b32 v7, 5, v7
    v_and_b32 v5, 3, v5
    v_lshlrev_b32 v5, 3, v5
    v_add3_u32 v7, v7, v5, s41
    s_mov_b32 s42, 0
    buffer_load_dwordx4 v[16:19], v6, s[16:19], s42 offen
    s_add_u32 s42, s42, 110592
    buffer_load_dwordx4 v[20:23], v6, s[16:19], s42 offen
    s_add_u32 s42, s42, 110592
    buffer_load_dwordx4 v[24:27], v6, s[16:19], s42 offen
    s_add_u32 s42, s42, 110592
    buffer_load_dwordx4 v[28:31], v6, s[16:19], s42 offen
    s_add_u32 s42, s42, 110592
    buffer_load_dwordx4 v[32:35], v6, s[16:19], s42 offen
    s_add_u32 s42, s42, 110592
    buffer_load_dwordx4 v[36:39], v6, s[16:19], s42 offen
    s_add_u32 s42, s42, 110592
    buffer_load_dwordx4 v[40:43], v6, s[16:19], s42 offen
    s_add_u32 s42, s42, 110592
    buffer_load_dwordx4 v[44:47], v6, s[16:19], s42 offen
    s_add_u32 s42, s42, 110592
    buffer_load_dwordx4 v[48:51], v6, s[16:19], s42 offen
    s_add_u32 s42, s42, 110592
    buffer_load_dwordx4 v[52:55], v6, s[16:19], s42 offen
    s_add_u32 s42, s42, 110592
    buffer_load_dwordx4 v[56:59], v6, s[16:19], s42 offen
    s_add_u32 s42, s42, 110592
    buffer_load_dwordx4 v[60:63], v6, s[16:19], s42 offen
    s_add_u32 s42, s42, 110592
    buffer_load_dwordx4 v[64:67], v6, s[16:19], s42 offen
    s_add_u32 s42, s42, 110592
    buffer_load_dwordx4 v[68:71], v6, s[16:19], s42 offen
    s_add_u32 s42, s42, 110592
    buffer_load_dwordx4 v[72:75], v6, s[16:19], s42 offen
    s_add_u32 s42, s42, 110592
    buffer_load_dwordx4 v[76:79], v6, s[16:19], s42 offen
    s_add_u32 s42, s42, 110592
    buffer_load_dwordx4 v[80:83], v6, s[16:19], s42 offen
    s_add_u32 s42, s42, 110592
    buffer_load_dwordx4 v[84:87], v6, s[16:19], s42 offen
    s_add_u32 s42, s42, 110592
    buffer_load_dwordx4 v[88:91], v6, s[16:19], s42 offen
    s_add_u32 s42, s42, 110592
    buffer_load_dwordx4 v[92:95], v6, s[16:19], s42 offen
    s_add_u32 s42, s42, 110592
    s_waitcnt vmcnt(19)
    ds_write_b128 v4, v[16:19] offset:0
    ds_read_b64_tr_b16 a[4:5], v7 offset:0
    ds_read_b64_tr_b16 a[6:7], v7 offset:512
    s_waitcnt vmcnt(18)
    ds_write_b128 v4, v[20:23] offset:1024
    ds_read_b64_tr_b16 a[12:13], v7 offset:1024
    ds_read_b64_tr_b16 a[14:15], v7 offset:1536
    s_waitcnt lgkmcnt(0)
    s_waitcnt vmcnt(17)
    ds_write_b128 v4, v[24:27] offset:0
    ds_read_b64_tr_b16 a[20:21], v7 offset:0
    ds_read_b64_tr_b16 a[22:23], v7 offset:512
    s_waitcnt vmcnt(16)
    ds_write_b128 v4, v[28:31] offset:1024
    ds_read_b64_tr_b16 a[28:29], v7 offset:1024
    ds_read_b64_tr_b16 a[30:31], v7 offset:1536
    s_waitcnt lgkmcnt(0)
    s_waitcnt vmcnt(15)
    ds_write_b128 v4, v[32:35] offset:0
    ds_read_b64_tr_b16 a[36:37], v7 offset:0
    ds_read_b64_tr_b16 a[38:39], v7 offset:512
    s_waitcnt vmcnt(14)
    ds_write_b128 v4, v[36:39] offset:1024
    ds_read_b64_tr_b16 a[44:45], v7 offset:1024
    ds_read_b64_tr_b16 a[46:47], v7 offset:1536
    s_waitcnt lgkmcnt(0)
    s_waitcnt vmcnt(13)
    ds_write_b128 v4, v[40:43] offset:0
    ds_read_b64_tr_b16 a[52:53], v7 offset:0
    ds_read_b64_tr_b16 a[54:55], v7 offset:512
    s_waitcnt vmcnt(12)
    ds_write_b128 v4, v[44:47] offset:1024
    ds_read_b64_tr_b16 a[60:61], v7 offset:1024
    ds_read_b64_tr_b16 a[62:63], v7 offset:1536
    s_waitcnt lgkmcnt(0)
    s_waitcnt vmcnt(11)
    ds_write_b128 v4, v[48:51] offset:0
    ds_read_b64_tr_b16 a[68:69], v7 offset:0
    ds_read_b64_tr_b16 a[70:71], v7 offset:512
    s_waitcnt vmcnt(10)
    ds_write_b128 v4, v[52:55] offset:1024
    ds_read_b64_tr_b16 a[76:77], v7 offset:1024
    ds_read_b64_tr_b16 a[78:79], v7 offset:1536
    s_waitcnt lgkmcnt(0)
    s_waitcnt vmcnt(9)
    ds_write_b128 v4, v[56:59] offset:0
    ds_read_b64_tr_b16 a[84:85], v7 offset:0
    ds_read_b64_tr_b16 a[86:87], v7 offset:512
    s_waitcnt vmcnt(8)
    ds_write_b128 v4, v[60:63] offset:1024
    ds_read_b64_tr_b16 a[92:93], v7 offset:1024
    ds_read_b64_tr_b16 a[94:95], v7 offset:1536
    s_waitcnt lgkmcnt(0)
    s_waitcnt vmcnt(7)
    ds_write_b128 v4, v[64:67] offset:0
    ds_read_b64_tr_b16 a[100:101], v7 offset:0
    ds_read_b64_tr_b16 a[102:103], v7 offset:512
    s_waitcnt vmcnt(6)
    ds_write_b128 v4, v[68:71] offset:1024
    ds_read_b64_tr_b16 a[108:109], v7 offset:1024
    ds_read_b64_tr_b16 a[110:111], v7 offset:1536
    s_waitcnt lgkmcnt(0)
    s_waitcnt vmcnt(5)
    ds_write_b128 v4, v[72:75] offset:0
    ds_read_b64_tr_b16 a[116:117], v7 offset:0
    ds_read_b64_tr_b16 a[118:119], v7 offset:512
    s_waitcnt vmcnt(4)
    ds_write_b128 v4, v[76:79] offset:1024
    ds_read_b64_tr_b16 a[124:125], v7 offset:1024
    ds_read_b64_tr_b16 a[126:127], v7 offset:1536
    s_waitcnt lgkmcnt(0)
    s_waitcnt vmcnt(3)
    ds_write_b128 v4, v[80:83] offset:0
    ds_read_b64_tr_b16 a[132:133], v7 offset:0
    ds_read_b64_tr_b16 a[134:135], v7 offset:512
    s_waitcnt vmcnt(2)
    ds_write_b128 v4, v[84:87] offset:1024
    ds_read_b64_tr_b16 a[140:141], v7 offset:1024
    ds_read_b64_tr_b16 a[142:143], v7 offset:1536
    s_waitcnt lgkmcnt(0)
    s_waitcnt vmcnt(1)
    ds_write_b128 v4, v[88:91] offset:0
    ds_read_b64_tr_b16 a[148:149], v7 offset:0
    ds_read_b64_tr_b16 a[150:151], v7 offset:512
    s_waitcnt vmcnt(0)
    ds_write_b128 v4, v[92:95] offset:1024
    ds_read_b64_tr_b16 a[156:157], v7 offset:1024
    ds_read_b64_tr_b16 a[158:159], v7 offset:1536
    s_waitcnt lgkmcnt(0)
    s_waitcnt lgkmcnt(0)
    v_mov_b32 v10, 0x3f803f80
    v_mov_b32 v11, 0x3f803f80
    v_mov_b32 v12, 0x3f803f80
    v_mov_b32 v13, 0x3f803f80
    s_nop 1
    v_mfma_f32_16x16x32_bf16 v[240:243], a[0:3], v[10:13], 0
    v_mfma_f32_16x16x32_bf16 v[244:247], a[4:7], v[10:13], 0
    v_mfma_f32_16x16x32_bf16 v[240:243], a[8:11], v[10:13], v[240:243]
    v_mfma_f32_16x16x32_bf16 v[244:247], a[12:15], v[10:13], v[244:247]
    v_mfma_f32_16x16x32_bf16 v[240:243], a[16:19], v[10:13], v[240:243]
    v_mfma_f32_16x16x32_bf16 v[244:247], a[20:23], v[10:13], v[244:247]
    v_mfma_f32_16x16x32_bf16 v[240:243], a[24:27], v[10:13], v[240:243]
    v_mfma_f32_16x16x32_bf16 v[244:247], a[28:31], v[10:13], v[244:247]
    v_mfma_f32_16x16x32_bf16 v[240:243], a[32:35], v[10:13], v[240:243]
    v_mfma_f32_16x16x32_bf16 v[244:247], a[36:39], v[10:13], v[244:247]
    v_mfma_f32_16x16x32_bf16 v[240:243], a[40:43], v[10:13], v[240:243]
    v_mfma_f32_16x16x32_bf16 v[244:247], a[44:47], v[10:13], v[244:247]
    v_mfma_f32_16x16x32_bf16 v[240:243], a[48:51], v[10:13], v[240:243]
    v_mfma_f32_16x16x32_bf16 v[244:247], a[52:55], v[10:13], v[244:247]
    v_mfma_f32_16x16x32_bf16 v[240:243], a[56:59], v[10:13], v[240:243]
    v_mfma_f32_16x16x32_bf16 v[244:247], a[60:63], v[10:13], v[244:247]
    v_mfma_f32_16x16x32_bf16 v[240:243], a[64:67], v[10:13], v[240:243]
    v_mfma_f32_16x16x32_bf16 v[244:247], a[68:71], v[10:13], v[244:247]
    v_mfma_f32_16x16x32_bf16 v[240:243], a[72:75], v[10:13], v[240:243]
    v_mfma_f32_16x16x32_bf16 v[244:247], a[76:79], v[10:13], v[244:247]
    v_mfma_f32_16x16x32_bf16 v[240:243], a[80:83], v[10:13], v[240:243]
    v_mfma_f32_16x16x32_bf16 v[244:247], a[84:87], v[10:13], v[244:247]
    v_mfma_f32_16x16x32_bf16 v[240:243], a[88:91], v[10:13], v[240:243]
    v_mfma_f32_16x16x32_bf16 v[244:247], a[92:95], v[10:13], v[244:247]
    v_mfma_f32_16x16x32_bf16 v[240:243], a[96:99], v[10:13], v[240:243]
    v_mfma_f32_16x16x32_bf16 v[244:247], a[100:103], v[10:13], v[244:247]
    v_mfma_f32_16x16x32_bf16 v[240:243], a[104:107], v[10:13], v[240:243]
    v_mfma_f32_16x16x32_bf16 v[244:247], a[108:111], v[10:13], v[244:247]
    v_mfma_f32_16x16x32_bf16 v[240:243], a[112:115], v[10:13], v[240:243]
    v_mfma_f32_16x16x32_bf16 v[244:247], a[116:119], v[10:13], v[244:247]
    v_mfma_f32_16x16x32_bf16 v[240:243], a[120:123], v[10:13], v[240:243]
    v_mfma_f32_16x16x32_bf16 v[244:247], a[124:127], v[10:13], v[244:247]
    v_mfma_f32_16x16x32_bf16 v[240:243], a[128:131], v[10:13], v[240:243]
    v_mfma_f32_16x16x32_bf16 v[244:247], a[132:135], v[10:13], v[244:247]
    v_mfma_f32_16x16x32_bf16 v[240:243], a[136:139], v[10:13], v[240:243]
    v_mfma_f32_16x16x32_bf16 v[244:247], a[140:143], v[10:13], v[244:247]
    v_mfma_f32_16x16x32_bf16 v[240:243], a[144:147], v[10:13], v[240:243]
    v_mfma_f32_16x16x32_bf16 v[244:247], a[148:151], v[10:13], v[244:247]
    v_mfma_f32_16x16x32_bf16 v[240:243], a[152:155], v[10:13], v[240:243]
    v_mfma_f32_16x16x32_bf16 v[244:247], a[156:159], v[10:13], v[244:247]
    v_mov_b32 v144, 0x3f803f80
    v_mov_b32 v145, 0x3f803f80
    v_mov_b32 v146, 0x3f803f80
    v_mov_b32 v147, 0x3f803f80
    v_and_b32 v1, 63, v0
    v_lshlrev_b32 v2, 4, v1
    v_and_b32 v5, 15, v1
    v_and_b32 v6, 3, v5
    v_lshrrev_b32 v9, 2, v5
    v_lshrrev_b32 v7, 4, v1
    v_cmp_eq_u32 s[54:55], v9, v7
    s_lshl_b32 s42, s21, 3
    v_add_u32 v8, s42, v2
    s_mov_b32 s20, 0
    s_mov_b32 s52, 0xbfb8aa3b
    s_mov_b32 s53, 0x3acccccd
    s_mov_b32 s35, 64
    s_cmp_lg_u32 s3, 0
    s_cbranch_scc1 L_w_f10_59_d
    s_lshl_b32 s60, s20, 9
    s_add_u32 s60, s60, 69337088
    v_and_b32 v12, 3, v0
    v_lshlrev_b32 v12, 7, v12
    v_add_u32 v12, s60, v12
    s_mov_b32 s61, 0
L_w_f10_59:
    global_load_dword v13, v12, s[6:7] sc1
    s_add_u32 s61, s61, 1
    s_waitcnt vmcnt(0)
    v_readlane_b32 s60, v13, 0
    v_readlane_b32 s62, v13, 1
    s_nop 0
    s_add_u32 s60, s60, s62
    v_readlane_b32 s62, v13, 2
    s_nop 0
    s_add_u32 s60, s60, s62
    v_readlane_b32 s62, v13, 3
    s_nop 0
    s_add_u32 s60, s60, s62
    s_cmp_ge_u32 s61, 100000
    s_cselect_b32 s63, 1, s63
    s_cmp_lg_u32 s63, 0
    s_cbranch_scc1 L_w_f10_59_d
    s_cmp_ge_u32 s60, 40
    s_cbranch_scc1 L_w_f10_59_d
    s_branch L_w_f10_59
L_w_f10_59_d:
    s_barrier
    s_lshl_b32 s43, s20, 1
    s_lshr_b32 s45, s3, 1
    s_add_u32 s45, s45, s43
    s_mul_i32 s44, s45, 20480
    s_add_u32 s44, s44, 96468992
    buffer_load_dwordx4 v[16:19], v2, s[8:11], s44 offen offset:0 sc1
    buffer_load_dwordx4 v[20:23], v2, s[8:11], s44 offen offset:1024 sc1
    buffer_load_dwordx4 v[24:27], v2, s[8:11], s44 offen offset:2048 sc1
    buffer_load_dwordx4 v[28:31], v2, s[8:11], s44 offen offset:3072 sc1
    s_add_u32 s49, s44, 4096
    buffer_load_dwordx4 v[32:35], v2, s[8:11], s49 offen sc1
    s_add_u32 s49, s44, 5120
    buffer_load_dwordx4 v[36:39], v2, s[8:11], s49 offen sc1
    s_add_u32 s49, s44, 6144
    buffer_load_dwordx4 v[40:43], v2, s[8:11], s49 offen sc1
    s_add_u32 s49, s44, 7168
    buffer_load_dwordx4 v[44:47], v2, s[8:11], s49 offen sc1
    s_add_u32 s49, s44, 8192
    buffer_load_dwordx4 v[48:51], v2, s[8:11], s49 offen sc1
    s_add_u32 s49, s44, 9216
    buffer_load_dwordx4 v[52:55], v2, s[8:11], s49 offen sc1
    s_add_u32 s49, s44, 10240
    buffer_load_dwordx4 v[56:59], v2, s[8:11], s49 offen sc1
    s_add_u32 s49, s44, 11264
    buffer_load_dwordx4 v[60:63], v2, s[8:11], s49 offen sc1
    s_add_u32 s49, s44, 12288
    buffer_load_dwordx4 v[64:67], v2, s[8:11], s49 offen sc1
    s_add_u32 s49, s44, 13312
    buffer_load_dwordx4 v[68:71], v2, s[8:11], s49 offen sc1
    s_add_u32 s49, s44, 14336
    buffer_load_dwordx4 v[72:75], v2, s[8:11], s49 offen sc1
    s_add_u32 s49, s44, 15360
    buffer_load_dwordx4 v[76:79], v2, s[8:11], s49 offen sc1
    s_add_u32 s49, s44, 16384
    buffer_load_dwordx4 v[80:83], v2, s[8:11], s49 offen sc1
    s_add_u32 s49, s44, 17408
    buffer_load_dwordx4 v[84:87], v2, s[8:11], s49 offen sc1
    s_add_u32 s49, s44, 18432
    buffer_load_dwordx4 v[88:91], v2, s[8:11], s49 offen sc1
    s_add_u32 s49, s44, 19456
    buffer_load_dwordx4 v[92:95], v2, s[8:11], s49 offen sc1
L_f1_loop:
    s_lshl_b32 s43, s20, 1
    s_lshr_b32 s46, s3, 1
    s_add_u32 s46, s46, s43
    s_add_u32 s32, s20, 1
    s_min_u32 s34, s32, 63
    s_lshl_b32 s60, s34, 9
    s_add_u32 s60, s60, 69337088
    v_and_b32 v12, 3, v0
    v_lshlrev_b32 v12, 7, v12
    v_add_u32 v12, s60, v12
    global_load_dword v13, v12, s[6:7] sc1
    s_waitcnt vmcnt(20)
    v_mfma_f32_16x16x32_bf16 v[128:131], a[0:3], v[16:19], 0
    v_mfma_f32_16x16x32_bf16 v[132:135], a[4:7], v[16:19], 0
    v_mfma_f32_16x16x32_bf16 v[136:139], v[144:147], v[16:19], 0
    v_mfma_f32_16x16x32_bf16 v[140:143], v[16:19], v[16:19], 0
    s_waitcnt vmcnt(19)
    v_mfma_f32_16x16x32_bf16 v[128:131], a[8:11], v[20:23], v[128:131]
    v_mfma_f32_16x16x32_bf16 v[132:135], a[12:15], v[20:23], v[132:135]
    v_mfma_f32_16x16x32_bf16 v[136:139], v[144:147], v[20:23], v[136:139]
    v_mfma_f32_16x16x32_bf16 v[140:143], v[20:23], v[20:23], v[140:143]
    s_waitcnt vmcnt(18)
    v_mfma_f32_16x16x32_bf16 v[128:131], a[16:19], v[24:27], v[128:131]
    v_mfma_f32_16x16x32_bf16 v[132:135], a[20:23], v[24:27], v[132:135]
    v_mfma_f32_16x16x32_bf16 v[136:139], v[144:147], v[24:27], v[136:139]
    v_mfma_f32_16x16x32_bf16 v[140:143], v[24:27], v[24:27], v[140:143]
    s_waitcnt vmcnt(17)
    v_mfma_f32_16x16x32_bf16 v[128:131], a[24:27], v[28:31], v[128:131]
    v_mfma_f32_16x16x32_bf16 v[132:135], a[28:31], v[28:31], v[132:135]
    v_mfma_f32_16x16x32_bf16 v[136:139], v[144:147], v[28:31], v[136:139]
    v_mfma_f32_16x16x32_bf16 v[140:143], v[28:31], v[28:31], v[140:143]
    s_waitcnt vmcnt(16)
    v_mfma_f32_16x16x32_bf16 v[128:131], a[32:35], v[32:35], v[128:131]
    v_mfma_f32_16x16x32_bf16 v[132:135], a[36:39], v[32:35], v[132:135]
    v_mfma_f32_16x16x32_bf16 v[136:139], v[144:147], v[32:35], v[136:139]
    v_mfma_f32_16x16x32_bf16 v[140:143], v[32:35], v[32:35], v[140:143]
    s_waitcnt vmcnt(15)
    v_mfma_f32_16x16x32_bf16 v[128:131], a[40:43], v[36:39], v[128:131]
    v_mfma_f32_16x16x32_bf16 v[132:135], a[44:47], v[36:39], v[132:135]
    v_mfma_f32_16x16x32_bf16 v[136:139], v[144:147], v[36:39], v[136:139]
    v_mfma_f32_16x16x32_bf16 v[140:143], v[36:39], v[36:39], v[140:143]
    s_waitcnt vmcnt(14)
    v_mfma_f32_16x16x32_bf16 v[128:131], a[48:51], v[40:43], v[128:131]
    v_mfma_f32_16x16x32_bf16 v[132:135], a[52:55], v[40:43], v[132:135]
    v_mfma_f32_16x16x32_bf16 v[136:139], v[144:147], v[40:43], v[136:139]
    v_mfma_f32_16x16x32_bf16 v[140:143], v[40:43], v[40:43], v[140:143]
    s_waitcnt vmcnt(13)
    v_mfma_f32_16x16x32_bf16 v[128:131], a[56:59], v[44:47], v[128:131]
    v_mfma_f32_16x16x32_bf16 v[132:135], a[60:63], v[44:47], v[132:135]
    v_mfma_f32_16x16x32_bf16 v[136:139], v[144:147], v[44:47], v[136:139]
    v_mfma_f32_16x16x32_bf16 v[140:143], v[44:47], v[44:47], v[140:143]
    s_waitcnt vmcnt(12)
    v_mfma_f32_16x16x32_bf16 v[128:131], a[64:67], v[48:51], v[128:131]
    v_mfma_f32_16x16x32_bf16 v[132:135], a[68:71], v[48:51], v[132:135]
    v_mfma_f32_16x16x32_bf16 v[136:139], v[144:147], v[48:51], v[136:139]
    v_mfma_f32_16x16x32_bf16 v[140:143], v[48:51], v[48:51], v[140:143]
    s_waitcnt vmcnt(11)
    v_mfma_f32_16x16x32_bf16 v[128:131], a[72:75], v[52:55], v[128:131]
    v_mfma_f32_16x16x32_bf16 v[132:135], a[76:79], v[52:55], v[132:135]
    v_mfma_f32_16x16x32_bf16 v[136:139], v[144:147], v[52:55], v[136:139]
    v_mfma_f32_16x16x32_bf16 v[140:143], v[52:55], v[52:55], v[140:143]
    s_waitcnt vmcnt(10)
    v_mfma_f32_16x16x32_bf16 v[128:131], a[80:83], v[56:59], v[128:131]
    v_mfma_f32_16x16x32_bf16 v[132:135], a[84:87], v[56:59], v[132:135]
    v_mfma_f32_16x16x32_bf16 v[136:139], v[144:147], v[56:59], v[136:139]
    v_mfma_f32_16x16x32_bf16 v[140:143], v[56:59], v[56:59], v[140:143]
    s_waitcnt vmcnt(9)
    v_mfma_f32_16x16x32_bf16 v[128:131], a[88:91], v[60:63], v[128:131]
    v_mfma_f32_16x16x32_bf16 v[132:135], a[92:95], v[60:63], v[132:135]
    v_mfma_f32_16x16x32_bf16 v[136:139], v[144:147], v[60:63], v[136:139]
    v_mfma_f32_16x16x32_bf16 v[140:143], v[60:63], v[60:63], v[140:143]
    s_waitcnt vmcnt(8)
    v_mfma_f32_16x16x32_bf16 v[128:131], a[96:99], v[64:67], v[128:131]
    v_mfma_f32_16x16x32_bf16 v[132:135], a[100:103], v[64:67], v[132:135]
    v_mfma_f32_16x16x32_bf16 v[136:139], v[144:147], v[64:67], v[136:139]
    v_mfma_f32_16x16x32_bf16 v[140:143], v[64:67], v[64:67], v[140:143]
    s_waitcnt vmcnt(7)
    v_mfma_f32_16x16x32_bf16 v[128:131], a[104:107], v[68:71], v[128:131]
    v_mfma_f32_16x16x32_bf16 v[132:135], a[108:111], v[68:71], v[132:135]
    v_mfma_f32_16x16x32_bf16 v[136:139], v[144:147], v[68:71], v[136:139]
    v_mfma_f32_16x16x32_bf16 v[140:143], v[68:71], v[68:71], v[140:143]
    s_waitcnt vmcnt(6)
    v_mfma_f32_16x16x32_bf16 v[128:131], a[112:115], v[72:75], v[128:131]
    v_mfma_f32_16x16x32_bf16 v[132:135], a[116:119], v[72:75], v[132:135]
    v_mfma_f32_16x16x32_bf16 v[136:139], v[144:147], v[72:75], v[136:139]
    v_mfma_f32_16x16x32_bf16 v[140:143], v[72:75], v[72:75], v[140:143]
    s_waitcnt vmcnt(5)
    v_mfma_f32_16x16x32_bf16 v[128:131], a[120:123], v[76:79], v[128:131]
    v_mfma_f32_16x16x32_bf16 v[132:135], a[124:127], v[76:79], v[132:135]
    v_mfma_f32_16x16x32_bf16 v[136:139], v[144:147], v[76:79], v[136:139]
    v_mfma_f32_16x16x32_bf16 v[140:143], v[76:79], v[76:79], v[140:143]
    s_waitcnt vmcnt(4)
    v_mfma_f32_16x16x32_bf16 v[128:131], a[128:131], v[80:83], v[128:131]
    v_mfma_f32_16x16x32_bf16 v[132:135], a[132:135], v[80:83], v[132:135]
    v_mfma_f32_16x16x32_bf16 v[136:139], v[144:147], v[80:83], v[136:139]
    v_mfma_f32_16x16x32_bf16 v[140:143], v[80:83], v[80:83], v[140:143]
    s_waitcnt vmcnt(3)
    v_mfma_f32_16x16x32_bf16 v[128:131], a[136:139], v[84:87], v[128:131]
    v_mfma_f32_16x16x32_bf16 v[132:135], a[140:143], v[84:87], v[132:135]
    v_mfma_f32_16x16x32_bf16 v[136:139], v[144:147], v[84:87], v[136:139]
    v_mfma_f32_16x16x32_bf16 v[140:143], v[84:87], v[84:87], v[140:143]
    s_waitcnt vmcnt(2)
    v_mfma_f32_16x16x32_bf16 v[128:131], a[144:147], v[88:91], v[128:131]
    v_mfma_f32_16x16x32_bf16 v[132:135], a[148:151], v[88:91], v[132:135]
    v_mfma_f32_16x16x32_bf16 v[136:139], v[144:147], v[88:91], v[136:139]
    v_mfma_f32_16x16x32_bf16 v[140:143], v[88:91], v[88:91], v[140:143]
    s_waitcnt vmcnt(1)
    v_mfma_f32_16x16x32_bf16 v[128:131], a[152:155], v[92:95], v[128:131]
    v_mfma_f32_16x16x32_bf16 v[132:135], a[156:159], v[92:95], v[132:135]
    v_mfma_f32_16x16x32_bf16 v[136:139], v[144:147], v[92:95], v[136:139]
    v_mfma_f32_16x16x32_bf16 v[140:143], v[92:95], v[92:95], v[140:143]
    s_waitcnt vmcnt(0)
    v_readlane_b32 s60, v13, 0
    v_readlane_b32 s62, v13, 1
    s_nop 0
    s_add_u32 s60, s60, s62
    v_readlane_b32 s62, v13, 2
    s_nop 0
    s_add_u32 s60, s60, s62
    v_readlane_b32 s62, v13, 3
    s_nop 0
    s_add_u32 s60, s60, s62
    s_cmp_ge_u32 s60, 40
    s_cselect_b32 s33, 1, 0
    s_cmp_ge_u32 s32, 64
    s_cselect_b32 s33, 0, s33
    v_mov_b32 v14, 16384
    s_cmp_lg_u32 s3, 0
    s_cbranch_scc1 L_f1_nofl
    v_mov_b32 v15, s33
    ds_write_b32 v14, v15
    s_waitcnt lgkmcnt(0)
L_f1_nofl:
    s_barrier
    ds_read_b32 v15, v14
    s_cmp_ge_u32 s35, 64
    s_cbranch_scc1 L_f1_nopend
    s_cmp_lg_u32 s3, 0
    s_cbranch_scc1 L_sr_60
    s_lshl_b32 s60, s35, 9
    s_add_u32 s60, s60, 69369856
    s_and_b32 s61, s29, 3
    s_lshl_b32 s61, s61, 7
    s_add_u32 s60, s60, s61
    v_mov_b32 v12, s60
    v_mov_b32 v13, 1
    s_mov_b64 exec, 1
    global_atomic_add v12, v13, s[6:7]
    s_mov_b64 exec, -1
L_sr_60:
    s_mov_b32 s35, 64
L_f1_nopend:
    v_cmp_eq_u32 vcc, 1, v6
    s_nop 1
    v_cndmask_b32 v11, v140, v141, vcc
    v_cmp_eq_u32 vcc, 2, v6
    s_nop 1
    v_cndmask_b32 v11, v11, v142, vcc
    v_cmp_eq_u32 vcc, 3, v6
    s_nop 1
    v_cndmask_b32 v11, v11, v143, vcc
    v_cndmask_b32 v11, 0, v11, s[54:55]
    v_mov_b32 v10, v11
    s_nop 1
    v_permlane32_swap_b32 v10, v11
    v_add_f32 v11, v11, v10
    v_mov_b32 v10, v11
    s_nop 1
    v_permlane16_swap_b32 v10, v11
    v_add_f32 v11, v11, v10
    v_mul_f32 v10, s53, v136
    v_mul_f32 v11, s53, v11
    v_fma_f32 v11, -v10, v10, v11
    v_max_f32 v11, 0, v11
    v_add_f32 v11, 0x3727c5ac, v11
    v_rsq_f32 v11, v11
    s_waitcnt lgkmcnt(0)
    v_readfirstlane_b32 s33, v15
    s_nop 0
    s_cmp_eq_u32 s33, 0
    s_cbranch_scc1 L_f1_nopre
    s_lshl_b32 s43, s32, 1
    s_lshr_b32 s45, s3, 1
    s_add_u32 s45, s45, s43
    s_mul_i32 s44, s45, 20480
    s_add_u32 s44, s44, 96468992
    buffer_load_dwordx4 v[16:19], v2, s[8:11], s44 offen offset:0 sc1
    buffer_load_dwordx4 v[20:23], v2, s[8:11], s44 offen offset:1024 sc1
    buffer_load_dwordx4 v[24:27], v2, s[8:11], s44 offen offset:2048 sc1
    buffer_load_dwordx4 v[28:31], v2, s[8:11], s44 offen offset:3072 sc1
    s_add_u32 s49, s44, 4096
    buffer_load_dwordx4 v[32:35], v2, s[8:11], s49 offen sc1
    s_add_u32 s49, s44, 5120
    buffer_load_dwordx4 v[36:39], v2, s[8:11], s49 offen sc1
    s_add_u32 s49, s44, 6144
    buffer_load_dwordx4 v[40:43], v2, s[8:11], s49 offen sc1
    s_add_u32 s49, s44, 7168
    buffer_load_dwordx4 v[44:47], v2, s[8:11], s49 offen sc1
    s_add_u32 s49, s44, 8192
    buffer_load_dwordx4 v[48:51], v2, s[8:11], s49 offen sc1
    s_add_u32 s49, s44, 9216
    buffer_load_dwordx4 v[52:55], v2, s[8:11], s49 offen sc1
    s_add_u32 s49, s44, 10240
    buffer_load_dwordx4 v[56:59], v2, s[8:11], s49 offen sc1
    s_add_u32 s49, s44, 11264
    buffer_load_dwordx4 v[60:63], v2, s[8:11], s49 offen sc1
    s_add_u32 s49, s44, 12288
    buffer_load_dwordx4 v[64:67], v2, s[8:11], s49 offen sc1
    s_add_u32 s49, s44, 13312
    buffer_load_dwordx4 v[68:71], v2, s[8:11], s49 offen sc1
    s_add_u32 s49, s44, 14336
    buffer_load_dwordx4 v[72:75], v2, s[8:11], s49 offen sc1
    s_add_u32 s49, s44, 15360
    buffer_load_dwordx4 v[76:79], v2, s[8:11], s49 offen sc1
    s_add_u32 s49, s44, 16384
    buffer_load_dwordx4 v[80:83], v2, s[8:11], s49 offen sc1
    s_add_u32 s49, s44, 17408
    buffer_load_dwordx4 v[84:87], v2, s[8:11], s49 offen sc1
    s_add_u32 s49, s44, 18432
    buffer_load_dwordx4 v[88:91], v2, s[8:11], s49 offen sc1
    s_add_u32 s49, s44, 19456
    buffer_load_dwordx4 v[92:95], v2, s[8:11], s49 offen sc1
L_f1_nopre:
    v_fma_f32 v128, -v10, v240, v128
    v_fma_f32 v132, -v10, v244, v132
    v_fma_f32 v129, -v10, v241, v129
    v_fma_f32 v133, -v10, v245, v133
    v_fma_f32 v130, -v10, v242, v130
    v_fma_f32 v134, -v10, v246, v134
    v_fma_f32 v131, -v10, v243, v131
    v_fma_f32 v135, -v10, v247, v135
    v_mul_f32 v128, v128, v11
    v_mul_f32 v132, v132, v11
    v_mul_f32 v129, v129, v11
    v_mul_f32 v133, v133, v11
    v_mul_f32 v130, v130, v11
    v_mul_f32 v134, v134, v11
    v_mul_f32 v131, v131, v11
    v_mul_f32 v135, v135, v11
    v_mul_f32 v128, s52, v128
    v_exp_f32 v128, v128
    v_mul_f32 v129, s52, v129
    v_exp_f32 v129, v129
    v_mul_f32 v130, s52, v130
    v_exp_f32 v130, v130
    v_mul_f32 v131, s52, v131
    v_exp_f32 v131, v131
    v_add_f32 v128, 1.0, v128
    v_rcp_f32 v128, v128
    v_add_f32 v129, 1.0, v129
    v_rcp_f32 v129, v129
    v_add_f32 v130, 1.0, v130
    v_rcp_f32 v130, v130
    v_add_f32 v131, 1.0, v131
    v_rcp_f32 v131, v131
    v_mul_f32 v128, v128, v132
    v_mul_f32 v129, v129, v133
    v_mul_f32 v130, v130, v134
    v_mul_f32 v131, v131, v135
    v_cvt_pk_bf16_f32 v12, v128, v129
    v_cvt_pk_bf16_f32 v13, v130, v131
    s_mul_i32 s47, s46, 55296
    s_lshl_b32 s48, s29, 10
    s_add_u32 s47, s47, s48
    s_add_u32 s47, s47, 100663296
    buffer_store_dwordx2 v[12:13], v8, s[8:11], s47 offen sc1
    s_cmp_eq_u32 s33, 0
    s_cbranch_scc1 L_f1_signow
    s_mov_b32 s35, s20
    s_branch L_f1_sigdone
L_f1_signow:
    s_lshl_b32 s60, s34, 9
    s_add_u32 s60, s60, 69337088
    v_and_b32 v12, 3, v0
    v_lshlrev_b32 v12, 7, v12
    v_add_u32 v12, s60, v12
    global_load_dword v13, v12, s[6:7] sc1
    s_waitcnt vmcnt(0)
    v_readlane_b32 s60, v13, 0
    v_readlane_b32 s62, v13, 1
    s_nop 0
    s_add_u32 s60, s60, s62
    v_readlane_b32 s62, v13, 2
    s_nop 0
    s_add_u32 s60, s60, s62
    v_readlane_b32 s62, v13, 3
    s_nop 0
    s_add_u32 s60, s60, s62
    s_cmp_ge_u32 s60, 40
    s_cselect_b32 s36, 1, 0
    v_mov_b32 v14, 16388
    s_cmp_lg_u32 s3, 0
    s_cbranch_scc1 L_sp_61
    v_mov_b32 v15, s36
    ds_write_b32 v14, v15
    s_waitcnt lgkmcnt(0)
L_sp_61:
    s_barrier
    ds_read_b32 v15, v14
    s_cmp_lg_u32 s3, 0
    s_cbranch_scc1 L_sr_62
    s_lshl_b32 s60, s20, 9
    s_add_u32 s60, s60, 69369856
    s_and_b32 s61, s29, 3
    s_lshl_b32 s61, s61, 7
    s_add_u32 s60, s60, s61
    v_mov_b32 v12, s60
    v_mov_b32 v13, 1
    s_mov_b64 exec, 1
    global_atomic_add v12, v13, s[6:7]
    s_mov_b64 exec, -1
L_sr_62:
    s_waitcnt lgkmcnt(0)
    v_readfirstlane_b32 s36, v15
    s_branch L_f1_late
L_f1_sigdone:
    s_mov_b32 s36, 0
L_f1_late:
    s_mov_b32 s20, s32
    s_cmp_ge_u32 s20, 64
    s_cbranch_scc1 L_f1_fin
    s_cmp_lg_u32 s33, 0
    s_cbranch_scc1 L_f1_loop
    s_cmp_lg_u32 s36, 0
    s_cbranch_scc1 L_f1_go
    s_cmp_lg_u32 s3, 0
    s_cbranch_scc1 L_w_f11_63_d
    s_lshl_b32 s60, s20, 9
    s_add_u32 s60, s60, 69337088
    v_and_b32 v12, 3, v0
    v_lshlrev_b32 v12, 7, v12
    v_add_u32 v12, s60, v12
    s_mov_b32 s61, 0
L_w_f11_63:
    global_load_dword v13, v12, s[6:7] sc1
    s_add_u32 s61, s61, 1
    s_waitcnt vmcnt(0)
    v_readlane_b32 s60, v13, 0
    v_readlane_b32 s62, v13, 1
    s_nop 0
    s_add_u32 s60, s60, s62
    v_readlane_b32 s62, v13, 2
    s_nop 0
    s_add_u32 s60, s60, s62
    v_readlane_b32 s62, v13, 3
    s_nop 0
    s_add_u32 s60, s60, s62
    s_cmp_ge_u32 s61, 100000
    s_cselect_b32 s63, 1, s63
    s_cmp_lg_u32 s63, 0
    s_cbranch_scc1 L_w_f11_63_d
    s_cmp_ge_u32 s60, 40
    s_cbranch_scc1 L_w_f11_63_d
    s_branch L_w_f11_63
L_w_f11_63_d:
    s_barrier
L_f1_go:
    s_lshl_b32 s43, s20, 1
    s_lshr_b32 s45, s3, 1
    s_add_u32 s45, s45, s43
    s_mul_i32 s44, s45, 20480
    s_add_u32 s44, s44, 96468992
    buffer_load_dwordx4 v[16:19], v2, s[8:11], s44 offen offset:0 sc1
    buffer_load_dwordx4 v[20:23], v2, s[8:11], s44 offen offset:1024 sc1
    buffer_load_dwordx4 v[24:27], v2, s[8:11], s44 offen offset:2048 sc1
    buffer_load_dwordx4 v[28:31], v2, s[8:11], s44 offen offset:3072 sc1
    s_add_u32 s49, s44, 4096
    buffer_load_dwordx4 v[32:35], v2, s[8:11], s49 offen sc1
    s_add_u32 s49, s44, 5120
    buffer_load_dwordx4 v[36:39], v2, s[8:11], s49 offen sc1
    s_add_u32 s49, s44, 6144
    buffer_load_dwordx4 v[40:43], v2, s[8:11], s49 offen sc1
    s_add_u32 s49, s44, 7168
    buffer_load_dwordx4 v[44:47], v2, s[8:11], s49 offen sc1
    s_add_u32 s49, s44, 8192
    buffer_load_dwordx4 v[48:51], v2, s[8:11], s49 offen sc1
    s_add_u32 s49, s44, 9216
    buffer_load_dwordx4 v[52:55], v2, s[8:11], s49 offen sc1
    s_add_u32 s49, s44, 10240
    buffer_load_dwordx4 v[56:59], v2, s[8:11], s49 offen sc1
    s_add_u32 s49, s44, 11264
    buffer_load_dwordx4 v[60:63], v2, s[8:11], s49 offen sc1
    s_add_u32 s49, s44, 12288
    buffer_load_dwordx4 v[64:67], v2, s[8:11], s49 offen sc1
    s_add_u32 s49, s44, 13312
    buffer_load_dwordx4 v[68:71], v2, s[8:11], s49 offen sc1
    s_add_u32 s49, s44, 14336
    buffer_load_dwordx4 v[72:75], v2, s[8:11], s49 offen sc1
    s_add_u32 s49, s44, 15360
    buffer_load_dwordx4 v[76:79], v2, s[8:11], s49 offen sc1
    s_add_u32 s49, s44, 16384
    buffer_load_dwordx4 v[80:83], v2, s[8:11], s49 offen sc1
    s_add_u32 s49, s44, 17408
    buffer_load_dwordx4 v[84:87], v2, s[8:11], s49 offen sc1
    s_add_u32 s49, s44, 18432
    buffer_load_dwordx4 v[88:91], v2, s[8:11], s49 offen sc1
    s_add_u32 s49, s44, 19456
    buffer_load_dwordx4 v[92:95], v2, s[8:11], s49 offen sc1
    s_branch L_f1_loop
L_f1_fin:
    s_branch L_post_end
L_role_f2:
    s_mov_b32 s29, s16
    s_mov_b32 s28, 0
    s_load_dwordx2 s[24:25], s[0:1], 80
    s_load_dwordx2 s[26:27], s[0:1], 88
    s_lshl_b32 s21, s29, 6
    s_mov_b32 s20, s28
    s_mul_i32 s22, s3, 14
    s_cmp_eq_u32 s3, 3
    s_cselect_b32 s22, 41, s22
    s_lshl_b32 s23, s22, 5
    s_waitcnt lgkmcnt(0)
    s_mov_b32 s12, s24
    s_mov_b32 s13, s25
    s_mov_b32 s14, 0x21c000
    s_mov_b32 s15, 0x20000
    s_mov_b32 s16, s26
    s_mov_b32 s17, s27
    s_mov_b32 s18, 0x280000
    s_mov_b32 s19, 0x20000
    v_and_b32 v1, 63, v0
    v_lshrrev_b32 v4, 2, v1
    v_and_b32 v5, 3, v1
    s_mov_b32 s40, 1280
    v_mul_lo_u32 v6, s40, v4
    v_lshlrev_b32 v7, 4, v5
    v_add3_u32 v6, v6, v7, s21
    v_mul_u32_u24 v4, 96, v4
    v_add_u32 v4, v4, v7
    s_mul_i32 s41, s3, 6144
    s_add_u32 s41, s41, 16384
    v_add_u32 v4, s41, v4
    v_and_b32 v5, 15, v1
    v_lshrrev_b32 v7, 4, v1
    v_lshlrev_b32 v7, 2, v7
    v_lshrrev_b32 v8, 2, v5
    v_add_u32 v7, v7, v8
    v_mul_u32_u24 v7, 96, v7
    v_and_b32 v5, 3, v5
    v_lshlrev_b32 v5, 3, v5
    v_add3_u32 v7, v7, v5, s41
    s_mul_i32 s42, s23, 1280
    buffer_load_dwordx4 v[10:13], v6, s[12:15], s42 offen
    s_add_u32 s42, s42, 20480
    buffer_load_dwordx4 v[14:17], v6, s[12:15], s42 offen
    s_add_u32 s42, s42, 20480
    buffer_load_dwordx4 v[18:21], v6, s[12:15], s42 offen
    s_add_u32 s42, s42, 20480
    buffer_load_dwordx4 v[22:25], v6, s[12:15], s42 offen
    s_add_u32 s42, s42, 20480
    buffer_load_dwordx4 v[26:29], v6, s[12:15], s42 offen
    s_add_u32 s42, s42, 20480
    buffer_load_dwordx4 v[30:33], v6, s[12:15], s42 offen
    s_add_u32 s42, s42, 20480
    buffer_load_dwordx4 v[34:37], v6, s[12:15], s42 offen
    s_add_u32 s42, s42, 20480
    buffer_load_dwordx4 v[38:41], v6, s[12:15], s42 offen
    s_add_u32 s42, s42, 20480
    buffer_load_dwordx4 v[42:45], v6, s[12:15], s42 offen
    s_add_u32 s42, s42, 20480
    buffer_load_dwordx4 v[46:49], v6, s[12:15], s42 offen
    s_add_u32 s42, s42, 20480
    buffer_load_dwordx4 v[50:53], v6, s[12:15], s42 offen
    s_add_u32 s42, s42, 20480
    buffer_load_dwordx4 v[54:57], v6, s[12:15], s42 offen
    s_add_u32 s42, s42, 20480
    buffer_load_dwordx4 v[58:61], v6, s[12:15], s42 offen
    s_add_u32 s42, s42, 20480
    buffer_load_dwordx4 v[62:65], v6, s[12:15], s42 offen
    s_add_u32 s42, s42, 20480
    buffer_load_dwordx4 v[66:69], v6, s[12:15], s42 offen
    s_add_u32 s42, s42, 20480
    buffer_load_dwordx4 v[70:73], v6, s[12:15], s42 offen
    s_add_u32 s42, s42, 20480
    s_waitcnt vmcnt(14)
    ds_write_b128 v4, v[10:13] offset:0
    ds_write_b128 v4, v[14:17] offset:1536
    buffer_load_dwordx4 v[10:13], v6, s[12:15], s42 offen
    s_add_u32 s42, s42, 20480
    buffer_load_dwordx4 v[14:17], v6, s[12:15], s42 offen
    s_add_u32 s42, s42, 20480
    ds_read_b64_tr_b16 a[0:1], v7 offset:0
    ds_read_b64_tr_b16 a[2:3], v7 offset:1536
    ds_read_b64_tr_b16 a[4:5], v7 offset:32
    ds_read_b64_tr_b16 a[6:7], v7 offset:1568
    s_waitcnt vmcnt(14)
    ds_write_b128 v4, v[18:21] offset:3072
    ds_write_b128 v4, v[22:25] offset:4608
    buffer_load_dwordx4 v[18:21], v6, s[12:15], s42 offen
    s_add_u32 s42, s42, 20480
    buffer_load_dwordx4 v[22:25], v6, s[12:15], s42 offen
    s_add_u32 s42, s42, 20480
    ds_read_b64_tr_b16 a[8:9], v7 offset:3072
    ds_read_b64_tr_b16 a[10:11], v7 offset:4608
    ds_read_b64_tr_b16 a[12:13], v7 offset:3104
    ds_read_b64_tr_b16 a[14:15], v7 offset:4640
    s_waitcnt lgkmcnt(0)
    s_waitcnt vmcnt(14)
    ds_write_b128 v4, v[26:29] offset:0
    ds_write_b128 v4, v[30:33] offset:1536
    buffer_load_dwordx4 v[26:29], v6, s[12:15], s42 offen
    s_add_u32 s42, s42, 20480
    buffer_load_dwordx4 v[30:33], v6, s[12:15], s42 offen
    s_add_u32 s42, s42, 20480
    ds_read_b64_tr_b16 a[16:17], v7 offset:0
    ds_read_b64_tr_b16 a[18:19], v7 offset:1536
    ds_read_b64_tr_b16 a[20:21], v7 offset:32
    ds_read_b64_tr_b16 a[22:23], v7 offset:1568
    s_waitcnt vmcnt(14)
    ds_write_b128 v4, v[34:37] offset:3072
    ds_write_b128 v4, v[38:41] offset:4608
    buffer_load_dwordx4 v[34:37], v6, s[12:15], s42 offen
    s_add_u32 s42, s42, 20480
    buffer_load_dwordx4 v[38:41], v6, s[12:15], s42 offen
    s_add_u32 s42, s42, 20480
    ds_read_b64_tr_b16 a[24:25], v7 offset:3072
    ds_read_b64_tr_b16 a[26:27], v7 offset:4608
    ds_read_b64_tr_b16 a[28:29], v7 offset:3104
    ds_read_b64_tr_b16 a[30:31], v7 offset:4640
    s_waitcnt lgkmcnt(0)
    s_waitcnt vmcnt(14)
    ds_write_b128 v4, v[42:45] offset:0
    ds_write_b128 v4, v[46:49] offset:1536
    buffer_load_dwordx4 v[42:45], v6, s[12:15], s42 offen
    s_add_u32 s42, s42, 20480
    buffer_load_dwordx4 v[46:49], v6, s[12:15], s42 offen
    s_add_u32 s42, s42, 20480
    ds_read_b64_tr_b16 a[32:33], v7 offset:0
    ds_read_b64_tr_b16 a[34:35], v7 offset:1536
    ds_read_b64_tr_b16 a[36:37], v7 offset:32
    ds_read_b64_tr_b16 a[38:39], v7 offset:1568
    s_waitcnt vmcnt(14)
    ds_write_b128 v4, v[50:53] offset:3072
    ds_write_b128 v4, v[54:57] offset:4608
    s_mul_i32 s43, s23, 1280
    s_cmp_ge_u32 s3, 2
    s_cselect_b32 s42, s43, s42
    buffer_load_dwordx4 v[50:53], v6, s[12:15], s42 offen
    s_add_u32 s42, s42, 20480
    buffer_load_dwordx4 v[54:57], v6, s[12:15], s42 offen
    s_add_u32 s42, s42, 20480
    ds_read_b64_tr_b16 a[40:41], v7 offset:3072
    ds_read_b64_tr_b16 a[42:43], v7 offset:4608
    ds_read_b64_tr_b16 a[44:45], v7 offset:3104
    ds_read_b64_tr_b16 a[46:47], v7 offset:4640
    s_waitcnt lgkmcnt(0)
    s_waitcnt vmcnt(14)
    ds_write_b128 v4, v[58:61] offset:0
    ds_write_b128 v4, v[62:65] offset:1536
    ds_read_b64_tr_b16 a[48:49], v7 offset:0
    ds_read_b64_tr_b16 a[50:51], v7 offset:1536
    ds_read_b64_tr_b16 a[52:53], v7 offset:32
    ds_read_b64_tr_b16 a[54:55], v7 offset:1568
    s_waitcnt vmcnt(12)
    ds_write_b128 v4, v[66:69] offset:3072
    ds_write_b128 v4, v[70:73] offset:4608
    ds_read_b64_tr_b16 a[56:57], v7 offset:3072
    ds_read_b64_tr_b16 a[58:59], v7 offset:4608
    ds_read_b64_tr_b16 a[60:61], v7 offset:3104
    ds_read_b64_tr_b16 a[62:63], v7 offset:4640
    s_waitcnt lgkmcnt(0)
    s_waitcnt vmcnt(10)
    ds_write_b128 v4, v[10:13] offset:0
    ds_write_b128 v4, v[14:17] offset:1536
    ds_read_b64_tr_b16 a[64:65], v7 offset:0
    ds_read_b64_tr_b16 a[66:67], v7 offset:1536
    ds_read_b64_tr_b16 a[68:69], v7 offset:32
    ds_read_b64_tr_b16 a[70:71], v7 offset:1568
    s_waitcnt vmcnt(8)
    ds_write_b128 v4, v[18:21] offset:3072
    ds_write_b128 v4, v[22:25] offset:4608
    ds_read_b64_tr_b16 a[72:73], v7 offset:3072
    ds_read_b64_tr_b16 a[74:75], v7 offset:4608
    ds_read_b64_tr_b16 a[76:77], v7 offset:3104
    ds_read_b64_tr_b16 a[78:79], v7 offset:4640
    s_waitcnt lgkmcnt(0)
    s_waitcnt vmcnt(6)
    ds_write_b128 v4, v[26:29] offset:0
    ds_write_b128 v4, v[30:33] offset:1536
    ds_read_b64_tr_b16 a[80:81], v7 offset:0
    ds_read_b64_tr_b16 a[82:83], v7 offset:1536
    ds_read_b64_tr_b16 a[84:85], v7 offset:32
    ds_read_b64_tr_b16 a[86:87], v7 offset:1568
    s_waitcnt vmcnt(4)
    ds_write_b128 v4, v[34:37] offset:3072
    ds_write_b128 v4, v[38:41] offset:4608
    ds_read_b64_tr_b16 a[88:89], v7 offset:3072
    ds_read_b64_tr_b16 a[90:91], v7 offset:4608
    ds_read_b64_tr_b16 a[92:93], v7 offset:3104
    ds_read_b64_tr_b16 a[94:95], v7 offset:4640
    s_waitcnt lgkmcnt(0)
    s_waitcnt vmcnt(2)
    ds_write_b128 v4, v[42:45] offset:0
    ds_write_b128 v4, v[46:49] offset:1536
    ds_read_b64_tr_b16 a[96:97], v7 offset:0
    ds_read_b64_tr_b16 a[98:99], v7 offset:1536
    ds_read_b64_tr_b16 a[100:101], v7 offset:32
    ds_read_b64_tr_b16 a[102:103], v7 offset:1568
    s_waitcnt vmcnt(0)
    ds_write_b128 v4, v[50:53] offset:3072
    ds_write_b128 v4, v[54:57] offset:4608
    ds_read_b64_tr_b16 a[104:105], v7 offset:3072
    ds_read_b64_tr_b16 a[106:107], v7 offset:4608
    ds_read_b64_tr_b16 a[108:109], v7 offset:3104
    ds_read_b64_tr_b16 a[110:111], v7 offset:4640
    s_waitcnt lgkmcnt(0)
    s_waitcnt lgkmcnt(0)
    s_cmp_lt_u32 s3, 2
    s_cbranch_scc1 L_f2_z_64
    v_accvgpr_write_b32 a104, 0
    v_accvgpr_write_b32 a105, 0
    v_accvgpr_write_b32 a106, 0
    v_accvgpr_write_b32 a107, 0
    v_accvgpr_write_b32 a108, 0
    v_accvgpr_write_b32 a109, 0
    v_accvgpr_write_b32 a110, 0
    v_accvgpr_write_b32 a111, 0
L_f2_z_64:
    v_and_b32 v1, 63, v0
    v_lshlrev_b32 v2, 4, v1
    s_lshl_b32 s40, s3, 12
    v_add_u32 v3, s40, v2
    s_lshl_b32 s40, s3, 10
    v_add_u32 v4, s40, v2
    v_and_b32 v5, 15, v1
    v_lshrrev_b32 v6, 4, v1
    s_and_b32 s41, s3, 1
    s_lshl_b32 s42, s41, 5
    s_add_u32 s42, s42, s21
    v_mul_u32_u24 v7, 1280, v5
    v_lshlrev_b32 v8, 3, v6
    v_add3_u32 v7, v7, v8, s42
    s_lshl_b32 s42, s41, 3
    v_add_u32 v8, s42, v2
    v_lshlrev_b32 v9, 3, v5
    s_lshr_b32 s31, s20, 0
    s_mov_b32 s35, 64
    s_cmp_lg_u32 s3, 0
    s_cbranch_scc1 L_w_f20_65_d
    s_lshl_b32 s60, s31, 9
    s_add_u32 s60, s60, 69369856
    v_and_b32 v12, 3, v0
    v_lshlrev_b32 v12, 7, v12
    v_add_u32 v12, s60, v12
    s_mov_b32 s61, 0
L_w_f20_65:
    global_load_dword v13, v12, s[6:7] sc1
    s_add_u32 s61, s61, 1
    s_waitcnt vmcnt(0)
    v_readlane_b32 s60, v13, 0
    v_readlane_b32 s62, v13, 1
    s_nop 0
    s_add_u32 s60, s60, s62
    v_readlane_b32 s62, v13, 2
    s_nop 0
    s_add_u32 s60, s60, s62
    v_readlane_b32 s62, v13, 3
    s_nop 0
    s_add_u32 s60, s60, s62
    s_cmp_ge_u32 s61, 100000
    s_cselect_b32 s63, 1, s63
    s_cmp_lg_u32 s63, 0
    s_cbranch_scc1 L_w_f20_65_d
    s_cmp_ge_u32 s60, 54
    s_cbranch_scc1 L_w_f20_65_d
    s_branch L_w_f20_65
L_w_f20_65_d:
    s_barrier
    s_lshl_b32 s43, s20, 1
    s_mul_i32 s44, s43, 55296
    s_lshl_b32 s45, s22, 10
    s_add_u32 s44, s44, s45
    s_add_u32 s44, s44, 100663296
    s_add_u32 s45, s44, 55296
    buffer_load_dwordx4 v[16:19], v2, s[8:11], s44 offen offset:0 sc1
    buffer_load_dwordx4 v[20:23], v2, s[8:11], s45 offen offset:0 sc1
    buffer_load_dwordx4 v[24:27], v2, s[8:11], s44 offen offset:1024 sc1
    buffer_load_dwordx4 v[28:31], v2, s[8:11], s45 offen offset:1024 sc1
    buffer_load_dwordx4 v[32:35], v2, s[8:11], s44 offen offset:2048 sc1
    buffer_load_dwordx4 v[36:39], v2, s[8:11], s45 offen offset:2048 sc1
    buffer_load_dwordx4 v[40:43], v2, s[8:11], s44 offen offset:3072 sc1
    buffer_load_dwordx4 v[44:47], v2, s[8:11], s45 offen offset:3072 sc1
    s_add_u32 s49, s44, 4096
    buffer_load_dwordx4 v[48:51], v2, s[8:11], s49 offen sc1
    s_add_u32 s49, s45, 4096
    buffer_load_dwordx4 v[52:55], v2, s[8:11], s49 offen sc1
    s_add_u32 s49, s44, 5120
    buffer_load_dwordx4 v[56:59], v2, s[8:11], s49 offen sc1
    s_add_u32 s49, s45, 5120
    buffer_load_dwordx4 v[60:63], v2, s[8:11], s49 offen sc1
    s_add_u32 s49, s44, 6144
    buffer_load_dwordx4 v[64:67], v2, s[8:11], s49 offen sc1
    s_add_u32 s49, s45, 6144
    buffer_load_dwordx4 v[68:71], v2, s[8:11], s49 offen sc1
    s_add_u32 s49, s44, 7168
    buffer_load_dwordx4 v[72:75], v2, s[8:11], s49 offen sc1
    s_add_u32 s49, s45, 7168
    buffer_load_dwordx4 v[76:79], v2, s[8:11], s49 offen sc1
    s_add_u32 s49, s44, 8192
    buffer_load_dwordx4 v[80:83], v2, s[8:11], s49 offen sc1
    s_add_u32 s49, s45, 8192
    buffer_load_dwordx4 v[84:87], v2, s[8:11], s49 offen sc1
    s_add_u32 s49, s44, 9216
    buffer_load_dwordx4 v[88:91], v2, s[8:11], s49 offen sc1
    s_add_u32 s49, s45, 9216
    buffer_load_dwordx4 v[92:95], v2, s[8:11], s49 offen sc1
    s_add_u32 s49, s44, 10240
    buffer_load_dwordx4 v[96:99], v2, s[8:11], s49 offen sc1
    s_add_u32 s49, s45, 10240
    buffer_load_dwordx4 v[100:103], v2, s[8:11], s49 offen sc1
    s_add_u32 s49, s44, 11264
    buffer_load_dwordx4 v[104:107], v2, s[8:11], s49 offen sc1
    s_add_u32 s49, s45, 11264
    buffer_load_dwordx4 v[108:111], v2, s[8:11], s49 offen sc1
    s_add_u32 s49, s44, 12288
    buffer_load_dwordx4 v[112:115], v2, s[8:11], s49 offen sc1
    s_add_u32 s49, s45, 12288
    buffer_load_dwordx4 v[116:119], v2, s[8:11], s49 offen sc1
    s_cmp_lt_u32 s3, 2
    s_cselect_b32 s49, 13312, 0
    s_add_u32 s49, s49, s44
    buffer_load_dwordx4 v[120:123], v2, s[8:11], s49 offen sc1
    s_cmp_lt_u32 s3, 2
    s_cselect_b32 s49, 13312, 0
    s_add_u32 s49, s49, s45
    buffer_load_dwordx4 v[124:127], v2, s[8:11], s49 offen sc1
L_f2_loop:
    s_lshl_b32 s46, s20, 1
    s_lshr_b32 s47, s3, 1
    s_add_u32 s46, s46, s47
    s_mul_i32 s47, s46, 20480
    s_lshl_b32 s48, s29, 10
    s_add_u32 s47, s47, s48
    s_add_u32 s47, s47, 96468992
    buffer_load_dwordx2 v[10:11], v8, s[8:11], s47 offen sc1
    s_add_u32 s32, s20, 1
    s_min_u32 s34, s32, 63
    s_lshr_b32 s34, s34, 0
    s_lshl_b32 s60, s34, 9
    s_add_u32 s60, s60, 69369856
    v_and_b32 v12, 3, v0
    v_lshlrev_b32 v12, 7, v12
    v_add_u32 v12, s60, v12
    global_load_dword v13, v12, s[6:7] sc1
    s_waitcnt vmcnt(29)
    v_mfma_f32_16x16x32_bf16 v[240:243], a[0:3], v[16:19], 0
    v_mfma_f32_16x16x32_bf16 v[244:247], a[4:7], v[16:19], 0
    s_waitcnt vmcnt(28)
    v_mfma_f32_16x16x32_bf16 v[248:251], a[0:3], v[20:23], 0
    v_mfma_f32_16x16x32_bf16 v[252:255], a[4:7], v[20:23], 0
    s_waitcnt vmcnt(27)
    v_mfma_f32_16x16x32_bf16 v[240:243], a[8:11], v[24:27], v[240:243]
    v_mfma_f32_16x16x32_bf16 v[244:247], a[12:15], v[24:27], v[244:247]
    s_waitcnt vmcnt(26)
    v_mfma_f32_16x16x32_bf16 v[248:251], a[8:11], v[28:31], v[248:251]
    v_mfma_f32_16x16x32_bf16 v[252:255], a[12:15], v[28:31], v[252:255]
    s_waitcnt vmcnt(25)
    v_mfma_f32_16x16x32_bf16 v[240:243], a[16:19], v[32:35], v[240:243]
    v_mfma_f32_16x16x32_bf16 v[244:247], a[20:23], v[32:35], v[244:247]
    s_waitcnt vmcnt(24)
    v_mfma_f32_16x16x32_bf16 v[248:251], a[16:19], v[36:39], v[248:251]
    v_mfma_f32_16x16x32_bf16 v[252:255], a[20:23], v[36:39], v[252:255]
    s_waitcnt vmcnt(23)
    v_mfma_f32_16x16x32_bf16 v[240:243], a[24:27], v[40:43], v[240:243]
    v_mfma_f32_16x16x32_bf16 v[244:247], a[28:31], v[40:43], v[244:247]
    s_waitcnt vmcnt(22)
    v_mfma_f32_16x16x32_bf16 v[248:251], a[24:27], v[44:47], v[248:251]
    v_mfma_f32_16x16x32_bf16 v[252:255], a[28:31], v[44:47], v[252:255]
    s_waitcnt vmcnt(21)
    v_mfma_f32_16x16x32_bf16 v[240:243], a[32:35], v[48:51], v[240:243]
    v_mfma_f32_16x16x32_bf16 v[244:247], a[36:39], v[48:51], v[244:247]
    s_waitcnt vmcnt(20)
    v_mfma_f32_16x16x32_bf16 v[248:251], a[32:35], v[52:55], v[248:251]
    v_mfma_f32_16x16x32_bf16 v[252:255], a[36:39], v[52:55], v[252:255]
    s_waitcnt vmcnt(19)
    v_mfma_f32_16x16x32_bf16 v[240:243], a[40:43], v[56:59], v[240:243]
    v_mfma_f32_16x16x32_bf16 v[244:247], a[44:47], v[56:59], v[244:247]
    s_waitcnt vmcnt(18)
    v_mfma_f32_16x16x32_bf16 v[248:251], a[40:43], v[60:63], v[248:251]
    v_mfma_f32_16x16x32_bf16 v[252:255], a[44:47], v[60:63], v[252:255]
    s_waitcnt vmcnt(17)
    v_mfma_f32_16x16x32_bf16 v[240:243], a[48:51], v[64:67], v[240:243]
    v_mfma_f32_16x16x32_bf16 v[244:247], a[52:55], v[64:67], v[244:247]
    s_waitcnt vmcnt(16)
    v_mfma_f32_16x16x32_bf16 v[248:251], a[48:51], v[68:71], v[248:251]
    v_mfma_f32_16x16x32_bf16 v[252:255], a[52:55], v[68:71], v[252:255]
    s_waitcnt vmcnt(15)
    v_mfma_f32_16x16x32_bf16 v[240:243], a[56:59], v[72:75], v[240:243]
    v_mfma_f32_16x16x32_bf16 v[244:247], a[60:63], v[72:75], v[244:247]
    s_waitcnt vmcnt(14)
    v_mfma_f32_16x16x32_bf16 v[248:251], a[56:59], v[76:79], v[248:251]
    v_mfma_f32_16x16x32_bf16 v[252:255], a[60:63], v[76:79], v[252:255]
    s_waitcnt vmcnt(13)
    v_mfma_f32_16x16x32_bf16 v[240:243], a[64:67], v[80:83], v[240:243]
    v_mfma_f32_16x16x32_bf16 v[244:247], a[68:71], v[80:83], v[244:247]
    s_waitcnt vmcnt(12)
    v_mfma_f32_16x16x32_bf16 v[248:251], a[64:67], v[84:87], v[248:251]
    v_mfma_f32_16x16x32_bf16 v[252:255], a[68:71], v[84:87], v[252:255]
    s_waitcnt vmcnt(11)
    v_mfma_f32_16x16x32_bf16 v[240:243], a[72:75], v[88:91], v[240:243]
    v_mfma_f32_16x16x32_bf16 v[244:247], a[76:79], v[88:91], v[244:247]
    s_waitcnt vmcnt(10)
    v_mfma_f32_16x16x32_bf16 v[248:251], a[72:75], v[92:95], v[248:251]
    v_mfma_f32_16x16x32_bf16 v[252:255], a[76:79], v[92:95], v[252:255]
    s_waitcnt vmcnt(9)
    v_mfma_f32_16x16x32_bf16 v[240:243], a[80:83], v[96:99], v[240:243]
    v_mfma_f32_16x16x32_bf16 v[244:247], a[84:87], v[96:99], v[244:247]
    s_waitcnt vmcnt(8)
    v_mfma_f32_16x16x32_bf16 v[248:251], a[80:83], v[100:103], v[248:251]
    v_mfma_f32_16x16x32_bf16 v[252:255], a[84:87], v[100:103], v[252:255]
    s_waitcnt vmcnt(7)
    v_mfma_f32_16x16x32_bf16 v[240:243], a[88:91], v[104:107], v[240:243]
    v_mfma_f32_16x16x32_bf16 v[244:247], a[92:95], v[104:107], v[244:247]
    s_waitcnt vmcnt(6)
    v_mfma_f32_16x16x32_bf16 v[248:251], a[88:91], v[108:111], v[248:251]
    v_mfma_f32_16x16x32_bf16 v[252:255], a[92:95], v[108:111], v[252:255]
    s_waitcnt vmcnt(5)
    v_mfma_f32_16x16x32_bf16 v[240:243], a[96:99], v[112:115], v[240:243]
    v_mfma_f32_16x16x32_bf16 v[244:247], a[100:103], v[112:115], v[244:247]
    s_waitcnt vmcnt(4)
    v_mfma_f32_16x16x32_bf16 v[248:251], a[96:99], v[116:119], v[248:251]
    v_mfma_f32_16x16x32_bf16 v[252:255], a[100:103], v[116:119], v[252:255]
    s_waitcnt vmcnt(3)
    v_mfma_f32_16x16x32_bf16 v[240:243], a[104:107], v[120:123], v[240:243]
    v_mfma_f32_16x16x32_bf16 v[244:247], a[108:111], v[120:123], v[244:247]
    s_waitcnt vmcnt(2)
    v_mfma_f32_16x16x32_bf16 v[248:251], a[104:107], v[124:127], v[248:251]
    v_mfma_f32_16x16x32_bf16 v[252:255], a[108:111], v[124:127], v[252:255]
    s_waitcnt vmcnt(0)
    v_readlane_b32 s60, v13, 0
    v_readlane_b32 s62, v13, 1
    s_nop 0
    s_add_u32 s60, s60, s62
    v_readlane_b32 s62, v13, 2
    s_nop 0
    s_add_u32 s60, s60, s62
    v_readlane_b32 s62, v13, 3
    s_nop 0
    s_add_u32 s60, s60, s62
    s_cmp_ge_u32 s60, 54
    s_cselect_b32 s33, 1, 0
    s_cmp_ge_u32 s32, 64
    s_cselect_b32 s33, 0, s33
    ds_write_b128 v3, v[240:243] offset:0
    ds_write_b128 v3, v[244:247] offset:1024
    ds_write_b128 v3, v[248:251] offset:2048
    ds_write_b128 v3, v[252:255] offset:3072
    v_mov_b32 v14, 53248
    s_cmp_lg_u32 s3, 0
    s_cbranch_scc1 L_f2_nofl
    v_mov_b32 v15, s33
    ds_write_b32 v14, v15
L_f2_nofl:
    s_waitcnt lgkmcnt(0)
    s_barrier
    ds_read_b32 v15, v14
    ds_read_b128 v[240:243], v4 offset:0
    ds_read_b128 v[244:247], v4 offset:4096
    ds_read_b128 v[248:251], v4 offset:8192
    ds_read_b128 v[252:255], v4 offset:12288
    s_waitcnt lgkmcnt(4)
    v_readfirstlane_b32 s33, v15
    s_nop 0
    s_cmp_eq_u32 s33, 0
    s_cbranch_scc1 L_f2_nopre
    s_lshl_b32 s43, s32, 1
    s_mul_i32 s44, s43, 55296
    s_lshl_b32 s45, s22, 10
    s_add_u32 s44, s44, s45
    s_add_u32 s44, s44, 100663296
    s_add_u32 s45, s44, 55296
    buffer_load_dwordx4 v[16:19], v2, s[8:11], s44 offen offset:0 sc1
    buffer_load_dwordx4 v[20:23], v2, s[8:11], s45 offen offset:0 sc1
    buffer_load_dwordx4 v[24:27], v2, s[8:11], s44 offen offset:1024 sc1
    buffer_load_dwordx4 v[28:31], v2, s[8:11], s45 offen offset:1024 sc1
    buffer_load_dwordx4 v[32:35], v2, s[8:11], s44 offen offset:2048 sc1
    buffer_load_dwordx4 v[36:39], v2, s[8:11], s45 offen offset:2048 sc1
    buffer_load_dwordx4 v[40:43], v2, s[8:11], s44 offen offset:3072 sc1
    buffer_load_dwordx4 v[44:47], v2, s[8:11], s45 offen offset:3072 sc1
    s_add_u32 s49, s44, 4096
    buffer_load_dwordx4 v[48:51], v2, s[8:11], s49 offen sc1
    s_add_u32 s49, s45, 4096
    buffer_load_dwordx4 v[52:55], v2, s[8:11], s49 offen sc1
    s_add_u32 s49, s44, 5120
    buffer_load_dwordx4 v[56:59], v2, s[8:11], s49 offen sc1
    s_add_u32 s49, s45, 5120
    buffer_load_dwordx4 v[60:63], v2, s[8:11], s49 offen sc1
    s_add_u32 s49, s44, 6144
    buffer_load_dwordx4 v[64:67], v2, s[8:11], s49 offen sc1
    s_add_u32 s49, s45, 6144
    buffer_load_dwordx4 v[68:71], v2, s[8:11], s49 offen sc1
    s_add_u32 s49, s44, 7168
    buffer_load_dwordx4 v[72:75], v2, s[8:11], s49 offen sc1
    s_add_u32 s49, s45, 7168
    buffer_load_dwordx4 v[76:79], v2, s[8:11], s49 offen sc1
    s_add_u32 s49, s44, 8192
    buffer_load_dwordx4 v[80:83], v2, s[8:11], s49 offen sc1
    s_add_u32 s49, s45, 8192
    buffer_load_dwordx4 v[84:87], v2, s[8:11], s49 offen sc1
    s_add_u32 s49, s44, 9216
    buffer_load_dwordx4 v[88:91], v2, s[8:11], s49 offen sc1
    s_add_u32 s49, s45, 9216
    buffer_load_dwordx4 v[92:95], v2, s[8:11], s49 offen sc1
    s_add_u32 s49, s44, 10240
    buffer_load_dwordx4 v[96:99], v2, s[8:11], s49 offen sc1
    s_add_u32 s49, s45, 10240
    buffer_load_dwordx4 v[100:103], v2, s[8:11], s49 offen sc1
    s_add_u32 s49, s44, 11264
    buffer_load_dwordx4 v[104:107], v2, s[8:11], s49 offen sc1
    s_add_u32 s49, s45, 11264
    buffer_load_dwordx4 v[108:111], v2, s[8:11], s49 offen sc1
    s_add_u32 s49, s44, 12288
    buffer_load_dwordx4 v[112:115], v2, s[8:11], s49 offen sc1
    s_add_u32 s49, s45, 12288
    buffer_load_dwordx4 v[116:119], v2, s[8:11], s49 offen sc1
    s_cmp_lt_u32 s3, 2
    s_cselect_b32 s49, 13312, 0
    s_add_u32 s49, s49, s44
    buffer_load_dwordx4 v[120:123], v2, s[8:11], s49 offen sc1
    s_cmp_lt_u32 s3, 2
    s_cselect_b32 s49, 13312, 0
    s_add_u32 s49, s49, s45
    buffer_load_dwordx4 v[124:127], v2, s[8:11], s49 offen sc1
L_f2_nopre:
    s_waitcnt lgkmcnt(0)
    s_barrier
    v_add_f32 v240, v240, v244
    v_add_f32 v248, v248, v252
    v_add_f32 v241, v241, v245
    v_add_f32 v249, v249, v253
    v_add_f32 v242, v242, v246
    v_add_f32 v250, v250, v254
    v_add_f32 v243, v243, v247
    v_add_f32 v251, v251, v255
    v_add_f32 v240, v240, v248
    v_add_f32 v241, v241, v249
    v_add_f32 v242, v242, v250
    v_add_f32 v243, v243, v251
    v_lshlrev_b32 v244, 16, v10
    v_and_b32 v245, 0xffff0000, v10
    v_lshlrev_b32 v246, 16, v11
    v_and_b32 v247, 0xffff0000, v11
    v_add_f32 v240, v240, v244
    v_add_f32 v241, v241, v245
    v_add_f32 v242, v242, v246
    v_add_f32 v243, v243, v247
    v_cvt_pk_bf16_f32 v10, v240, v241
    v_cvt_pk_bf16_f32 v11, v242, v243
    s_mul_i32 s47, s46, 20480
    buffer_store_dwordx2 v[10:11], v7, s[16:19], s47 offen
    s_mov_b32 s36, 0
    s_cmp_lg_u32 s33, 0
    s_cbranch_scc1 L_f2_late
    s_lshl_b32 s60, s34, 9
    s_add_u32 s60, s60, 69369856
    v_and_b32 v12, 3, v0
    v_lshlrev_b32 v12, 7, v12
    v_add_u32 v12, s60, v12
    global_load_dword v13, v12, s[6:7] sc1
    s_waitcnt vmcnt(0)
    v_readlane_b32 s60, v13, 0
    v_readlane_b32 s62, v13, 1
    s_nop 0
    s_add_u32 s60, s60, s62
    v_readlane_b32 s62, v13, 2
    s_nop 0
    s_add_u32 s60, s60, s62
    v_readlane_b32 s62, v13, 3
    s_nop 0
    s_add_u32 s60, s60, s62
    s_cmp_ge_u32 s60, 54
    s_cselect_b32 s36, 1, 0
    v_mov_b32 v14, 53252
    s_cmp_lg_u32 s3, 0
    s_cbranch_scc1 L_sp_66
    v_mov_b32 v15, s36
    ds_write_b32 v14, v15
    s_waitcnt lgkmcnt(0)
L_sp_66:
    s_barrier
    ds_read_b32 v15, v14
    s_waitcnt lgkmcnt(0)
    v_readfirstlane_b32 s36, v15
L_f2_late:
    s_mov_b32 s20, s32
    s_cmp_ge_u32 s20, 64
    s_cbranch_scc1 L_f2_fin
    s_lshr_b32 s31, s20, 0
    s_cmp_lg_u32 s33, 0
    s_cbranch_scc1 L_f2_loop
    s_cmp_lg_u32 s36, 0
    s_cbranch_scc1 L_f2_go
    s_cmp_lg_u32 s3, 0
    s_cbranch_scc1 L_w_f21_67_d
    s_lshl_b32 s60, s31, 9
    s_add_u32 s60, s60, 69369856
    v_and_b32 v12, 3, v0
    v_lshlrev_b32 v12, 7, v12
    v_add_u32 v12, s60, v12
    s_mov_b32 s61, 0
L_w_f21_67:
    global_load_dword v13, v12, s[6:7] sc1
    s_add_u32 s61, s61, 1
    s_waitcnt vmcnt(0)
    v_readlane_b32 s60, v13, 0
    v_readlane_b32 s62, v13, 1
    s_nop 0
    s_add_u32 s60, s60, s62
    v_readlane_b32 s62, v13, 2
    s_nop 0
    s_add_u32 s60, s60, s62
    v_readlane_b32 s62, v13, 3
    s_nop 0
    s_add_u32 s60, s60, s62
    s_cmp_ge_u32 s61, 100000
    s_cselect_b32 s63, 1, s63
    s_cmp_lg_u32 s63, 0
    s_cbranch_scc1 L_w_f21_67_d
    s_cmp_ge_u32 s60, 54
    s_cbranch_scc1 L_w_f21_67_d
    s_branch L_w_f21_67
L_w_f21_67_d:
    s_barrier
L_f2_go:
    s_lshl_b32 s43, s20, 1
    s_mul_i32 s44, s43, 55296
    s_lshl_b32 s45, s22, 10
    s_add_u32 s44, s44, s45
    s_add_u32 s44, s44, 100663296
    s_add_u32 s45, s44, 55296
    buffer_load_dwordx4 v[16:19], v2, s[8:11], s44 offen offset:0 sc1
    buffer_load_dwordx4 v[20:23], v2, s[8:11], s45 offen offset:0 sc1
    buffer_load_dwordx4 v[24:27], v2, s[8:11], s44 offen offset:1024 sc1
    buffer_load_dwordx4 v[28:31], v2, s[8:11], s45 offen offset:1024 sc1
    buffer_load_dwordx4 v[32:35], v2, s[8:11], s44 offen offset:2048 sc1
    buffer_load_dwordx4 v[36:39], v2, s[8:11], s45 offen offset:2048 sc1
    buffer_load_dwordx4 v[40:43], v2, s[8:11], s44 offen offset:3072 sc1
    buffer_load_dwordx4 v[44:47], v2, s[8:11], s45 offen offset:3072 sc1
    s_add_u32 s49, s44, 4096
    buffer_load_dwordx4 v[48:51], v2, s[8:11], s49 offen sc1
    s_add_u32 s49, s45, 4096
    buffer_load_dwordx4 v[52:55], v2, s[8:11], s49 offen sc1
    s_add_u32 s49, s44, 5120
    buffer_load_dwordx4 v[56:59], v2, s[8:11], s49 offen sc1
    s_add_u32 s49, s45, 5120
    buffer_load_dwordx4 v[60:63], v2, s[8:11], s49 offen sc1
    s_add_u32 s49, s44, 6144
    buffer_load_dwordx4 v[64:67], v2, s[8:11], s49 offen sc1
    s_add_u32 s49, s45, 6144
    buffer_load_dwordx4 v[68:71], v2, s[8:11], s49 offen sc1
    s_add_u32 s49, s44, 7168
    buffer_load_dwordx4 v[72:75], v2, s[8:11], s49 offen sc1
    s_add_u32 s49, s45, 7168
    buffer_load_dwordx4 v[76:79], v2, s[8:11], s49 offen sc1
    s_add_u32 s49, s44, 8192
    buffer_load_dwordx4 v[80:83], v2, s[8:11], s49 offen sc1
    s_add_u32 s49, s45, 8192
    buffer_load_dwordx4 v[84:87], v2, s[8:11], s49 offen sc1
    s_add_u32 s49, s44, 9216
    buffer_load_dwordx4 v[88:91], v2, s[8:11], s49 offen sc1
    s_add_u32 s49, s45, 9216
    buffer_load_dwordx4 v[92:95], v2, s[8:11], s49 offen sc1
    s_add_u32 s49, s44, 10240
    buffer_load_dwordx4 v[96:99], v2, s[8:11], s49 offen sc1
    s_add_u32 s49, s45, 10240
    buffer_load_dwordx4 v[100:103], v2, s[8:11], s49 offen sc1
    s_add_u32 s49, s44, 11264
    buffer_load_dwordx4 v[104:107], v2, s[8:11], s49 offen sc1
    s_add_u32 s49, s45, 11264
    buffer_load_dwordx4 v[108:111], v2, s[8:11], s49 offen sc1
    s_add_u32 s49, s44, 12288
    buffer_load_dwordx4 v[112:115], v2, s[8:11], s49 offen sc1
    s_add_u32 s49, s45, 12288
    buffer_load_dwordx4 v[116:119], v2, s[8:11], s49 offen sc1
    s_cmp_lt_u32 s3, 2
    s_cselect_b32 s49, 13312, 0
    s_add_u32 s49, s49, s44
    buffer_load_dwordx4 v[120:123], v2, s[8:11], s49 offen sc1
    s_cmp_lt_u32 s3, 2
    s_cselect_b32 s49, 13312, 0
    s_add_u32 s49, s49, s45
    buffer_load_dwordx4 v[124:127], v2, s[8:11], s49 offen sc1
    s_branch L_f2_loop
L_f2_fin:
L_post_end:
L_w_end:
    s_waitcnt vmcnt(0)
L_end:
    s_endpgm
.section .rodata,"a"
.p2align 6
.amdhsa_kernel main_kernel
  .amdhsa_next_free_vgpr 512
  .amdhsa_next_free_sgpr 102
  .amdhsa_accum_offset 256
  .amdhsa_group_segment_fixed_size 0
  .amdhsa_kernarg_size 112
  .amdhsa_user_sgpr_count 2
  .amdhsa_user_sgpr_kernarg_segment_ptr 1
  .amdhsa_system_sgpr_workgroup_id_x 1
  .amdhsa_float_denorm_mode_32 3
.end_amdhsa_kernel
```
